```python
import torch

def _softmax(x, axis=-1):
    return torch.softmax(x, dim=axis)
def _gelu(x):
    return torch.nn.functional.gelu(x, approximate="tanh")
def _silu(x):
    return torch.nn.functional.silu(x)
def _sigmoid(x):
    return torch.sigmoid(x)
def _layernorm(x, axis=-1, eps=1e-5):
    m = x.mean(dim=axis, keepdim=True)
    v = x.var(dim=axis, keepdim=True, unbiased=False)
    return (x - m) / torch.sqrt(v + eps)
def _scatter_add(tgt, idx, src, axis=0):
    return tgt.clone().index_add_(axis, idx, src)
def _segment_sum(src, seg, n):
    out = torch.zeros((n,) + src.shape[1:], dtype=src.dtype)
    return out.index_add_(0, seg, src)
def _pad(x, pw):
    flat = tuple(v for pair in reversed(pw) for v in pair)
    return torch.nn.functional.pad(x, flat)

kernel_name = 'concat_heads__gqa_block_cached__gqa_block_cached__near_ridge'

def setup_inputs():

    _w = (lambda a: (lambda t: t.to(torch.bfloat16) if t.is_floating_point() else t)(torch.as_tensor(a)))
    def _A_setup():
        B, Sq, D = 8, 96, 640
        Hq, Hkv, Sk, Dh = 32, 32, 512, 128
        assert Hq % Hkv == 0, (Hq, Hkv)
        return {
            "x": _w((lambda *s: torch.randn(*s, dtype=torch.bfloat16) * 0.8)(B, Sq, D)),
            "k_cache": _w((lambda *s: torch.randn(*s, dtype=torch.bfloat16) * 0.8)(B, Hkv, Sk, Dh)),
            "v_cache": _w((lambda *s: torch.randn(*s, dtype=torch.bfloat16) * 0.05)(B, Hkv, Sk, Dh)),
            "wq": _w((lambda *s: torch.randn(*s, dtype=torch.bfloat16) * 0.8)(D, Hq * Dh) * (D ** -0.5)),
            "wo": _w((lambda *s: torch.randn(*s, dtype=torch.bfloat16) * 0.05)(Hq * Dh, D) * ((Hq * Dh) ** -0.5)),
        }
    _A_in = _A_setup()

    def _B_setup():
        B, Sq, D = 8, 96, 640
        Hq, Hkv, Sk, Dh = 32, 32, 512, 128
        assert Hq % Hkv == 0, (Hq, Hkv)
        return {
            "x": _w((lambda *s: torch.randn(*s, dtype=torch.bfloat16) * 0.8)(B, Sq, D)),
            "k_cache": _w((lambda *s: torch.randn(*s, dtype=torch.bfloat16) * 0.8)(B, Hkv, Sk, Dh)),
            "v_cache": _w((lambda *s: torch.randn(*s, dtype=torch.bfloat16) * 0.05)(B, Hkv, Sk, Dh)),
            "wq": _w((lambda *s: torch.randn(*s, dtype=torch.bfloat16) * 0.8)(D, Hq * Dh) * (D ** -0.5)),
            "wo": _w((lambda *s: torch.randn(*s, dtype=torch.bfloat16) * 0.05)(Hq * Dh, D) * ((Hq * Dh) ** -0.5)),
        }
    _B_in = _B_setup()

    return {
        "A_x": _A_in["x"],
        "A_k_cache": _A_in["k_cache"],
        "A_v_cache": _A_in["v_cache"],
        "A_wq": _A_in["wq"],
        "A_wo": _A_in["wo"],
        "B_x": _B_in["x"],
        "B_k_cache": _B_in["k_cache"],
        "B_v_cache": _B_in["v_cache"],
        "B_wq": _B_in["wq"],
        "B_wo": _B_in["wo"],
    }

def reference(A_x, A_k_cache, A_v_cache, A_wq, A_wo, B_x, B_k_cache, B_v_cache, B_wq, B_wo):
    def _A_ref(x, k_cache, v_cache, wq, wo):
        B, Sq, D = x.shape
        Hq, Dh = 32, 128
        Hkv = k_cache.shape[1]
        rep = Hq // Hkv
        q = (lambda x, *d: x.permute(*d))((x @ wq).reshape(B, Sq, Hq, Dh), 0, 2, 1, 3)
        k = (lambda x, n, axis: torch.repeat_interleave(x, n, dim=axis))(k_cache, rep, axis=1)
        v = (lambda x, n, axis: torch.repeat_interleave(x, n, dim=axis))(v_cache, rep, axis=1)
        scores = torch.einsum("bhqd,bhkd->bhqk", q, k) * (Dh ** -0.5)
        p = _softmax(scores, axis=-1)
        o = torch.einsum("bhqk,bhkd->bhqd", p, v)
        return (lambda x, *d: x.permute(*d))(o, 0, 2, 1, 3).reshape(B, Sq, Hq * Dh) @ wo

    def _B_ref(x, k_cache, v_cache, wq, wo):
        B, Sq, D = x.shape
        Hq, Dh = 32, 128
        Hkv = k_cache.shape[1]
        rep = Hq // Hkv
        q = (lambda x, *d: x.permute(*d))((x @ wq).reshape(B, Sq, Hq, Dh), 0, 2, 1, 3)
        k = (lambda x, n, axis: torch.repeat_interleave(x, n, dim=axis))(k_cache, rep, axis=1)
        v = (lambda x, n, axis: torch.repeat_interleave(x, n, dim=axis))(v_cache, rep, axis=1)
        scores = torch.einsum("bhqd,bhkd->bhqk", q, k) * (Dh ** -0.5)
        p = _softmax(scores, axis=-1)
        o = torch.einsum("bhqk,bhkd->bhqd", p, v)
        return (lambda x, *d: x.permute(*d))(o, 0, 2, 1, 3).reshape(B, Sq, Hq * Dh) @ wo

    a = _A_ref(A_x, A_k_cache, A_v_cache, A_wq, A_wo)
    b = _B_ref(B_x, B_k_cache, B_v_cache, B_wq, B_wo)
    return torch.concatenate([a, b], axis=-1)
```

```asm
; @launch grid=(256,1,1) block=(512,1,1) lds=163840
.amdgcn_target "amdgcn-amd-amdhsa--gfx950"
.text
.globl concat_heads__gqa_block_cached__gqa_block_cached__near_ridge_kernel
.p2align 8
.type concat_heads__gqa_block_cached__gqa_block_cached__near_ridge_kernel,@function
concat_heads__gqa_block_cached__gqa_block_cached__near_ridge_kernel:
    s_cmp_ge_u32 s2, 256
    s_cbranch_scc1 L_end
    s_and_b32 s7, s2, 7
    s_lshr_b32 s43, s2, 3
    s_lshr_b32 s4, s7, 2
    s_mul_i32 s44, s4, 40
    s_add_u32 s44, s0, s44
    s_addc_u32 s45, s1, 0
    s_load_dwordx2 s[20:21], s[44:45], 0
    s_load_dwordx2 s[8:9], s[44:45], 8
    s_load_dwordx2 s[12:13], s[44:45], 16
    s_load_dwordx2 s[16:17], s[44:45], 24
    s_load_dwordx2 s[28:29], s[44:45], 32
    s_load_dwordx2 s[32:33], s[0:1], 80
    s_load_dwordx2 s[36:37], s[0:1], 88
    s_load_dwordx2 s[24:25], s[0:1], 96
    v_lshrrev_b32 v1, 6, v0
    v_and_b32 v249, 63, v0
    s_and_b32 s94, s7, 3
    v_readfirstlane_b32 s3, v1
    s_lshl_b32 s7, s94, 2
    s_lshr_b32 s95, s43, 3
    s_add_u32 s5, s95, s7
    s_and_b32 s6, s43, 7
    v_lshrrev_b32 v250, 4, v249
    v_and_b32 v251, 15, v249
    s_lshl_b32 s46, s6, 5
    s_add_u32 s46, s46, s5
    s_lshl_b32 s46, s46, 17
    s_lshl_b32 s47, s5, 8
    s_mul_i32 s48, s6, 122880
    s_sub_u32 s49, 5242880, s47
    s_waitcnt lgkmcnt(0)
    s_add_u32 s20, s20, s48
    s_addc_u32 s21, s21, 0
    s_and_b32 s21, s21, 0xffff
    s_mov_b32 s22, 122880
    s_mov_b32 s23, 0x20000
    s_add_u32 s16, s16, s47
    s_addc_u32 s17, s17, 0
    s_and_b32 s17, s17, 0xffff
    s_mov_b32 s18, s49
    s_mov_b32 s19, 0x20000
    s_add_u32 s8, s8, s46
    s_addc_u32 s9, s9, 0
    s_and_b32 s9, s9, 0xffff
    s_mov_b32 s10, 2228224
    s_mov_b32 s11, 0x20000
    s_add_u32 s12, s12, s46
    s_addc_u32 s13, s13, 0
    s_and_b32 s13, s13, 0xffff
    s_mov_b32 s14, 2228224
    s_mov_b32 s15, 0x20000
    s_cmp_ge_u32 s3, 6
    s_cbranch_scc1 L_prod
    s_cmp_lt_u32 s3, 4
    s_cbranch_scc1 L_qp
    s_cmp_eq_u32 s3, 5
    s_cbranch_scc1 L_t5_1
    s_cmp_lt_u32 s6, 4
    s_cselect_b32 s46, 36, 76
    s_and_b32 s47, s6, 3
    s_add_u32 s46, s46, s47
    s_lshl_b32 s46, s46, 16
    v_lshrrev_b32 v252, 1, v249
    v_lshlrev_b32 v252, 12, v252
    v_and_b32 v253, 1, v249
    v_lshl_add_u32 v252, v253, 7, v252
    s_mov_b32 exec_hi, 0
    buffer_load_dword v22, v252, s[16:19], s46 offen sc1
    s_branch L_te_2
L_t5_1:
    s_and_b32 s47, s6, 1
    s_add_u32 s46, s47, 4
    s_cmp_eq_u32 s47, 0
    s_cselect_b32 s47, 9, 0
    s_cmp_lt_u32 s95, 2
    s_cselect_b32 s46, s46, s47
    s_lshl_b32 s46, s46, 7
    s_and_b32 s47, s95, 1
    s_mul_i32 s47, s47, 61440
    s_add_u32 s46, s46, s47
    v_mul_u32_u24 v252, 1280, v249
    s_mov_b32 exec_hi, 0xffff
    buffer_load_dword v22, v252, s[20:23], s46 offen sc1
L_te_2:
    s_mov_b64 exec, -1
    v_xor_b32 v252, v250, v251
    v_lshlrev_b32 v252, 4, v252
    v_lshl_add_u32 v224, v251, 8, v252
    v_xor_b32 v225, 64, v224
    v_xor_b32 v226, 0x80, v224
    v_xor_b32 v227, 0xc0, v224
    v_bfe_u32 v252, v249, 2, 2
    v_and_b32 v253, 3, v249
    v_and_b32 v254, 1, v250
    v_lshl_add_u32 v254, v254, 2, v252
    v_lshlrev_b32 v254, 5, v254
    v_lshl_add_u32 v254, v253, 3, v254
    v_lshl_add_u32 v255, v250, 2, v252
    v_lshl_add_u32 v228, v255, 8, v254
    v_xor_b32 v229, 32, v228
    v_xor_b32 v230, 64, v228
    v_xor_b32 v231, 96, v228
    v_xor_b32 v232, 128, v228
    v_xor_b32 v233, 160, v228
    v_xor_b32 v234, 192, v228
    v_xor_b32 v235, 224, v228
    v_mov_b32 v240, 0x3f803f80
    v_mov_b32 v241, 0x3f803f80
    v_mov_b32 v242, 0x3f803f80
    v_mov_b32 v243, 0x3f803f80
    s_lshl_b32 s46, s3, 17
    v_lshlrev_b32 v248, 4, v249
    v_add_u32 v248, s46, v248
    s_mov_b32 s41, 0x3e0293ee
    s_lshl_b32 s96, s4, 3
    s_add_u32 s96, s96, s6
    s_mul_i32 s99, s96, 786432
    s_lshl_b32 s47, s5, 12
    s_add_u32 s50, s99, s47
    s_lshl_b32 s51, s96, 3
    s_add_u32 s51, s51, 128
    s_lshl_b32 s96, s96, 2
    s_add_u32 s96, s96, s95
    s_and_b32 s25, s25, 0xffff
    s_mov_b32 s26, 268435456
    s_mov_b32 s27, 0x20000
    s_and_b32 s37, s37, 0xffff
    s_mov_b32 s38, 256
    s_mov_b32 s39, 0x20000
    s_and_b32 s33, s33, 0xffff
    s_mov_b32 s34, 1966080
    s_mov_b32 s35, 0x20000
    s_memrealtime s[92:93]
    s_add_u32 s101, s5, s6
    s_and_b32 s101, s101, 7
    s_add_u32 s101, s101, 2
    s_cmp_eq_u32 s3, 5
    s_cselect_b32 s101, s101, 99
    v_mov_b32 v18, 0
    v_mov_b32 v19, 0
    v_mov_b32 v20, 0
    s_waitcnt lgkmcnt(0)
    s_or_b32 s92, s92, 1
    v_mov_b32 v16, s92
    v_mov_b32 v17, s93
    s_barrier
    s_barrier
    s_barrier
    s_cmp_lg_u32 s101, 2
    s_cbranch_scc1 L_na_3
    s_mov_b64 exec, 1
    buffer_atomic_cmpswap_x2 v[16:19], v20, s[36:39], s51 offen sc0 sc1
    s_mov_b64 exec, -1
L_na_3:
    s_barrier
    s_cmp_lg_u32 s101, 3
    s_cbranch_scc1 L_na_4
    s_mov_b64 exec, 1
    buffer_atomic_cmpswap_x2 v[16:19], v20, s[36:39], s51 offen sc0 sc1
    s_mov_b64 exec, -1
L_na_4:
    s_barrier
    s_cmp_lg_u32 s101, 4
    s_cbranch_scc1 L_na_5
    s_mov_b64 exec, 1
    buffer_atomic_cmpswap_x2 v[16:19], v20, s[36:39], s51 offen sc0 sc1
    s_mov_b64 exec, -1
L_na_5:
    s_barrier
    s_cmp_lg_u32 s101, 5
    s_cbranch_scc1 L_na_6
    s_mov_b64 exec, 1
    buffer_atomic_cmpswap_x2 v[16:19], v20, s[36:39], s51 offen sc0 sc1
    s_mov_b64 exec, -1
L_na_6:
    s_barrier
    s_cmp_lg_u32 s101, 6
    s_cbranch_scc1 L_na_7
    s_mov_b64 exec, 1
    buffer_atomic_cmpswap_x2 v[16:19], v20, s[36:39], s51 offen sc0 sc1
    s_mov_b64 exec, -1
L_na_7:
    s_barrier
    s_cmp_lg_u32 s101, 7
    s_cbranch_scc1 L_na_8
    s_mov_b64 exec, 1
    buffer_atomic_cmpswap_x2 v[16:19], v20, s[36:39], s51 offen sc0 sc1
    s_mov_b64 exec, -1
L_na_8:
    s_barrier
    s_cmp_lg_u32 s101, 8
    s_cbranch_scc1 L_na_9
    s_mov_b64 exec, 1
    buffer_atomic_cmpswap_x2 v[16:19], v20, s[36:39], s51 offen sc0 sc1
    s_mov_b64 exec, -1
L_na_9:
    s_barrier
    s_cmp_lg_u32 s101, 9
    s_cbranch_scc1 L_na_10
    s_mov_b64 exec, 1
    buffer_atomic_cmpswap_x2 v[16:19], v20, s[36:39], s51 offen sc0 sc1
    s_mov_b64 exec, -1
L_na_10:
    s_barrier
    s_barrier
    s_barrier
    s_barrier
    s_barrier
    s_barrier
    s_barrier
    s_barrier
    s_barrier
    s_barrier
    s_waitcnt vmcnt(0)
    v_readfirstlane_b32 s46, v16
    v_readfirstlane_b32 s47, v17
    s_or_b32 s48, s46, s47
    s_cmp_lg_u32 s48, 0
    s_cselect_b32 s92, s46, s92
    s_cselect_b32 s93, s47, s93
    s_barrier
    s_barrier
    s_branch L_attn
L_prod:
    s_sub_u32 s46, s3, 6
    s_lshl_b32 s47, s95, 1
    s_add_u32 s47, s47, s6
    s_mul_i32 s47, s47, 5
    s_lshr_b32 s47, s47, 2
    s_sub_u32 s48, s47, 10
    s_cmp_ge_u32 s47, 10
    s_cselect_b32 s47, s48, s47
    s_lshl_b32 s55, s47, 19
    s_lshl_b32 s56, s47, 7
    v_and_b32 v252, 7, v249
    v_xor_b32 v252, v252, v250
    v_lshlrev_b32 v252, 4, v252
    v_lshrrev_b32 v253, 3, v249
    v_mul_u32_u24 v253, 1280, v253
    s_mul_i32 s47, s46, 61440
    v_add_u32 v253, s47, v253
    v_xor_b32 v254, 64, v252
    v_add_u32 v252, v252, v253
    v_add_u32 v254, v254, v253
    v_add_u32 v242, 0, v252
    v_add_u32 v243, 9216, v254
    v_add_u32 v244, 18432, v252
    v_add_u32 v245, 27648, v254
    v_add_u32 v246, 40960, v252
    v_add_u32 v247, 50176, v254
    s_mul_i32 s57, s46, 6144
    s_add_u32 s57, s57, 114688
    s_add_u32 m0, s57, 0
    s_nop 0
    buffer_load_dwordx4 v242, s[20:23], s56 offen offset:0 sc1 lds
    buffer_load_dwordx4 v243, s[20:23], s56 offen offset:1024 sc1 lds
    buffer_load_dwordx4 v244, s[20:23], s56 offen offset:2048 sc1 lds
    buffer_load_dwordx4 v245, s[20:23], s56 offen offset:3072 sc1 lds
    s_add_u32 m0, s57, 4096
    s_nop 0
    buffer_load_dwordx4 v246, s[20:23], s56 offen offset:0 sc1 lds
    buffer_load_dwordx4 v247, s[20:23], s56 offen offset:1024 sc1 lds
    s_add_u32 s56, s56, 128
    s_cmp_eq_u32 s56, 1280
    s_cselect_b32 s56, 0, s56
    v_lshlrev_b32 v252, 1, v250
    v_xor_b32 v252, v252, v251
    v_lshlrev_b32 v252, 4, v252
    v_lshl_add_u32 v252, v250, 13, v252
    s_lshl_b32 s47, s46, 12
    v_add_u32 v238, s47, v252
    v_add_u32 v239, 31744, v238
    v_xor_b32 v252, 0x80, v238
    v_add_u32 v240, 63488, v252
    v_add_u32 v241, 95232, v252
    s_lshl_b32 s52, s46, 13
    s_add_u32 s52, s52, 49152
    s_add_u32 m0, s52, 0
    s_add_u32 s40, s55, 131072
    buffer_load_dwordx4 v238, s[16:19], s55 offen offset:0 sc1 lds
    buffer_load_dwordx4 v239, s[16:19], s55 offen offset:1024 sc1 lds
    buffer_load_dwordx4 v240, s[16:19], s55 offen offset:2048 sc1 lds
    buffer_load_dwordx4 v241, s[16:19], s55 offen offset:3072 sc1 lds
    s_add_u32 m0, s52, 4096
    s_nop 0
    buffer_load_dwordx4 v238, s[16:19], s40 offen offset:0 sc1 lds
    buffer_load_dwordx4 v239, s[16:19], s40 offen offset:1024 sc1 lds
    buffer_load_dwordx4 v240, s[16:19], s40 offen offset:2048 sc1 lds
    buffer_load_dwordx4 v241, s[16:19], s40 offen offset:3072 sc1 lds
    s_add_u32 s55, s55, 262144
    s_cmp_eq_u32 s55, 5242880
    s_cselect_b32 s55, 0, s55
    s_add_u32 m0, s52, 16384
    s_add_u32 s40, s55, 131072
    buffer_load_dwordx4 v238, s[16:19], s55 offen offset:0 sc1 lds
    buffer_load_dwordx4 v239, s[16:19], s55 offen offset:1024 sc1 lds
    buffer_load_dwordx4 v240, s[16:19], s55 offen offset:2048 sc1 lds
    buffer_load_dwordx4 v241, s[16:19], s55 offen offset:3072 sc1 lds
    s_add_u32 m0, s52, 20480
    s_nop 0
    buffer_load_dwordx4 v238, s[16:19], s40 offen offset:0 sc1 lds
    buffer_load_dwordx4 v239, s[16:19], s40 offen offset:1024 sc1 lds
    buffer_load_dwordx4 v240, s[16:19], s40 offen offset:2048 sc1 lds
    buffer_load_dwordx4 v241, s[16:19], s40 offen offset:3072 sc1 lds
    s_add_u32 s55, s55, 262144
    s_cmp_eq_u32 s55, 5242880
    s_cselect_b32 s55, 0, s55
    s_add_u32 m0, s57, 12288
    s_nop 0
    buffer_load_dwordx4 v242, s[20:23], s56 offen offset:0 sc1 lds
    buffer_load_dwordx4 v243, s[20:23], s56 offen offset:1024 sc1 lds
    buffer_load_dwordx4 v244, s[20:23], s56 offen offset:2048 sc1 lds
    buffer_load_dwordx4 v245, s[20:23], s56 offen offset:3072 sc1 lds
    s_add_u32 m0, s57, 16384
    s_nop 0
    buffer_load_dwordx4 v246, s[20:23], s56 offen offset:0 sc1 lds
    buffer_load_dwordx4 v247, s[20:23], s56 offen offset:1024 sc1 lds
    s_add_u32 s56, s56, 128
    s_cmp_eq_u32 s56, 1280
    s_cselect_b32 s56, 0, s56
    s_add_u32 m0, s52, 32768
    s_add_u32 s40, s55, 131072
    buffer_load_dwordx4 v238, s[16:19], s55 offen offset:0 sc1 lds
    buffer_load_dwordx4 v239, s[16:19], s55 offen offset:1024 sc1 lds
    buffer_load_dwordx4 v240, s[16:19], s55 offen offset:2048 sc1 lds
    buffer_load_dwordx4 v241, s[16:19], s55 offen offset:3072 sc1 lds
    s_add_u32 m0, s52, 36864
    s_nop 0
    buffer_load_dwordx4 v238, s[16:19], s40 offen offset:0 sc1 lds
    buffer_load_dwordx4 v239, s[16:19], s40 offen offset:1024 sc1 lds
    buffer_load_dwordx4 v240, s[16:19], s40 offen offset:2048 sc1 lds
    buffer_load_dwordx4 v241, s[16:19], s40 offen offset:3072 sc1 lds
    s_add_u32 s55, s55, 262144
    s_cmp_eq_u32 s55, 5242880
    s_cselect_b32 s55, 0, s55
    s_sub_u32 s46, s3, 6
    v_xor_b32 v252, v250, v251
    v_lshlrev_b32 v252, 4, v252
    v_lshl_add_u32 v252, v250, 8, v252
    s_lshl_b32 s42, s46, 13
    v_add_u32 v227, s42, v252
    v_xor_b32 v228, 64, v227
    v_xor_b32 v229, 0x80, v227
    v_xor_b32 v230, 0xc0, v227
    v_lshlrev_b32 v252, 1, v250
    v_xor_b32 v252, v252, v251
    v_lshlrev_b32 v252, 4, v252
    v_lshl_add_u32 v252, v250, 8, v252
    v_add_u32 v231, s42, v252
    v_xor_b32 v232, 0x80, v231
    v_lshlrev_b32 v224, 4, v249
    v_add_u32 v224, s42, v224
    v_add_u32 v225, 0x10000, v224
    v_add_u32 v226, 0x20000, v224
    s_add_u32 m0, s42, 0
    s_mov_b32 s40, 0
    buffer_load_dwordx4 v227, s[8:11], s40 offen offset:0 nt lds
    buffer_load_dwordx4 v228, s[8:11], s40 offen offset:1024 nt lds
    buffer_load_dwordx4 v229, s[8:11], s40 offen offset:2048 nt lds
    buffer_load_dwordx4 v230, s[8:11], s40 offen offset:3072 nt lds
    s_add_u32 m0, s42, 4096
    s_mov_b32 s40, 4096
    buffer_load_dwordx4 v227, s[8:11], s40 offen offset:0 nt lds
    buffer_load_dwordx4 v228, s[8:11], s40 offen offset:1024 nt lds
    buffer_load_dwordx4 v229, s[8:11], s40 offen offset:2048 nt lds
    buffer_load_dwordx4 v230, s[8:11], s40 offen offset:3072 nt lds
    s_lshl_b32 s96, s4, 3
    s_add_u32 s96, s96, s6
    s_mul_i32 s99, s96, 786432
    s_lshl_b32 s47, s5, 12
    s_add_u32 s50, s99, s47
    s_lshl_b32 s51, s96, 3
    s_add_u32 s51, s51, 128
    s_lshl_b32 s96, s96, 2
    s_add_u32 s96, s96, s95
    s_and_b32 s25, s25, 0xffff
    s_mov_b32 s26, 268435456
    s_mov_b32 s27, 0x20000
    s_and_b32 s37, s37, 0xffff
    s_mov_b32 s38, 256
    s_mov_b32 s39, 0x20000
    s_and_b32 s33, s33, 0xffff
    s_mov_b32 s34, 1966080
    s_mov_b32 s35, 0x20000
    s_and_b32 s29, s29, 0xffff
    s_mov_b32 s30, 5242880
    s_mov_b32 s31, 0x20000
    s_waitcnt vmcnt(30)
    s_barrier
    s_add_u32 m0, s52, 49152
    s_add_u32 s40, s55, 131072
    buffer_load_dwordx4 v238, s[16:19], s55 offen offset:0 sc1 lds
    buffer_load_dwordx4 v239, s[16:19], s55 offen offset:1024 sc1 lds
    buffer_load_dwordx4 v240, s[16:19], s55 offen offset:2048 sc1 lds
    buffer_load_dwordx4 v241, s[16:19], s55 offen offset:3072 sc1 lds
    s_add_u32 m0, s52, 53248
    s_nop 0
    buffer_load_dwordx4 v238, s[16:19], s40 offen offset:0 sc1 lds
    buffer_load_dwordx4 v239, s[16:19], s40 offen offset:1024 sc1 lds
    buffer_load_dwordx4 v240, s[16:19], s40 offen offset:2048 sc1 lds
    buffer_load_dwordx4 v241, s[16:19], s40 offen offset:3072 sc1 lds
    s_add_u32 s55, s55, 262144
    s_cmp_eq_u32 s55, 5242880
    s_cselect_b32 s55, 0, s55
    s_add_u32 m0, s57, 24576
    s_nop 0
    buffer_load_dwordx4 v242, s[20:23], s56 offen offset:0 sc1 lds
    buffer_load_dwordx4 v243, s[20:23], s56 offen offset:1024 sc1 lds
    buffer_load_dwordx4 v244, s[20:23], s56 offen offset:2048 sc1 lds
    buffer_load_dwordx4 v245, s[20:23], s56 offen offset:3072 sc1 lds
    s_add_u32 m0, s57, 28672
    s_nop 0
    buffer_load_dwordx4 v246, s[20:23], s56 offen offset:0 sc1 lds
    buffer_load_dwordx4 v247, s[20:23], s56 offen offset:1024 sc1 lds
    s_add_u32 s56, s56, 128
    s_cmp_eq_u32 s56, 1280
    s_cselect_b32 s56, 0, s56
    s_waitcnt vmcnt(36)
    s_barrier
    s_add_u32 m0, s52, 0
    s_add_u32 s40, s55, 131072
    buffer_load_dwordx4 v238, s[16:19], s55 offen offset:0 sc1 lds
    buffer_load_dwordx4 v239, s[16:19], s55 offen offset:1024 sc1 lds
    buffer_load_dwordx4 v240, s[16:19], s55 offen offset:2048 sc1 lds
    buffer_load_dwordx4 v241, s[16:19], s55 offen offset:3072 sc1 lds
    s_add_u32 m0, s52, 4096
    s_nop 0
    buffer_load_dwordx4 v238, s[16:19], s40 offen offset:0 sc1 lds
    buffer_load_dwordx4 v239, s[16:19], s40 offen offset:1024 sc1 lds
    buffer_load_dwordx4 v240, s[16:19], s40 offen offset:2048 sc1 lds
    buffer_load_dwordx4 v241, s[16:19], s40 offen offset:3072 sc1 lds
    s_add_u32 s55, s55, 262144
    s_cmp_eq_u32 s55, 5242880
    s_cselect_b32 s55, 0, s55
    s_add_u32 m0, s42, 16384
    s_mov_b32 s40, 16384
    buffer_load_dwordx4 v227, s[8:11], s40 offen offset:0 nt lds
    buffer_load_dwordx4 v228, s[8:11], s40 offen offset:1024 nt lds
    buffer_load_dwordx4 v229, s[8:11], s40 offen offset:2048 nt lds
    buffer_load_dwordx4 v230, s[8:11], s40 offen offset:3072 nt lds
    s_add_u32 m0, s42, 20480
    s_mov_b32 s40, 20480
    buffer_load_dwordx4 v227, s[8:11], s40 offen offset:0 nt lds
    buffer_load_dwordx4 v228, s[8:11], s40 offen offset:1024 nt lds
    buffer_load_dwordx4 v229, s[8:11], s40 offen offset:2048 nt lds
    buffer_load_dwordx4 v230, s[8:11], s40 offen offset:3072 nt lds
    s_waitcnt vmcnt(38)
    s_barrier
    s_add_u32 m0, s52, 16384
    s_add_u32 s40, s55, 131072
    buffer_load_dwordx4 v238, s[16:19], s55 offen offset:0 sc1 lds
    buffer_load_dwordx4 v239, s[16:19], s55 offen offset:1024 sc1 lds
    buffer_load_dwordx4 v240, s[16:19], s55 offen offset:2048 sc1 lds
    buffer_load_dwordx4 v241, s[16:19], s55 offen offset:3072 sc1 lds
    s_add_u32 m0, s52, 20480
    s_nop 0
    buffer_load_dwordx4 v238, s[16:19], s40 offen offset:0 sc1 lds
    buffer_load_dwordx4 v239, s[16:19], s40 offen offset:1024 sc1 lds
    buffer_load_dwordx4 v240, s[16:19], s40 offen offset:2048 sc1 lds
    buffer_load_dwordx4 v241, s[16:19], s40 offen offset:3072 sc1 lds
    s_add_u32 s55, s55, 262144
    s_cmp_eq_u32 s55, 5242880
    s_cselect_b32 s55, 0, s55
    s_add_u32 m0, s57, 0
    s_nop 0
    buffer_load_dwordx4 v242, s[20:23], s56 offen offset:0 sc1 lds
    buffer_load_dwordx4 v243, s[20:23], s56 offen offset:1024 sc1 lds
    buffer_load_dwordx4 v244, s[20:23], s56 offen offset:2048 sc1 lds
    buffer_load_dwordx4 v245, s[20:23], s56 offen offset:3072 sc1 lds
    s_add_u32 m0, s57, 4096
    s_nop 0
    buffer_load_dwordx4 v246, s[20:23], s56 offen offset:0 sc1 lds
    buffer_load_dwordx4 v247, s[20:23], s56 offen offset:1024 sc1 lds
    s_add_u32 s56, s56, 128
    s_cmp_eq_u32 s56, 1280
    s_cselect_b32 s56, 0, s56
    s_waitcnt vmcnt(36)
    s_barrier
    s_add_u32 m0, s52, 32768
    s_add_u32 s40, s55, 131072
    buffer_load_dwordx4 v238, s[16:19], s55 offen offset:0 sc1 lds
    buffer_load_dwordx4 v239, s[16:19], s55 offen offset:1024 sc1 lds
    buffer_load_dwordx4 v240, s[16:19], s55 offen offset:2048 sc1 lds
    buffer_load_dwordx4 v241, s[16:19], s55 offen offset:3072 sc1 lds
    s_add_u32 m0, s52, 36864
    s_nop 0
    buffer_load_dwordx4 v238, s[16:19], s40 offen offset:0 sc1 lds
    buffer_load_dwordx4 v239, s[16:19], s40 offen offset:1024 sc1 lds
    buffer_load_dwordx4 v240, s[16:19], s40 offen offset:2048 sc1 lds
    buffer_load_dwordx4 v241, s[16:19], s40 offen offset:3072 sc1 lds
    s_add_u32 s55, s55, 262144
    s_cmp_eq_u32 s55, 5242880
    s_cselect_b32 s55, 0, s55
    s_waitcnt vmcnt(30)
    s_barrier
    s_add_u32 m0, s52, 49152
    s_add_u32 s40, s55, 131072
    buffer_load_dwordx4 v238, s[16:19], s55 offen offset:0 sc1 lds
    buffer_load_dwordx4 v239, s[16:19], s55 offen offset:1024 sc1 lds
    buffer_load_dwordx4 v240, s[16:19], s55 offen offset:2048 sc1 lds
    buffer_load_dwordx4 v241, s[16:19], s55 offen offset:3072 sc1 lds
    s_add_u32 m0, s52, 53248
    s_nop 0
    buffer_load_dwordx4 v238, s[16:19], s40 offen offset:0 sc1 lds
    buffer_load_dwordx4 v239, s[16:19], s40 offen offset:1024 sc1 lds
    buffer_load_dwordx4 v240, s[16:19], s40 offen offset:2048 sc1 lds
    buffer_load_dwordx4 v241, s[16:19], s40 offen offset:3072 sc1 lds
    s_add_u32 s55, s55, 262144
    s_cmp_eq_u32 s55, 5242880
    s_cselect_b32 s55, 0, s55
    s_add_u32 m0, s57, 12288
    s_nop 0
    buffer_load_dwordx4 v242, s[20:23], s56 offen offset:0 sc1 lds
    buffer_load_dwordx4 v243, s[20:23], s56 offen offset:1024 sc1 lds
    buffer_load_dwordx4 v244, s[20:23], s56 offen offset:2048 sc1 lds
    buffer_load_dwordx4 v245, s[20:23], s56 offen offset:3072 sc1 lds
    s_add_u32 m0, s57, 16384
    s_nop 0
    buffer_load_dwordx4 v246, s[20:23], s56 offen offset:0 sc1 lds
    buffer_load_dwordx4 v247, s[20:23], s56 offen offset:1024 sc1 lds
    s_add_u32 s56, s56, 128
    s_cmp_eq_u32 s56, 1280
    s_cselect_b32 s56, 0, s56
    s_add_u32 m0, s42, 32768
    s_mov_b32 s40, 32768
    buffer_load_dwordx4 v227, s[8:11], s40 offen offset:0 nt lds
    buffer_load_dwordx4 v228, s[8:11], s40 offen offset:1024 nt lds
    buffer_load_dwordx4 v229, s[8:11], s40 offen offset:2048 nt lds
    buffer_load_dwordx4 v230, s[8:11], s40 offen offset:3072 nt lds
    s_add_u32 m0, s42, 36864
    s_mov_b32 s40, 36864
    buffer_load_dwordx4 v227, s[8:11], s40 offen offset:0 nt lds
    buffer_load_dwordx4 v228, s[8:11], s40 offen offset:1024 nt lds
    buffer_load_dwordx4 v229, s[8:11], s40 offen offset:2048 nt lds
    buffer_load_dwordx4 v230, s[8:11], s40 offen offset:3072 nt lds
    s_waitcnt vmcnt(36)
    s_barrier
    s_add_u32 m0, s52, 0
    s_add_u32 s40, s55, 131072
    buffer_load_dwordx4 v238, s[16:19], s55 offen offset:0 sc1 lds
    buffer_load_dwordx4 v239, s[16:19], s55 offen offset:1024 sc1 lds
    buffer_load_dwordx4 v240, s[16:19], s55 offen offset:2048 sc1 lds
    buffer_load_dwordx4 v241, s[16:19], s55 offen offset:3072 sc1 lds
    s_add_u32 m0, s52, 4096
    s_nop 0
    buffer_load_dwordx4 v238, s[16:19], s40 offen offset:0 sc1 lds
    buffer_load_dwordx4 v239, s[16:19], s40 offen offset:1024 sc1 lds
    buffer_load_dwordx4 v240, s[16:19], s40 offen offset:2048 sc1 lds
    buffer_load_dwordx4 v241, s[16:19], s40 offen offset:3072 sc1 lds
    s_add_u32 s55, s55, 262144
    s_cmp_eq_u32 s55, 5242880
    s_cselect_b32 s55, 0, s55
    s_waitcnt vmcnt(30)
    s_barrier
    s_add_u32 m0, s52, 16384
    s_add_u32 s40, s55, 131072
    buffer_load_dwordx4 v238, s[16:19], s55 offen offset:0 sc1 lds
    buffer_load_dwordx4 v239, s[16:19], s55 offen offset:1024 sc1 lds
    buffer_load_dwordx4 v240, s[16:19], s55 offen offset:2048 sc1 lds
    buffer_load_dwordx4 v241, s[16:19], s55 offen offset:3072 sc1 lds
    s_add_u32 m0, s52, 20480
    s_nop 0
    buffer_load_dwordx4 v238, s[16:19], s40 offen offset:0 sc1 lds
    buffer_load_dwordx4 v239, s[16:19], s40 offen offset:1024 sc1 lds
    buffer_load_dwordx4 v240, s[16:19], s40 offen offset:2048 sc1 lds
    buffer_load_dwordx4 v241, s[16:19], s40 offen offset:3072 sc1 lds
    s_add_u32 s55, s55, 262144
    s_cmp_eq_u32 s55, 5242880
    s_cselect_b32 s55, 0, s55
    s_add_u32 m0, s57, 24576
    s_nop 0
    buffer_load_dwordx4 v242, s[20:23], s56 offen offset:0 sc1 lds
    buffer_load_dwordx4 v243, s[20:23], s56 offen offset:1024 sc1 lds
    buffer_load_dwordx4 v244, s[20:23], s56 offen offset:2048 sc1 lds
    buffer_load_dwordx4 v245, s[20:23], s56 offen offset:3072 sc1 lds
    s_add_u32 m0, s57, 28672
    s_nop 0
    buffer_load_dwordx4 v246, s[20:23], s56 offen offset:0 sc1 lds
    buffer_load_dwordx4 v247, s[20:23], s56 offen offset:1024 sc1 lds
    s_add_u32 s56, s56, 128
    s_cmp_eq_u32 s56, 1280
    s_cselect_b32 s56, 0, s56
    s_waitcnt vmcnt(36)
    s_barrier
    s_add_u32 m0, s52, 32768
    s_add_u32 s40, s55, 131072
    buffer_load_dwordx4 v238, s[16:19], s55 offen offset:0 sc1 lds
    buffer_load_dwordx4 v239, s[16:19], s55 offen offset:1024 sc1 lds
    buffer_load_dwordx4 v240, s[16:19], s55 offen offset:2048 sc1 lds
    buffer_load_dwordx4 v241, s[16:19], s55 offen offset:3072 sc1 lds
    s_add_u32 m0, s52, 36864
    s_nop 0
    buffer_load_dwordx4 v238, s[16:19], s40 offen offset:0 sc1 lds
    buffer_load_dwordx4 v239, s[16:19], s40 offen offset:1024 sc1 lds
    buffer_load_dwordx4 v240, s[16:19], s40 offen offset:2048 sc1 lds
    buffer_load_dwordx4 v241, s[16:19], s40 offen offset:3072 sc1 lds
    s_add_u32 s55, s55, 262144
    s_cmp_eq_u32 s55, 5242880
    s_cselect_b32 s55, 0, s55
    s_mov_b32 s40, 49152
    buffer_load_dwordx4 v[0:3], v227, s[8:11], s40 offen offset:0 nt
    buffer_load_dwordx4 v[4:7], v228, s[8:11], s40 offen offset:1024 nt
    buffer_load_dwordx4 v[8:11], v229, s[8:11], s40 offen offset:2048 nt
    buffer_load_dwordx4 v[12:15], v230, s[8:11], s40 offen offset:3072 nt
    s_mov_b32 s40, 53248
    buffer_load_dwordx4 v[16:19], v227, s[8:11], s40 offen offset:0 nt
    buffer_load_dwordx4 v[20:23], v228, s[8:11], s40 offen offset:1024 nt
    buffer_load_dwordx4 v[24:27], v229, s[8:11], s40 offen offset:2048 nt
    buffer_load_dwordx4 v[28:31], v230, s[8:11], s40 offen offset:3072 nt
    s_waitcnt vmcnt(30)
    s_barrier
    s_add_u32 m0, s52, 49152
    s_add_u32 s40, s55, 131072
    buffer_load_dwordx4 v238, s[16:19], s55 offen offset:0 sc1 lds
    buffer_load_dwordx4 v239, s[16:19], s55 offen offset:1024 sc1 lds
    buffer_load_dwordx4 v240, s[16:19], s55 offen offset:2048 sc1 lds
    buffer_load_dwordx4 v241, s[16:19], s55 offen offset:3072 sc1 lds
    s_add_u32 m0, s52, 53248
    s_nop 0
    buffer_load_dwordx4 v238, s[16:19], s40 offen offset:0 sc1 lds
    buffer_load_dwordx4 v239, s[16:19], s40 offen offset:1024 sc1 lds
    buffer_load_dwordx4 v240, s[16:19], s40 offen offset:2048 sc1 lds
    buffer_load_dwordx4 v241, s[16:19], s40 offen offset:3072 sc1 lds
    s_add_u32 s55, s55, 262144
    s_cmp_eq_u32 s55, 5242880
    s_cselect_b32 s55, 0, s55
    s_add_u32 m0, s57, 0
    s_nop 0
    buffer_load_dwordx4 v242, s[20:23], s56 offen offset:0 sc1 lds
    buffer_load_dwordx4 v243, s[20:23], s56 offen offset:1024 sc1 lds
    buffer_load_dwordx4 v244, s[20:23], s56 offen offset:2048 sc1 lds
    buffer_load_dwordx4 v245, s[20:23], s56 offen offset:3072 sc1 lds
    s_add_u32 m0, s57, 4096
    s_nop 0
    buffer_load_dwordx4 v246, s[20:23], s56 offen offset:0 sc1 lds
    buffer_load_dwordx4 v247, s[20:23], s56 offen offset:1024 sc1 lds
    s_add_u32 s56, s56, 128
    s_cmp_eq_u32 s56, 1280
    s_cselect_b32 s56, 0, s56
    s_waitcnt vmcnt(36)
    s_barrier
    s_add_u32 m0, s52, 0
    s_add_u32 s40, s55, 131072
    buffer_load_dwordx4 v238, s[16:19], s55 offen offset:0 sc1 lds
    buffer_load_dwordx4 v239, s[16:19], s55 offen offset:1024 sc1 lds
    buffer_load_dwordx4 v240, s[16:19], s55 offen offset:2048 sc1 lds
    buffer_load_dwordx4 v241, s[16:19], s55 offen offset:3072 sc1 lds
    s_add_u32 m0, s52, 4096
    s_nop 0
    buffer_load_dwordx4 v238, s[16:19], s40 offen offset:0 sc1 lds
    buffer_load_dwordx4 v239, s[16:19], s40 offen offset:1024 sc1 lds
    buffer_load_dwordx4 v240, s[16:19], s40 offen offset:2048 sc1 lds
    buffer_load_dwordx4 v241, s[16:19], s40 offen offset:3072 sc1 lds
    s_add_u32 s55, s55, 262144
    s_cmp_eq_u32 s55, 5242880
    s_cselect_b32 s55, 0, s55
    s_waitcnt vmcnt(30)
    s_barrier
    s_add_u32 m0, s52, 16384
    s_add_u32 s40, s55, 131072
    buffer_load_dwordx4 v238, s[16:19], s55 offen offset:0 sc1 lds
    buffer_load_dwordx4 v239, s[16:19], s55 offen offset:1024 sc1 lds
    buffer_load_dwordx4 v240, s[16:19], s55 offen offset:2048 sc1 lds
    buffer_load_dwordx4 v241, s[16:19], s55 offen offset:3072 sc1 lds
    s_add_u32 m0, s52, 20480
    s_nop 0
    buffer_load_dwordx4 v238, s[16:19], s40 offen offset:0 sc1 lds
    buffer_load_dwordx4 v239, s[16:19], s40 offen offset:1024 sc1 lds
    buffer_load_dwordx4 v240, s[16:19], s40 offen offset:2048 sc1 lds
    buffer_load_dwordx4 v241, s[16:19], s40 offen offset:3072 sc1 lds
    s_add_u32 s55, s55, 262144
    s_cmp_eq_u32 s55, 5242880
    s_cselect_b32 s55, 0, s55
    s_add_u32 m0, s57, 12288
    s_nop 0
    buffer_load_dwordx4 v242, s[20:23], s56 offen offset:0 sc1 lds
    buffer_load_dwordx4 v243, s[20:23], s56 offen offset:1024 sc1 lds
    buffer_load_dwordx4 v244, s[20:23], s56 offen offset:2048 sc1 lds
    buffer_load_dwordx4 v245, s[20:23], s56 offen offset:3072 sc1 lds
    s_add_u32 m0, s57, 16384
    s_nop 0
    buffer_load_dwordx4 v246, s[20:23], s56 offen offset:0 sc1 lds
    buffer_load_dwordx4 v247, s[20:23], s56 offen offset:1024 sc1 lds
    s_add_u32 s56, s56, 128
    s_cmp_eq_u32 s56, 1280
    s_cselect_b32 s56, 0, s56
    s_mov_b32 s40, 65536
    buffer_load_dwordx4 v[32:35], v227, s[8:11], s40 offen offset:0 nt
    buffer_load_dwordx4 v[36:39], v228, s[8:11], s40 offen offset:1024 nt
    buffer_load_dwordx4 v[40:43], v229, s[8:11], s40 offen offset:2048 nt
    buffer_load_dwordx4 v[44:47], v230, s[8:11], s40 offen offset:3072 nt
    s_mov_b32 s40, 69632
    buffer_load_dwordx4 v[48:51], v227, s[8:11], s40 offen offset:0 nt
    buffer_load_dwordx4 v[52:55], v228, s[8:11], s40 offen offset:1024 nt
    buffer_load_dwordx4 v[56:59], v229, s[8:11], s40 offen offset:2048 nt
    buffer_load_dwordx4 v[60:63], v230, s[8:11], s40 offen offset:3072 nt
    s_waitcnt vmcnt(36)
    s_barrier
    s_add_u32 m0, s52, 32768
    s_add_u32 s40, s55, 131072
    buffer_load_dwordx4 v238, s[16:19], s55 offen offset:0 sc1 lds
    buffer_load_dwordx4 v239, s[16:19], s55 offen offset:1024 sc1 lds
    buffer_load_dwordx4 v240, s[16:19], s55 offen offset:2048 sc1 lds
    buffer_load_dwordx4 v241, s[16:19], s55 offen offset:3072 sc1 lds
    s_add_u32 m0, s52, 36864
    s_nop 0
    buffer_load_dwordx4 v238, s[16:19], s40 offen offset:0 sc1 lds
    buffer_load_dwordx4 v239, s[16:19], s40 offen offset:1024 sc1 lds
    buffer_load_dwordx4 v240, s[16:19], s40 offen offset:2048 sc1 lds
    buffer_load_dwordx4 v241, s[16:19], s40 offen offset:3072 sc1 lds
    s_add_u32 s55, s55, 262144
    s_cmp_eq_u32 s55, 5242880
    s_cselect_b32 s55, 0, s55
    s_waitcnt vmcnt(30)
    s_barrier
    s_add_u32 m0, s52, 49152
    s_add_u32 s40, s55, 131072
    buffer_load_dwordx4 v238, s[16:19], s55 offen offset:0 sc1 lds
    buffer_load_dwordx4 v239, s[16:19], s55 offen offset:1024 sc1 lds
    buffer_load_dwordx4 v240, s[16:19], s55 offen offset:2048 sc1 lds
    buffer_load_dwordx4 v241, s[16:19], s55 offen offset:3072 sc1 lds
    s_add_u32 m0, s52, 53248
    s_nop 0
    buffer_load_dwordx4 v238, s[16:19], s40 offen offset:0 sc1 lds
    buffer_load_dwordx4 v239, s[16:19], s40 offen offset:1024 sc1 lds
    buffer_load_dwordx4 v240, s[16:19], s40 offen offset:2048 sc1 lds
    buffer_load_dwordx4 v241, s[16:19], s40 offen offset:3072 sc1 lds
    s_add_u32 s55, s55, 262144
    s_cmp_eq_u32 s55, 5242880
    s_cselect_b32 s55, 0, s55
    s_add_u32 m0, s57, 24576
    s_nop 0
    buffer_load_dwordx4 v242, s[20:23], s56 offen offset:0 sc1 lds
    buffer_load_dwordx4 v243, s[20:23], s56 offen offset:1024 sc1 lds
    buffer_load_dwordx4 v244, s[20:23], s56 offen offset:2048 sc1 lds
    buffer_load_dwordx4 v245, s[20:23], s56 offen offset:3072 sc1 lds
    s_add_u32 m0, s57, 28672
    s_nop 0
    buffer_load_dwordx4 v246, s[20:23], s56 offen offset:0 sc1 lds
    buffer_load_dwordx4 v247, s[20:23], s56 offen offset:1024 sc1 lds
    s_add_u32 s56, s56, 128
    s_cmp_eq_u32 s56, 1280
    s_cselect_b32 s56, 0, s56
    s_mov_b32 s40, 81920
    buffer_load_dwordx4 v[64:67], v227, s[8:11], s40 offen offset:0 nt
    buffer_load_dwordx4 v[68:71], v228, s[8:11], s40 offen offset:1024 nt
    buffer_load_dwordx4 v[72:75], v229, s[8:11], s40 offen offset:2048 nt
    buffer_load_dwordx4 v[76:79], v230, s[8:11], s40 offen offset:3072 nt
    s_mov_b32 s40, 86016
    buffer_load_dwordx4 v[80:83], v227, s[8:11], s40 offen offset:0 nt
    buffer_load_dwordx4 v[84:87], v228, s[8:11], s40 offen offset:1024 nt
    buffer_load_dwordx4 v[88:91], v229, s[8:11], s40 offen offset:2048 nt
    buffer_load_dwordx4 v[92:95], v230, s[8:11], s40 offen offset:3072 nt
    s_waitcnt vmcnt(44)
    s_barrier
    s_add_u32 m0, s52, 0
    s_add_u32 s40, s55, 131072
    buffer_load_dwordx4 v238, s[16:19], s55 offen offset:0 sc1 lds
    buffer_load_dwordx4 v239, s[16:19], s55 offen offset:1024 sc1 lds
    buffer_load_dwordx4 v240, s[16:19], s55 offen offset:2048 sc1 lds
    buffer_load_dwordx4 v241, s[16:19], s55 offen offset:3072 sc1 lds
    s_add_u32 m0, s52, 4096
    s_nop 0
    buffer_load_dwordx4 v238, s[16:19], s40 offen offset:0 sc1 lds
    buffer_load_dwordx4 v239, s[16:19], s40 offen offset:1024 sc1 lds
    buffer_load_dwordx4 v240, s[16:19], s40 offen offset:2048 sc1 lds
    buffer_load_dwordx4 v241, s[16:19], s40 offen offset:3072 sc1 lds
    s_add_u32 s55, s55, 262144
    s_cmp_eq_u32 s55, 5242880
    s_cselect_b32 s55, 0, s55
    s_waitcnt vmcnt(30)
    s_barrier
    s_add_u32 m0, s52, 16384
    s_add_u32 s40, s55, 131072
    buffer_load_dwordx4 v238, s[16:19], s55 offen offset:0 sc1 lds
    buffer_load_dwordx4 v239, s[16:19], s55 offen offset:1024 sc1 lds
    buffer_load_dwordx4 v240, s[16:19], s55 offen offset:2048 sc1 lds
    buffer_load_dwordx4 v241, s[16:19], s55 offen offset:3072 sc1 lds
    s_add_u32 m0, s52, 20480
    s_nop 0
    buffer_load_dwordx4 v238, s[16:19], s40 offen offset:0 sc1 lds
    buffer_load_dwordx4 v239, s[16:19], s40 offen offset:1024 sc1 lds
    buffer_load_dwordx4 v240, s[16:19], s40 offen offset:2048 sc1 lds
    buffer_load_dwordx4 v241, s[16:19], s40 offen offset:3072 sc1 lds
    s_add_u32 s55, s55, 262144
    s_cmp_eq_u32 s55, 5242880
    s_cselect_b32 s55, 0, s55
    s_add_u32 m0, s57, 0
    s_nop 0
    buffer_load_dwordx4 v242, s[20:23], s56 offen offset:0 sc1 lds
    buffer_load_dwordx4 v243, s[20:23], s56 offen offset:1024 sc1 lds
    buffer_load_dwordx4 v244, s[20:23], s56 offen offset:2048 sc1 lds
    buffer_load_dwordx4 v245, s[20:23], s56 offen offset:3072 sc1 lds
    s_add_u32 m0, s57, 4096
    s_nop 0
    buffer_load_dwordx4 v246, s[20:23], s56 offen offset:0 sc1 lds
    buffer_load_dwordx4 v247, s[20:23], s56 offen offset:1024 sc1 lds
    s_add_u32 s56, s56, 128
    s_cmp_eq_u32 s56, 1280
    s_cselect_b32 s56, 0, s56
    s_mov_b32 s40, 98304
    buffer_load_dwordx4 v[96:99], v227, s[8:11], s40 offen offset:0 nt
    buffer_load_dwordx4 v[100:103], v228, s[8:11], s40 offen offset:1024 nt
    buffer_load_dwordx4 v[104:107], v229, s[8:11], s40 offen offset:2048 nt
    buffer_load_dwordx4 v[108:111], v230, s[8:11], s40 offen offset:3072 nt
    s_mov_b32 s40, 102400
    buffer_load_dwordx4 v[112:115], v227, s[8:11], s40 offen offset:0 nt
    buffer_load_dwordx4 v[116:119], v228, s[8:11], s40 offen offset:1024 nt
    buffer_load_dwordx4 v[120:123], v229, s[8:11], s40 offen offset:2048 nt
    buffer_load_dwordx4 v[124:127], v230, s[8:11], s40 offen offset:3072 nt
    s_waitcnt vmcnt(44)
    s_barrier
    s_add_u32 m0, s52, 32768
    s_add_u32 s40, s55, 131072
    buffer_load_dwordx4 v238, s[16:19], s55 offen offset:0 sc1 lds
    buffer_load_dwordx4 v239, s[16:19], s55 offen offset:1024 sc1 lds
    buffer_load_dwordx4 v240, s[16:19], s55 offen offset:2048 sc1 lds
    buffer_load_dwordx4 v241, s[16:19], s55 offen offset:3072 sc1 lds
    s_add_u32 m0, s52, 36864
    s_nop 0
    buffer_load_dwordx4 v238, s[16:19], s40 offen offset:0 sc1 lds
    buffer_load_dwordx4 v239, s[16:19], s40 offen offset:1024 sc1 lds
    buffer_load_dwordx4 v240, s[16:19], s40 offen offset:2048 sc1 lds
    buffer_load_dwordx4 v241, s[16:19], s40 offen offset:3072 sc1 lds
    s_add_u32 s55, s55, 262144
    s_cmp_eq_u32 s55, 5242880
    s_cselect_b32 s55, 0, s55
    s_waitcnt vmcnt(30)
    s_barrier
    s_add_u32 m0, s52, 49152
    s_add_u32 s40, s55, 131072
    buffer_load_dwordx4 v238, s[16:19], s55 offen offset:0 sc1 lds
    buffer_load_dwordx4 v239, s[16:19], s55 offen offset:1024 sc1 lds
    buffer_load_dwordx4 v240, s[16:19], s55 offen offset:2048 sc1 lds
    buffer_load_dwordx4 v241, s[16:19], s55 offen offset:3072 sc1 lds
    s_add_u32 m0, s52, 53248
    s_nop 0
    buffer_load_dwordx4 v238, s[16:19], s40 offen offset:0 sc1 lds
    buffer_load_dwordx4 v239, s[16:19], s40 offen offset:1024 sc1 lds
    buffer_load_dwordx4 v240, s[16:19], s40 offen offset:2048 sc1 lds
    buffer_load_dwordx4 v241, s[16:19], s40 offen offset:3072 sc1 lds
    s_add_u32 s55, s55, 262144
    s_cmp_eq_u32 s55, 5242880
    s_cselect_b32 s55, 0, s55
    s_mov_b32 s40, 114688
    buffer_load_dwordx4 v[128:131], v227, s[8:11], s40 offen offset:0 nt
    buffer_load_dwordx4 v[132:135], v228, s[8:11], s40 offen offset:1024 nt
    buffer_load_dwordx4 v[136:139], v229, s[8:11], s40 offen offset:2048 nt
    buffer_load_dwordx4 v[140:143], v230, s[8:11], s40 offen offset:3072 nt
    s_mov_b32 s40, 118784
    buffer_load_dwordx4 v[144:147], v227, s[8:11], s40 offen offset:0 nt
    buffer_load_dwordx4 v[148:151], v228, s[8:11], s40 offen offset:1024 nt
    buffer_load_dwordx4 v[152:155], v229, s[8:11], s40 offen offset:2048 nt
    buffer_load_dwordx4 v[156:159], v230, s[8:11], s40 offen offset:3072 nt
    s_waitcnt vmcnt(38)
    s_barrier
    s_mov_b32 s40, 0
    buffer_load_dwordx4 v[160:163], v231, s[12:15], s40 offen offset:0 nt
    buffer_load_dwordx4 v[164:167], v232, s[12:15], s40 offen offset:1024 nt
    buffer_load_dwordx4 v[168:171], v231, s[12:15], s40 offen offset:2048 nt
    buffer_load_dwordx4 v[172:175], v232, s[12:15], s40 offen offset:3072 nt
    s_mov_b32 s40, 4096
    buffer_load_dwordx4 v[176:179], v231, s[12:15], s40 offen offset:0 nt
    buffer_load_dwordx4 v[180:183], v232, s[12:15], s40 offen offset:1024 nt
    buffer_load_dwordx4 v[184:187], v231, s[12:15], s40 offen offset:2048 nt
    buffer_load_dwordx4 v[188:191], v232, s[12:15], s40 offen offset:3072 nt
    s_waitcnt vmcnt(24)
    s_barrier
    s_mov_b32 s40, 16384
    buffer_load_dwordx4 v[192:195], v231, s[12:15], s40 offen offset:0 nt
    buffer_load_dwordx4 v[196:199], v232, s[12:15], s40 offen offset:1024 nt
    buffer_load_dwordx4 v[200:203], v231, s[12:15], s40 offen offset:2048 nt
    buffer_load_dwordx4 v[204:207], v232, s[12:15], s40 offen offset:3072 nt
    s_mov_b32 s40, 20480
    buffer_load_dwordx4 v[208:211], v231, s[12:15], s40 offen offset:0 nt
    buffer_load_dwordx4 v[212:215], v232, s[12:15], s40 offen offset:1024 nt
    buffer_load_dwordx4 v[216:219], v231, s[12:15], s40 offen offset:2048 nt
    buffer_load_dwordx4 v[220:223], v232, s[12:15], s40 offen offset:3072 nt
    s_waitcnt vmcnt(24)
    s_barrier
    s_barrier
    ds_write_b128 v224, v[0:3] offset:49152
    ds_write_b128 v224, v[4:7] offset:50176
    ds_write_b128 v224, v[8:11] offset:51200
    ds_write_b128 v224, v[12:15] offset:52224
    ds_write_b128 v224, v[16:19] offset:53248
    ds_write_b128 v224, v[20:23] offset:54272
    ds_write_b128 v224, v[24:27] offset:55296
    ds_write_b128 v224, v[28:31] offset:56320
    s_add_u32 m0, s42, 65536
    s_mov_b32 s40, 32768
    buffer_load_dwordx4 v231, s[12:15], s40 offen offset:0 nt lds
    buffer_load_dwordx4 v232, s[12:15], s40 offen offset:1024 nt lds
    buffer_load_dwordx4 v231, s[12:15], s40 offen offset:2048 nt lds
    buffer_load_dwordx4 v232, s[12:15], s40 offen offset:3072 nt lds
    s_add_u32 m0, s42, 69632
    s_mov_b32 s40, 36864
    buffer_load_dwordx4 v231, s[12:15], s40 offen offset:0 nt lds
    buffer_load_dwordx4 v232, s[12:15], s40 offen offset:1024 nt lds
    buffer_load_dwordx4 v231, s[12:15], s40 offen offset:2048 nt lds
    buffer_load_dwordx4 v232, s[12:15], s40 offen offset:3072 nt lds
    s_barrier
    s_waitcnt lgkmcnt(0)
    s_barrier
    s_add_u32 m0, s42, 81920
    s_mov_b32 s40, 49152
    buffer_load_dwordx4 v231, s[12:15], s40 offen offset:0 nt lds
    buffer_load_dwordx4 v232, s[12:15], s40 offen offset:1024 nt lds
    buffer_load_dwordx4 v231, s[12:15], s40 offen offset:2048 nt lds
    buffer_load_dwordx4 v232, s[12:15], s40 offen offset:3072 nt lds
    s_add_u32 m0, s42, 86016
    s_mov_b32 s40, 53248
    buffer_load_dwordx4 v231, s[12:15], s40 offen offset:0 nt lds
    buffer_load_dwordx4 v232, s[12:15], s40 offen offset:1024 nt lds
    buffer_load_dwordx4 v231, s[12:15], s40 offen offset:2048 nt lds
    buffer_load_dwordx4 v232, s[12:15], s40 offen offset:3072 nt lds
    s_waitcnt lgkmcnt(0)
    s_barrier
    s_waitcnt lgkmcnt(0)
    s_barrier
    s_add_u32 m0, s42, 98304
    s_mov_b32 s40, 65536
    buffer_load_dwordx4 v231, s[12:15], s40 offen offset:0 nt lds
    buffer_load_dwordx4 v232, s[12:15], s40 offen offset:1024 nt lds
    buffer_load_dwordx4 v231, s[12:15], s40 offen offset:2048 nt lds
    buffer_load_dwordx4 v232, s[12:15], s40 offen offset:3072 nt lds
    s_add_u32 m0, s42, 102400
    s_mov_b32 s40, 69632
    buffer_load_dwordx4 v231, s[12:15], s40 offen offset:0 nt lds
    buffer_load_dwordx4 v232, s[12:15], s40 offen offset:1024 nt lds
    buffer_load_dwordx4 v231, s[12:15], s40 offen offset:2048 nt lds
    buffer_load_dwordx4 v232, s[12:15], s40 offen offset:3072 nt lds
    ds_write_b128 v224, v[32:35] offset:0
    ds_write_b128 v224, v[36:39] offset:1024
    ds_write_b128 v224, v[40:43] offset:2048
    ds_write_b128 v224, v[44:47] offset:3072
    ds_write_b128 v224, v[48:51] offset:4096
    ds_write_b128 v224, v[52:55] offset:5120
    ds_write_b128 v224, v[56:59] offset:6144
    ds_write_b128 v224, v[60:63] offset:7168
    s_waitcnt lgkmcnt(0)
    s_barrier
    s_add_u32 m0, s42, 114688
    s_mov_b32 s40, 81920
    buffer_load_dwordx4 v231, s[12:15], s40 offen offset:0 nt lds
    buffer_load_dwordx4 v232, s[12:15], s40 offen offset:1024 nt lds
    buffer_load_dwordx4 v231, s[12:15], s40 offen offset:2048 nt lds
    buffer_load_dwordx4 v232, s[12:15], s40 offen offset:3072 nt lds
    s_add_u32 m0, s42, 118784
    s_mov_b32 s40, 86016
    buffer_load_dwordx4 v231, s[12:15], s40 offen offset:0 nt lds
    buffer_load_dwordx4 v232, s[12:15], s40 offen offset:1024 nt lds
    buffer_load_dwordx4 v231, s[12:15], s40 offen offset:2048 nt lds
    buffer_load_dwordx4 v232, s[12:15], s40 offen offset:3072 nt lds
    ds_write_b128 v224, v[64:67] offset:16384
    ds_write_b128 v224, v[68:71] offset:17408
    ds_write_b128 v224, v[72:75] offset:18432
    ds_write_b128 v224, v[76:79] offset:19456
    ds_write_b128 v224, v[80:83] offset:20480
    ds_write_b128 v224, v[84:87] offset:21504
    ds_write_b128 v224, v[88:91] offset:22528
    ds_write_b128 v224, v[92:95] offset:23552
    s_waitcnt lgkmcnt(0)
    s_barrier
    ds_write_b128 v224, v[96:99] offset:32768
    ds_write_b128 v224, v[100:103] offset:33792
    ds_write_b128 v224, v[104:107] offset:34816
    ds_write_b128 v224, v[108:111] offset:35840
    ds_write_b128 v224, v[112:115] offset:36864
    ds_write_b128 v224, v[116:119] offset:37888
    ds_write_b128 v224, v[120:123] offset:38912
    ds_write_b128 v224, v[124:127] offset:39936
    s_waitcnt lgkmcnt(0)
    s_barrier
    s_add_u32 m0, s42, 131072
    s_mov_b32 s40, 98304
    buffer_load_dwordx4 v231, s[12:15], s40 offen offset:0 nt lds
    buffer_load_dwordx4 v232, s[12:15], s40 offen offset:1024 nt lds
    buffer_load_dwordx4 v231, s[12:15], s40 offen offset:2048 nt lds
    buffer_load_dwordx4 v232, s[12:15], s40 offen offset:3072 nt lds
    s_waitcnt vmcnt(52)
    s_add_u32 m0, s42, 135168
    s_mov_b32 s40, 102400
    buffer_load_dwordx4 v231, s[12:15], s40 offen offset:0 nt lds
    buffer_load_dwordx4 v232, s[12:15], s40 offen offset:1024 nt lds
    buffer_load_dwordx4 v231, s[12:15], s40 offen offset:2048 nt lds
    buffer_load_dwordx4 v232, s[12:15], s40 offen offset:3072 nt lds
    ds_write_b128 v224, v[128:131] offset:49152
    ds_write_b128 v224, v[132:135] offset:50176
    ds_write_b128 v224, v[136:139] offset:51200
    ds_write_b128 v224, v[140:143] offset:52224
    ds_write_b128 v224, v[144:147] offset:53248
    ds_write_b128 v224, v[148:151] offset:54272
    ds_write_b128 v224, v[152:155] offset:55296
    ds_write_b128 v224, v[156:159] offset:56320
    s_waitcnt lgkmcnt(0)
    s_barrier
    s_add_u32 m0, s42, 147456
    s_mov_b32 s40, 114688
    buffer_load_dwordx4 v231, s[12:15], s40 offen offset:0 nt lds
    buffer_load_dwordx4 v232, s[12:15], s40 offen offset:1024 nt lds
    buffer_load_dwordx4 v231, s[12:15], s40 offen offset:2048 nt lds
    buffer_load_dwordx4 v232, s[12:15], s40 offen offset:3072 nt lds
    s_waitcnt vmcnt(52)
    s_add_u32 m0, s42, 151552
    s_mov_b32 s40, 118784
    buffer_load_dwordx4 v231, s[12:15], s40 offen offset:0 nt lds
    buffer_load_dwordx4 v232, s[12:15], s40 offen offset:1024 nt lds
    buffer_load_dwordx4 v231, s[12:15], s40 offen offset:2048 nt lds
    buffer_load_dwordx4 v232, s[12:15], s40 offen offset:3072 nt lds
    ds_write_b128 v224, v[160:163] offset:0
    ds_write_b128 v224, v[164:167] offset:1024
    ds_write_b128 v224, v[168:171] offset:2048
    ds_write_b128 v224, v[172:175] offset:3072
    ds_write_b128 v224, v[176:179] offset:4096
    ds_write_b128 v224, v[180:183] offset:5120
    ds_write_b128 v224, v[184:187] offset:6144
    ds_write_b128 v224, v[188:191] offset:7168
    s_waitcnt lgkmcnt(0)
    s_barrier
    s_mov_b32 s40, 2097152
    buffer_load_dwordx4 v[0:3], v227, s[8:11], s40 offen offset:0 nt
    buffer_load_dwordx4 v[4:7], v228, s[8:11], s40 offen offset:1024 nt
    buffer_load_dwordx4 v[8:11], v229, s[8:11], s40 offen offset:2048 nt
    buffer_load_dwordx4 v[12:15], v230, s[8:11], s40 offen offset:3072 nt
    s_waitcnt vmcnt(52)
    s_mov_b32 s40, 2101248
    buffer_load_dwordx4 v[16:19], v227, s[8:11], s40 offen offset:0 nt
    buffer_load_dwordx4 v[20:23], v228, s[8:11], s40 offen offset:1024 nt
    buffer_load_dwordx4 v[24:27], v229, s[8:11], s40 offen offset:2048 nt
    buffer_load_dwordx4 v[28:31], v230, s[8:11], s40 offen offset:3072 nt
    ds_write_b128 v224, v[192:195] offset:16384
    ds_write_b128 v224, v[196:199] offset:17408
    ds_write_b128 v224, v[200:203] offset:18432
    ds_write_b128 v224, v[204:207] offset:19456
    ds_write_b128 v224, v[208:211] offset:20480
    ds_write_b128 v224, v[212:215] offset:21504
    ds_write_b128 v224, v[216:219] offset:22528
    ds_write_b128 v224, v[220:223] offset:23552
    s_waitcnt lgkmcnt(0)
    s_barrier
    s_mov_b32 s40, 2113536
    buffer_load_dwordx4 v[32:35], v227, s[8:11], s40 offen offset:0 nt
    buffer_load_dwordx4 v[36:39], v228, s[8:11], s40 offen offset:1024 nt
    buffer_load_dwordx4 v[40:43], v229, s[8:11], s40 offen offset:2048 nt
    buffer_load_dwordx4 v[44:47], v230, s[8:11], s40 offen offset:3072 nt
    s_waitcnt vmcnt(52)
    s_mov_b32 s40, 2117632
    buffer_load_dwordx4 v[48:51], v227, s[8:11], s40 offen offset:0 nt
    buffer_load_dwordx4 v[52:55], v228, s[8:11], s40 offen offset:1024 nt
    buffer_load_dwordx4 v[56:59], v229, s[8:11], s40 offen offset:2048 nt
    buffer_load_dwordx4 v[60:63], v230, s[8:11], s40 offen offset:3072 nt
    s_waitcnt lgkmcnt(0)
    s_barrier
    s_mov_b32 s40, 2129920
    buffer_load_dwordx4 v[64:67], v227, s[8:11], s40 offen offset:0 nt
    buffer_load_dwordx4 v[68:71], v228, s[8:11], s40 offen offset:1024 nt
    buffer_load_dwordx4 v[72:75], v229, s[8:11], s40 offen offset:2048 nt
    buffer_load_dwordx4 v[76:79], v230, s[8:11], s40 offen offset:3072 nt
    s_waitcnt vmcnt(52)
    s_mov_b32 s40, 2134016
    buffer_load_dwordx4 v[80:83], v227, s[8:11], s40 offen offset:0 nt
    buffer_load_dwordx4 v[84:87], v228, s[8:11], s40 offen offset:1024 nt
    buffer_load_dwordx4 v[88:91], v229, s[8:11], s40 offen offset:2048 nt
    buffer_load_dwordx4 v[92:95], v230, s[8:11], s40 offen offset:3072 nt
    s_waitcnt lgkmcnt(0)
    s_barrier
    s_mov_b32 s40, 2146304
    buffer_load_dwordx4 v[96:99], v227, s[8:11], s40 offen offset:0 nt
    buffer_load_dwordx4 v[100:103], v228, s[8:11], s40 offen offset:1024 nt
    buffer_load_dwordx4 v[104:107], v229, s[8:11], s40 offen offset:2048 nt
    buffer_load_dwordx4 v[108:111], v230, s[8:11], s40 offen offset:3072 nt
    s_waitcnt vmcnt(52)
    s_mov_b32 s40, 2150400
    buffer_load_dwordx4 v[112:115], v227, s[8:11], s40 offen offset:0 nt
    buffer_load_dwordx4 v[116:119], v228, s[8:11], s40 offen offset:1024 nt
    buffer_load_dwordx4 v[120:123], v229, s[8:11], s40 offen offset:2048 nt
    buffer_load_dwordx4 v[124:127], v230, s[8:11], s40 offen offset:3072 nt
    s_sub_u32 s46, s3, 6
    s_mul_i32 s52, s46, 10240
    s_mul_i32 s47, s46, 40960
    s_mul_i32 s48, s95, 320
    s_add_u32 s47, s47, s48
    v_add_u32 v252, 0, v249
    v_mul_u32_u24 v253, 3277, v252
    v_lshrrev_b32 v253, 16, v253
    v_mul_u32_u24 v254, 20, v253
    v_sub_u32 v252, v252, v254
    v_lshrrev_b32 v254, 1, v253
    v_and_b32 v254, 2, v254
    v_xor_b32 v252, v252, v254
    v_lshlrev_b32 v252, 4, v252
    v_mul_u32_u24 v253, 1280, v253
    v_add3_u32 v192, v252, v253, s47
    v_add_u32 v252, 64, v249
    v_mul_u32_u24 v253, 3277, v252
    v_lshrrev_b32 v253, 16, v253
    v_mul_u32_u24 v254, 20, v253
    v_sub_u32 v252, v252, v254
    v_lshrrev_b32 v254, 1, v253
    v_and_b32 v254, 2, v254
    v_xor_b32 v252, v252, v254
    v_lshlrev_b32 v252, 4, v252
    v_mul_u32_u24 v253, 1280, v253
    v_add3_u32 v193, v252, v253, s47
    v_subrev_u32 v193, 1024, v193
    v_add_u32 v252, 128, v249
    v_mul_u32_u24 v253, 3277, v252
    v_lshrrev_b32 v253, 16, v253
    v_mul_u32_u24 v254, 20, v253
    v_sub_u32 v252, v252, v254
    v_lshrrev_b32 v254, 1, v253
    v_and_b32 v254, 2, v254
    v_xor_b32 v252, v252, v254
    v_lshlrev_b32 v252, 4, v252
    v_mul_u32_u24 v253, 1280, v253
    v_add3_u32 v194, v252, v253, s47
    v_subrev_u32 v194, 2048, v194
    v_add_u32 v252, 192, v249
    v_mul_u32_u24 v253, 3277, v252
    v_lshrrev_b32 v253, 16, v253
    v_mul_u32_u24 v254, 20, v253
    v_sub_u32 v252, v252, v254
    v_lshrrev_b32 v254, 1, v253
    v_and_b32 v254, 2, v254
    v_xor_b32 v252, v252, v254
    v_lshlrev_b32 v252, 4, v252
    v_mul_u32_u24 v253, 1280, v253
    v_add3_u32 v195, v252, v253, s47
    v_subrev_u32 v195, 3072, v195
    v_add_u32 v252, 256, v249
    v_mul_u32_u24 v253, 3277, v252
    v_lshrrev_b32 v253, 16, v253
    v_mul_u32_u24 v254, 20, v253
    v_sub_u32 v252, v252, v254
    v_lshrrev_b32 v254, 1, v253
    v_and_b32 v254, 2, v254
    v_xor_b32 v252, v252, v254
    v_lshlrev_b32 v252, 4, v252
    v_mul_u32_u24 v253, 1280, v253
    v_add3_u32 v196, v252, v253, s47
    s_waitcnt lgkmcnt(0)
    s_barrier
    s_mov_b32 s40, 2162688
    buffer_load_dwordx4 v[128:131], v227, s[8:11], s40 offen offset:0 nt
    buffer_load_dwordx4 v[132:135], v228, s[8:11], s40 offen offset:1024 nt
    buffer_load_dwordx4 v[136:139], v229, s[8:11], s40 offen offset:2048 nt
    buffer_load_dwordx4 v[140:143], v230, s[8:11], s40 offen offset:3072 nt
    s_waitcnt vmcnt(52)
    s_mov_b32 s40, 2166784
    buffer_load_dwordx4 v[144:147], v227, s[8:11], s40 offen offset:0 nt
    buffer_load_dwordx4 v[148:151], v228, s[8:11], s40 offen offset:1024 nt
    buffer_load_dwordx4 v[152:155], v229, s[8:11], s40 offen offset:2048 nt
    buffer_load_dwordx4 v[156:159], v230, s[8:11], s40 offen offset:3072 nt
    s_waitcnt lgkmcnt(0)
    s_barrier
    s_mov_b32 s40, 2179072
    buffer_load_dwordx4 v[160:163], v227, s[8:11], s40 offen offset:0 nt
    buffer_load_dwordx4 v[164:167], v228, s[8:11], s40 offen offset:1024 nt
    buffer_load_dwordx4 v[168:171], v229, s[8:11], s40 offen offset:2048 nt
    buffer_load_dwordx4 v[172:175], v230, s[8:11], s40 offen offset:3072 nt
    s_waitcnt vmcnt(52)
    s_mov_b32 s40, 2183168
    buffer_load_dwordx4 v[176:179], v227, s[8:11], s40 offen offset:0 nt
    buffer_load_dwordx4 v[180:183], v228, s[8:11], s40 offen offset:1024 nt
    buffer_load_dwordx4 v[184:187], v229, s[8:11], s40 offen offset:2048 nt
    buffer_load_dwordx4 v[188:191], v230, s[8:11], s40 offen offset:3072 nt
    s_waitcnt lgkmcnt(0)
    s_barrier
    s_add_u32 m0, s42, 32768
    s_mov_b32 s40, 2195456
    buffer_load_dwordx4 v227, s[8:11], s40 offen offset:0 nt lds
    buffer_load_dwordx4 v228, s[8:11], s40 offen offset:1024 nt lds
    buffer_load_dwordx4 v229, s[8:11], s40 offen offset:2048 nt lds
    buffer_load_dwordx4 v230, s[8:11], s40 offen offset:3072 nt lds
    s_waitcnt vmcnt(52)
    s_add_u32 m0, s42, 36864
    s_mov_b32 s40, 2199552
    buffer_load_dwordx4 v227, s[8:11], s40 offen offset:0 nt lds
    buffer_load_dwordx4 v228, s[8:11], s40 offen offset:1024 nt lds
    buffer_load_dwordx4 v229, s[8:11], s40 offen offset:2048 nt lds
    buffer_load_dwordx4 v230, s[8:11], s40 offen offset:3072 nt lds
    s_waitcnt lgkmcnt(0)
    s_barrier
    s_add_u32 m0, s42, 49152
    s_mov_b32 s40, 2211840
    buffer_load_dwordx4 v227, s[8:11], s40 offen offset:0 nt lds
    buffer_load_dwordx4 v228, s[8:11], s40 offen offset:1024 nt lds
    buffer_load_dwordx4 v229, s[8:11], s40 offen offset:2048 nt lds
    buffer_load_dwordx4 v230, s[8:11], s40 offen offset:3072 nt lds
    s_waitcnt vmcnt(52)
    s_add_u32 m0, s42, 53248
    s_mov_b32 s40, 2215936
    buffer_load_dwordx4 v227, s[8:11], s40 offen offset:0 nt lds
    buffer_load_dwordx4 v228, s[8:11], s40 offen offset:1024 nt lds
    buffer_load_dwordx4 v229, s[8:11], s40 offen offset:2048 nt lds
    buffer_load_dwordx4 v230, s[8:11], s40 offen offset:3072 nt lds
    ds_write_b128 v225, v[0:3] offset:32768
    ds_write_b128 v225, v[4:7] offset:33792
    ds_write_b128 v225, v[8:11] offset:34816
    ds_write_b128 v225, v[12:15] offset:35840
    ds_write_b128 v225, v[16:19] offset:36864
    ds_write_b128 v225, v[20:23] offset:37888
    ds_write_b128 v225, v[24:27] offset:38912
    ds_write_b128 v225, v[28:31] offset:39936
    s_waitcnt lgkmcnt(0)
    s_barrier
    s_add_u32 m0, s42, 0
    s_mov_b32 s40, 2097152
    buffer_load_dwordx4 v231, s[12:15], s40 offen offset:0 nt lds
    buffer_load_dwordx4 v232, s[12:15], s40 offen offset:1024 nt lds
    buffer_load_dwordx4 v231, s[12:15], s40 offen offset:2048 nt lds
    buffer_load_dwordx4 v232, s[12:15], s40 offen offset:3072 nt lds
    s_waitcnt vmcnt(52)
    s_add_u32 m0, s42, 4096
    s_mov_b32 s40, 2101248
    buffer_load_dwordx4 v231, s[12:15], s40 offen offset:0 nt lds
    buffer_load_dwordx4 v232, s[12:15], s40 offen offset:1024 nt lds
    buffer_load_dwordx4 v231, s[12:15], s40 offen offset:2048 nt lds
    buffer_load_dwordx4 v232, s[12:15], s40 offen offset:3072 nt lds
    ds_write_b128 v225, v[32:35] offset:49152
    ds_write_b128 v225, v[36:39] offset:50176
    ds_write_b128 v225, v[40:43] offset:51200
    ds_write_b128 v225, v[44:47] offset:52224
    ds_write_b128 v225, v[48:51] offset:53248
    ds_write_b128 v225, v[52:55] offset:54272
    ds_write_b128 v225, v[56:59] offset:55296
    ds_write_b128 v225, v[60:63] offset:56320
    s_waitcnt lgkmcnt(0)
    s_barrier
    s_add_u32 m0, s42, 16384
    s_mov_b32 s40, 2113536
    buffer_load_dwordx4 v231, s[12:15], s40 offen offset:0 nt lds
    buffer_load_dwordx4 v232, s[12:15], s40 offen offset:1024 nt lds
    buffer_load_dwordx4 v231, s[12:15], s40 offen offset:2048 nt lds
    buffer_load_dwordx4 v232, s[12:15], s40 offen offset:3072 nt lds
    s_waitcnt vmcnt(52)
    s_add_u32 m0, s42, 20480
    s_mov_b32 s40, 2117632
    buffer_load_dwordx4 v231, s[12:15], s40 offen offset:0 nt lds
    buffer_load_dwordx4 v232, s[12:15], s40 offen offset:1024 nt lds
    buffer_load_dwordx4 v231, s[12:15], s40 offen offset:2048 nt lds
    buffer_load_dwordx4 v232, s[12:15], s40 offen offset:3072 nt lds
    ds_write_b128 v226, v[64:67] offset:0
    ds_write_b128 v226, v[68:71] offset:1024
    ds_write_b128 v226, v[72:75] offset:2048
    ds_write_b128 v226, v[76:79] offset:3072
    ds_write_b128 v226, v[80:83] offset:4096
    ds_write_b128 v226, v[84:87] offset:5120
    ds_write_b128 v226, v[88:91] offset:6144
    ds_write_b128 v226, v[92:95] offset:7168
    s_waitcnt lgkmcnt(0)
    s_barrier
    s_waitcnt vmcnt(48)
    ds_write_b128 v226, v[96:99] offset:16384
    ds_write_b128 v226, v[100:103] offset:17408
    ds_write_b128 v226, v[104:107] offset:18432
    ds_write_b128 v226, v[108:111] offset:19456
    ds_write_b128 v226, v[112:115] offset:20480
    ds_write_b128 v226, v[116:119] offset:21504
    ds_write_b128 v226, v[120:123] offset:22528
    ds_write_b128 v226, v[124:127] offset:23552
    s_waitcnt lgkmcnt(0)
    s_barrier
    s_add_u32 m0, s42, 65536
    s_mov_b32 s40, 2129920
    buffer_load_dwordx4 v231, s[12:15], s40 offen offset:0 nt lds
    buffer_load_dwordx4 v232, s[12:15], s40 offen offset:1024 nt lds
    buffer_load_dwordx4 v231, s[12:15], s40 offen offset:2048 nt lds
    buffer_load_dwordx4 v232, s[12:15], s40 offen offset:3072 nt lds
    s_add_u32 m0, s42, 69632
    s_mov_b32 s40, 2134016
    buffer_load_dwordx4 v231, s[12:15], s40 offen offset:0 nt lds
    buffer_load_dwordx4 v232, s[12:15], s40 offen offset:1024 nt lds
    buffer_load_dwordx4 v231, s[12:15], s40 offen offset:2048 nt lds
    buffer_load_dwordx4 v232, s[12:15], s40 offen offset:3072 nt lds
    s_waitcnt vmcnt(48)
    ds_write_b128 v225, v[128:131] offset:32768
    ds_write_b128 v225, v[132:135] offset:33792
    ds_write_b128 v225, v[136:139] offset:34816
    ds_write_b128 v225, v[140:143] offset:35840
    ds_write_b128 v225, v[144:147] offset:36864
    ds_write_b128 v225, v[148:151] offset:37888
    ds_write_b128 v225, v[152:155] offset:38912
    ds_write_b128 v225, v[156:159] offset:39936
    s_waitcnt lgkmcnt(0)
    s_barrier
    s_add_u32 m0, s42, 81920
    s_mov_b32 s40, 2146304
    buffer_load_dwordx4 v231, s[12:15], s40 offen offset:0 nt lds
    buffer_load_dwordx4 v232, s[12:15], s40 offen offset:1024 nt lds
    buffer_load_dwordx4 v231, s[12:15], s40 offen offset:2048 nt lds
    buffer_load_dwordx4 v232, s[12:15], s40 offen offset:3072 nt lds
    s_add_u32 m0, s42, 86016
    s_mov_b32 s40, 2150400
    buffer_load_dwordx4 v231, s[12:15], s40 offen offset:0 nt lds
    buffer_load_dwordx4 v232, s[12:15], s40 offen offset:1024 nt lds
    buffer_load_dwordx4 v231, s[12:15], s40 offen offset:2048 nt lds
    buffer_load_dwordx4 v232, s[12:15], s40 offen offset:3072 nt lds
    s_waitcnt vmcnt(48)
    ds_write_b128 v225, v[160:163] offset:49152
    ds_write_b128 v225, v[164:167] offset:50176
    ds_write_b128 v225, v[168:171] offset:51200
    ds_write_b128 v225, v[172:175] offset:52224
    ds_write_b128 v225, v[176:179] offset:53248
    ds_write_b128 v225, v[180:183] offset:54272
    ds_write_b128 v225, v[184:187] offset:55296
    ds_write_b128 v225, v[188:191] offset:56320
    s_waitcnt lgkmcnt(0)
    s_barrier
    s_add_u32 m0, s42, 131072
    s_mov_b32 s40, 2162688
    buffer_load_dwordx4 v231, s[12:15], s40 offen offset:0 nt lds
    buffer_load_dwordx4 v232, s[12:15], s40 offen offset:1024 nt lds
    buffer_load_dwordx4 v231, s[12:15], s40 offen offset:2048 nt lds
    buffer_load_dwordx4 v232, s[12:15], s40 offen offset:3072 nt lds
    s_add_u32 m0, s42, 135168
    s_mov_b32 s40, 2166784
    buffer_load_dwordx4 v231, s[12:15], s40 offen offset:0 nt lds
    buffer_load_dwordx4 v232, s[12:15], s40 offen offset:1024 nt lds
    buffer_load_dwordx4 v231, s[12:15], s40 offen offset:2048 nt lds
    buffer_load_dwordx4 v232, s[12:15], s40 offen offset:3072 nt lds
    s_waitcnt lgkmcnt(0)
    s_barrier
    s_waitcnt vmcnt(48)
    s_waitcnt lgkmcnt(0)
    s_barrier
    s_add_u32 m0, s42, 147456
    s_mov_b32 s40, 2179072
    buffer_load_dwordx4 v231, s[12:15], s40 offen offset:0 nt lds
    buffer_load_dwordx4 v232, s[12:15], s40 offen offset:1024 nt lds
    buffer_load_dwordx4 v231, s[12:15], s40 offen offset:2048 nt lds
    buffer_load_dwordx4 v232, s[12:15], s40 offen offset:3072 nt lds
    s_add_u32 m0, s42, 151552
    s_mov_b32 s40, 2183168
    buffer_load_dwordx4 v231, s[12:15], s40 offen offset:0 nt lds
    buffer_load_dwordx4 v232, s[12:15], s40 offen offset:1024 nt lds
    buffer_load_dwordx4 v231, s[12:15], s40 offen offset:2048 nt lds
    buffer_load_dwordx4 v232, s[12:15], s40 offen offset:3072 nt lds
    s_waitcnt vmcnt(48)
    s_waitcnt lgkmcnt(0)
    s_barrier
    s_add_u32 m0, s42, 98304
    s_mov_b32 s40, 2195456
    buffer_load_dwordx4 v231, s[12:15], s40 offen offset:0 nt lds
    buffer_load_dwordx4 v232, s[12:15], s40 offen offset:1024 nt lds
    buffer_load_dwordx4 v231, s[12:15], s40 offen offset:2048 nt lds
    buffer_load_dwordx4 v232, s[12:15], s40 offen offset:3072 nt lds
    s_add_u32 m0, s42, 102400
    s_mov_b32 s40, 2199552
    buffer_load_dwordx4 v231, s[12:15], s40 offen offset:0 nt lds
    buffer_load_dwordx4 v232, s[12:15], s40 offen offset:1024 nt lds
    buffer_load_dwordx4 v231, s[12:15], s40 offen offset:2048 nt lds
    buffer_load_dwordx4 v232, s[12:15], s40 offen offset:3072 nt lds
    s_waitcnt vmcnt(48)
    s_waitcnt lgkmcnt(0)
    s_barrier
    s_add_u32 m0, s42, 114688
    s_mov_b32 s40, 2211840
    buffer_load_dwordx4 v231, s[12:15], s40 offen offset:0 nt lds
    buffer_load_dwordx4 v232, s[12:15], s40 offen offset:1024 nt lds
    buffer_load_dwordx4 v231, s[12:15], s40 offen offset:2048 nt lds
    buffer_load_dwordx4 v232, s[12:15], s40 offen offset:3072 nt lds
    s_add_u32 m0, s42, 118784
    s_mov_b32 s40, 2215936
    buffer_load_dwordx4 v231, s[12:15], s40 offen offset:0 nt lds
    buffer_load_dwordx4 v232, s[12:15], s40 offen offset:1024 nt lds
    buffer_load_dwordx4 v231, s[12:15], s40 offen offset:2048 nt lds
    buffer_load_dwordx4 v232, s[12:15], s40 offen offset:3072 nt lds
    s_waitcnt vmcnt(48)
    s_waitcnt lgkmcnt(0)
    s_barrier
    s_add_u32 s53, s95, 0
    s_and_b32 s53, s53, 3
    s_lshl_b32 s54, s94, 2
    s_add_u32 s53, s53, s54
    s_mul_i32 s97, s53, 163840
    s_add_u32 s40, s97, 20480
    s_add_u32 m0, s52, 32768
    s_nop 0
    buffer_load_dwordx4 v192, s[28:31], s97 offen offset:0 lds
    buffer_load_dwordx4 v193, s[28:31], s97 offen offset:1024 lds
    buffer_load_dwordx4 v194, s[28:31], s97 offen offset:2048 lds
    buffer_load_dwordx4 v195, s[28:31], s97 offen offset:3072 lds
    s_add_u32 m0, s52, 36864
    s_nop 0
    buffer_load_dwordx4 v196, s[28:31], s97 offen offset:0 lds
    s_add_u32 m0, s52, 37888
    s_nop 0
    buffer_load_dwordx4 v192, s[28:31], s40 offen offset:0 lds
    buffer_load_dwordx4 v193, s[28:31], s40 offen offset:1024 lds
    buffer_load_dwordx4 v194, s[28:31], s40 offen offset:2048 lds
    buffer_load_dwordx4 v195, s[28:31], s40 offen offset:3072 lds
    s_add_u32 m0, s52, 41984
    s_nop 0
    buffer_load_dwordx4 v196, s[28:31], s40 offen offset:0 lds
    s_lshr_b32 s46, s43, 2
    s_and_b32 s47, s46, 3
    s_lshr_b32 s46, s46, 2
    s_lshl_b32 s46, s46, 4
    s_add_u32 s46, s46, s47
    s_lshl_b32 s47, s94, 2
    s_add_u32 s46, s46, s47
    s_lshl_b32 s46, s46, 2
    s_and_b32 s47, s43, 3
    s_add_u32 s46, s46, s47
    s_mul_i32 s46, s46, 40960
    s_sub_u32 s47, s3, 6
    s_mul_i32 s47, s47, 20480
    s_add_u32 s49, s46, s47
    v_lshlrev_b32 v237, 7, v249
    s_bfm_b64 exec, 32, 0
    buffer_load_dword v236, v237, s[28:31], s49 offen sc1
    s_add_u32 s49, s49, 4096
    s_mov_b64 exec, -1
    s_waitcnt vmcnt(51)
    s_waitcnt lgkmcnt(0)
    s_barrier
    s_bfm_b64 exec, 32, 0
    buffer_load_dword v236, v237, s[28:31], s49 offen sc1
    s_add_u32 s49, s49, 4096
    s_mov_b64 exec, -1
    s_waitcnt vmcnt(44)
    s_waitcnt lgkmcnt(0)
    s_barrier
    s_add_u32 s97, s97, 81920
    s_add_u32 s40, s97, 20480
    s_add_u32 m0, s52, 0
    s_nop 0
    buffer_load_dwordx4 v192, s[28:31], s97 offen offset:0 lds
    buffer_load_dwordx4 v193, s[28:31], s97 offen offset:1024 lds
    buffer_load_dwordx4 v194, s[28:31], s97 offen offset:2048 lds
    buffer_load_dwordx4 v195, s[28:31], s97 offen offset:3072 lds
    s_add_u32 m0, s52, 4096
    s_nop 0
    buffer_load_dwordx4 v196, s[28:31], s97 offen offset:0 lds
    s_add_u32 m0, s52, 5120
    s_nop 0
    buffer_load_dwordx4 v192, s[28:31], s40 offen offset:0 lds
    buffer_load_dwordx4 v193, s[28:31], s40 offen offset:1024 lds
    buffer_load_dwordx4 v194, s[28:31], s40 offen offset:2048 lds
    buffer_load_dwordx4 v195, s[28:31], s40 offen offset:3072 lds
    s_add_u32 m0, s52, 9216
    s_nop 0
    buffer_load_dwordx4 v196, s[28:31], s40 offen offset:0 lds
    s_bfm_b64 exec, 32, 0
    buffer_load_dword v236, v237, s[28:31], s49 offen sc1
    s_add_u32 s49, s49, 4096
    s_mov_b64 exec, -1
    s_waitcnt vmcnt(47)
    s_waitcnt lgkmcnt(0)
    s_barrier
    s_bfm_b64 exec, 32, 0
    buffer_load_dword v236, v237, s[28:31], s49 offen sc1
    s_add_u32 s49, s49, 4096
    s_mov_b64 exec, -1
    s_waitcnt vmcnt(40)
    s_waitcnt lgkmcnt(0)
    s_barrier
    s_add_u32 s53, s95, 0
    s_and_b32 s53, s53, 3
    s_lshl_b32 s54, s94, 2
    s_add_u32 s53, s53, s54
    s_add_u32 s53, s53, 16
    s_mul_i32 s97, s53, 163840
    s_add_u32 s40, s97, 20480
    s_add_u32 m0, s52, 65536
    s_nop 0
    buffer_load_dwordx4 v192, s[28:31], s97 offen offset:0 lds
    buffer_load_dwordx4 v193, s[28:31], s97 offen offset:1024 lds
    buffer_load_dwordx4 v194, s[28:31], s97 offen offset:2048 lds
    buffer_load_dwordx4 v195, s[28:31], s97 offen offset:3072 lds
    s_add_u32 m0, s52, 69632
    s_nop 0
    buffer_load_dwordx4 v196, s[28:31], s97 offen offset:0 lds
    s_add_u32 m0, s52, 70656
    s_nop 0
    buffer_load_dwordx4 v192, s[28:31], s40 offen offset:0 lds
    buffer_load_dwordx4 v193, s[28:31], s40 offen offset:1024 lds
    buffer_load_dwordx4 v194, s[28:31], s40 offen offset:2048 lds
    buffer_load_dwordx4 v195, s[28:31], s40 offen offset:3072 lds
    s_add_u32 m0, s52, 74752
    s_nop 0
    buffer_load_dwordx4 v196, s[28:31], s40 offen offset:0 lds
    s_bfm_b64 exec, 32, 0
    buffer_load_dword v236, v237, s[28:31], s49 offen sc1
    s_add_u32 s49, s49, 4096
    s_mov_b64 exec, -1
    s_waitcnt vmcnt(43)
    s_waitcnt lgkmcnt(0)
    s_barrier
    s_waitcnt vmcnt(35)
    s_waitcnt lgkmcnt(0)
    s_barrier
    s_add_u32 s97, s97, 81920
    s_add_u32 s40, s97, 20480
    s_add_u32 m0, s52, 131072
    s_nop 0
    buffer_load_dwordx4 v192, s[28:31], s97 offen offset:0 lds
    buffer_load_dwordx4 v193, s[28:31], s97 offen offset:1024 lds
    buffer_load_dwordx4 v194, s[28:31], s97 offen offset:2048 lds
    buffer_load_dwordx4 v195, s[28:31], s97 offen offset:3072 lds
    s_add_u32 m0, s52, 135168
    s_nop 0
    buffer_load_dwordx4 v196, s[28:31], s97 offen offset:0 lds
    s_add_u32 m0, s52, 136192
    s_nop 0
    buffer_load_dwordx4 v192, s[28:31], s40 offen offset:0 lds
    buffer_load_dwordx4 v193, s[28:31], s40 offen offset:1024 lds
    buffer_load_dwordx4 v194, s[28:31], s40 offen offset:2048 lds
    buffer_load_dwordx4 v195, s[28:31], s40 offen offset:3072 lds
    s_add_u32 m0, s52, 140288
    s_nop 0
    buffer_load_dwordx4 v196, s[28:31], s40 offen offset:0 lds
    s_waitcnt vmcnt(35)
    s_barrier
    s_add_u32 s53, s95, 1
    s_and_b32 s53, s53, 3
    s_lshl_b32 s54, s94, 2
    s_add_u32 s53, s53, s54
    s_mul_i32 s97, s53, 163840
    s_add_u32 s40, s97, 20480
    s_add_u32 m0, s52, 98304
    s_nop 0
    buffer_load_dwordx4 v192, s[28:31], s97 offen offset:0 lds
    buffer_load_dwordx4 v193, s[28:31], s97 offen offset:1024 lds
    buffer_load_dwordx4 v194, s[28:31], s97 offen offset:2048 lds
    buffer_load_dwordx4 v195, s[28:31], s97 offen offset:3072 lds
    s_add_u32 m0, s52, 102400
    s_nop 0
    buffer_load_dwordx4 v196, s[28:31], s97 offen offset:0 lds
    s_add_u32 m0, s52, 103424
    s_nop 0
    buffer_load_dwordx4 v192, s[28:31], s40 offen offset:0 lds
    buffer_load_dwordx4 v193, s[28:31], s40 offen offset:1024 lds
    buffer_load_dwordx4 v194, s[28:31], s40 offen offset:2048 lds
    buffer_load_dwordx4 v195, s[28:31], s40 offen offset:3072 lds
    s_add_u32 m0, s52, 107520
    s_nop 0
    buffer_load_dwordx4 v196, s[28:31], s40 offen offset:0 lds
    s_waitcnt vmcnt(33)
    s_barrier
    s_add_u32 s97, s97, 81920
    s_add_u32 s40, s97, 20480
    s_add_u32 m0, s52, 32768
    s_nop 0
    buffer_load_dwordx4 v192, s[28:31], s97 offen offset:0 lds
    buffer_load_dwordx4 v193, s[28:31], s97 offen offset:1024 lds
    buffer_load_dwordx4 v194, s[28:31], s97 offen offset:2048 lds
    buffer_load_dwordx4 v195, s[28:31], s97 offen offset:3072 lds
    s_add_u32 m0, s52, 36864
    s_nop 0
    buffer_load_dwordx4 v196, s[28:31], s97 offen offset:0 lds
    s_add_u32 m0, s52, 37888
    s_nop 0
    buffer_load_dwordx4 v192, s[28:31], s40 offen offset:0 lds
    buffer_load_dwordx4 v193, s[28:31], s40 offen offset:1024 lds
    buffer_load_dwordx4 v194, s[28:31], s40 offen offset:2048 lds
    buffer_load_dwordx4 v195, s[28:31], s40 offen offset:3072 lds
    s_add_u32 m0, s52, 41984
    s_nop 0
    buffer_load_dwordx4 v196, s[28:31], s40 offen offset:0 lds
    s_waitcnt vmcnt(31)
    s_barrier
    s_add_u32 s53, s95, 2
    s_and_b32 s53, s53, 3
    s_lshl_b32 s54, s94, 2
    s_add_u32 s53, s53, s54
    s_mul_i32 s97, s53, 163840
    s_add_u32 s40, s97, 20480
    s_add_u32 m0, s52, 0
    s_nop 0
    buffer_load_dwordx4 v192, s[28:31], s97 offen offset:0 lds
    buffer_load_dwordx4 v193, s[28:31], s97 offen offset:1024 lds
    buffer_load_dwordx4 v194, s[28:31], s97 offen offset:2048 lds
    buffer_load_dwordx4 v195, s[28:31], s97 offen offset:3072 lds
    s_add_u32 m0, s52, 4096
    s_nop 0
    buffer_load_dwordx4 v196, s[28:31], s97 offen offset:0 lds
    s_add_u32 m0, s52, 5120
    s_nop 0
    buffer_load_dwordx4 v192, s[28:31], s40 offen offset:0 lds
    buffer_load_dwordx4 v193, s[28:31], s40 offen offset:1024 lds
    buffer_load_dwordx4 v194, s[28:31], s40 offen offset:2048 lds
    buffer_load_dwordx4 v195, s[28:31], s40 offen offset:3072 lds
    s_add_u32 m0, s52, 9216
    s_nop 0
    buffer_load_dwordx4 v196, s[28:31], s40 offen offset:0 lds
    s_waitcnt vmcnt(30)
    s_barrier
    s_add_u32 s97, s97, 81920
    s_add_u32 s40, s97, 20480
    s_add_u32 m0, s52, 65536
    s_nop 0
    buffer_load_dwordx4 v192, s[28:31], s97 offen offset:0 lds
    buffer_load_dwordx4 v193, s[28:31], s97 offen offset:1024 lds
    buffer_load_dwordx4 v194, s[28:31], s97 offen offset:2048 lds
    buffer_load_dwordx4 v195, s[28:31], s97 offen offset:3072 lds
    s_add_u32 m0, s52, 69632
    s_nop 0
    buffer_load_dwordx4 v196, s[28:31], s97 offen offset:0 lds
    s_add_u32 m0, s52, 70656
    s_nop 0
    buffer_load_dwordx4 v192, s[28:31], s40 offen offset:0 lds
    buffer_load_dwordx4 v193, s[28:31], s40 offen offset:1024 lds
    buffer_load_dwordx4 v194, s[28:31], s40 offen offset:2048 lds
    buffer_load_dwordx4 v195, s[28:31], s40 offen offset:3072 lds
    s_add_u32 m0, s52, 74752
    s_nop 0
    buffer_load_dwordx4 v196, s[28:31], s40 offen offset:0 lds
    s_waitcnt vmcnt(30)
    s_barrier
    s_add_u32 s53, s95, 3
    s_and_b32 s53, s53, 3
    s_lshl_b32 s54, s94, 2
    s_add_u32 s53, s53, s54
    s_mul_i32 s97, s53, 163840
    s_add_u32 s40, s97, 20480
    s_add_u32 m0, s52, 131072
    s_nop 0
    buffer_load_dwordx4 v192, s[28:31], s97 offen offset:0 lds
    buffer_load_dwordx4 v193, s[28:31], s97 offen offset:1024 lds
    buffer_load_dwordx4 v194, s[28:31], s97 offen offset:2048 lds
    buffer_load_dwordx4 v195, s[28:31], s97 offen offset:3072 lds
    s_add_u32 m0, s52, 135168
    s_nop 0
    buffer_load_dwordx4 v196, s[28:31], s97 offen offset:0 lds
    s_add_u32 m0, s52, 136192
    s_nop 0
    buffer_load_dwordx4 v192, s[28:31], s40 offen offset:0 lds
    buffer_load_dwordx4 v193, s[28:31], s40 offen offset:1024 lds
    buffer_load_dwordx4 v194, s[28:31], s40 offen offset:2048 lds
    buffer_load_dwordx4 v195, s[28:31], s40 offen offset:3072 lds
    s_add_u32 m0, s52, 140288
    s_nop 0
    buffer_load_dwordx4 v196, s[28:31], s40 offen offset:0 lds
    s_waitcnt vmcnt(30)
    s_barrier
    s_add_u32 s97, s97, 81920
    s_add_u32 s40, s97, 20480
    s_add_u32 m0, s52, 98304
    s_nop 0
    buffer_load_dwordx4 v192, s[28:31], s97 offen offset:0 lds
    buffer_load_dwordx4 v193, s[28:31], s97 offen offset:1024 lds
    buffer_load_dwordx4 v194, s[28:31], s97 offen offset:2048 lds
    buffer_load_dwordx4 v195, s[28:31], s97 offen offset:3072 lds
    s_add_u32 m0, s52, 102400
    s_nop 0
    buffer_load_dwordx4 v196, s[28:31], s97 offen offset:0 lds
    s_add_u32 m0, s52, 103424
    s_nop 0
    buffer_load_dwordx4 v192, s[28:31], s40 offen offset:0 lds
    buffer_load_dwordx4 v193, s[28:31], s40 offen offset:1024 lds
    buffer_load_dwordx4 v194, s[28:31], s40 offen offset:2048 lds
    buffer_load_dwordx4 v195, s[28:31], s40 offen offset:3072 lds
    s_add_u32 m0, s52, 107520
    s_nop 0
    buffer_load_dwordx4 v196, s[28:31], s40 offen offset:0 lds
    s_waitcnt vmcnt(30)
    s_barrier
    s_add_u32 s53, s95, 1
    s_and_b32 s53, s53, 3
    s_lshl_b32 s54, s94, 2
    s_add_u32 s53, s53, s54
    s_add_u32 s53, s53, 16
    s_mul_i32 s97, s53, 163840
    s_add_u32 s40, s97, 20480
    s_add_u32 m0, s52, 32768
    s_nop 0
    buffer_load_dwordx4 v192, s[28:31], s97 offen offset:0 lds
    buffer_load_dwordx4 v193, s[28:31], s97 offen offset:1024 lds
    buffer_load_dwordx4 v194, s[28:31], s97 offen offset:2048 lds
    buffer_load_dwordx4 v195, s[28:31], s97 offen offset:3072 lds
    s_add_u32 m0, s52, 36864
    s_nop 0
    buffer_load_dwordx4 v196, s[28:31], s97 offen offset:0 lds
    s_add_u32 m0, s52, 37888
    s_nop 0
    buffer_load_dwordx4 v192, s[28:31], s40 offen offset:0 lds
    buffer_load_dwordx4 v193, s[28:31], s40 offen offset:1024 lds
    buffer_load_dwordx4 v194, s[28:31], s40 offen offset:2048 lds
    buffer_load_dwordx4 v195, s[28:31], s40 offen offset:3072 lds
    s_add_u32 m0, s52, 41984
    s_nop 0
    buffer_load_dwordx4 v196, s[28:31], s40 offen offset:0 lds
    s_waitcnt vmcnt(30)
    s_barrier
    s_add_u32 s97, s97, 81920
    s_add_u32 s40, s97, 20480
    s_add_u32 m0, s52, 0
    s_nop 0
    buffer_load_dwordx4 v192, s[28:31], s97 offen offset:0 lds
    buffer_load_dwordx4 v193, s[28:31], s97 offen offset:1024 lds
    buffer_load_dwordx4 v194, s[28:31], s97 offen offset:2048 lds
    buffer_load_dwordx4 v195, s[28:31], s97 offen offset:3072 lds
    s_add_u32 m0, s52, 4096
    s_nop 0
    buffer_load_dwordx4 v196, s[28:31], s97 offen offset:0 lds
    s_add_u32 m0, s52, 5120
    s_nop 0
    buffer_load_dwordx4 v192, s[28:31], s40 offen offset:0 lds
    buffer_load_dwordx4 v193, s[28:31], s40 offen offset:1024 lds
    buffer_load_dwordx4 v194, s[28:31], s40 offen offset:2048 lds
    buffer_load_dwordx4 v195, s[28:31], s40 offen offset:3072 lds
    s_add_u32 m0, s52, 9216
    s_nop 0
    buffer_load_dwordx4 v196, s[28:31], s40 offen offset:0 lds
    s_waitcnt vmcnt(30)
    s_barrier
    s_add_u32 s53, s95, 2
    s_and_b32 s53, s53, 3
    s_lshl_b32 s54, s94, 2
    s_add_u32 s53, s53, s54
    s_add_u32 s53, s53, 16
    s_mul_i32 s97, s53, 163840
    s_add_u32 s40, s97, 20480
    s_add_u32 m0, s52, 65536
    s_nop 0
    buffer_load_dwordx4 v192, s[28:31], s97 offen offset:0 lds
    buffer_load_dwordx4 v193, s[28:31], s97 offen offset:1024 lds
    buffer_load_dwordx4 v194, s[28:31], s97 offen offset:2048 lds
    buffer_load_dwordx4 v195, s[28:31], s97 offen offset:3072 lds
    s_add_u32 m0, s52, 69632
    s_nop 0
    buffer_load_dwordx4 v196, s[28:31], s97 offen offset:0 lds
    s_add_u32 m0, s52, 70656
    s_nop 0
    buffer_load_dwordx4 v192, s[28:31], s40 offen offset:0 lds
    buffer_load_dwordx4 v193, s[28:31], s40 offen offset:1024 lds
    buffer_load_dwordx4 v194, s[28:31], s40 offen offset:2048 lds
    buffer_load_dwordx4 v195, s[28:31], s40 offen offset:3072 lds
    s_add_u32 m0, s52, 74752
    s_nop 0
    buffer_load_dwordx4 v196, s[28:31], s40 offen offset:0 lds
    s_waitcnt vmcnt(30)
    s_barrier
    s_add_u32 s97, s97, 81920
    s_add_u32 s40, s97, 20480
    s_add_u32 m0, s52, 131072
    s_nop 0
    buffer_load_dwordx4 v192, s[28:31], s97 offen offset:0 lds
    buffer_load_dwordx4 v193, s[28:31], s97 offen offset:1024 lds
    buffer_load_dwordx4 v194, s[28:31], s97 offen offset:2048 lds
    buffer_load_dwordx4 v195, s[28:31], s97 offen offset:3072 lds
    s_add_u32 m0, s52, 135168
    s_nop 0
    buffer_load_dwordx4 v196, s[28:31], s97 offen offset:0 lds
    s_add_u32 m0, s52, 136192
    s_nop 0
    buffer_load_dwordx4 v192, s[28:31], s40 offen offset:0 lds
    buffer_load_dwordx4 v193, s[28:31], s40 offen offset:1024 lds
    buffer_load_dwordx4 v194, s[28:31], s40 offen offset:2048 lds
    buffer_load_dwordx4 v195, s[28:31], s40 offen offset:3072 lds
    s_add_u32 m0, s52, 140288
    s_nop 0
    buffer_load_dwordx4 v196, s[28:31], s40 offen offset:0 lds
    s_waitcnt vmcnt(30)
    s_barrier
    s_add_u32 s53, s95, 3
    s_and_b32 s53, s53, 3
    s_lshl_b32 s54, s94, 2
    s_add_u32 s53, s53, s54
    s_add_u32 s53, s53, 16
    s_mul_i32 s97, s53, 163840
    s_add_u32 s40, s97, 20480
    s_add_u32 m0, s52, 98304
    s_nop 0
    buffer_load_dwordx4 v192, s[28:31], s97 offen offset:0 lds
    buffer_load_dwordx4 v193, s[28:31], s97 offen offset:1024 lds
    buffer_load_dwordx4 v194, s[28:31], s97 offen offset:2048 lds
    buffer_load_dwordx4 v195, s[28:31], s97 offen offset:3072 lds
    s_add_u32 m0, s52, 102400
    s_nop 0
    buffer_load_dwordx4 v196, s[28:31], s97 offen offset:0 lds
    s_add_u32 m0, s52, 103424
    s_nop 0
    buffer_load_dwordx4 v192, s[28:31], s40 offen offset:0 lds
    buffer_load_dwordx4 v193, s[28:31], s40 offen offset:1024 lds
    buffer_load_dwordx4 v194, s[28:31], s40 offen offset:2048 lds
    buffer_load_dwordx4 v195, s[28:31], s40 offen offset:3072 lds
    s_add_u32 m0, s52, 107520
    s_nop 0
    buffer_load_dwordx4 v196, s[28:31], s40 offen offset:0 lds
    s_waitcnt vmcnt(30)
    s_barrier
    s_add_u32 s97, s97, 81920
    s_add_u32 s40, s97, 20480
    s_add_u32 m0, s52, 32768
    s_nop 0
    buffer_load_dwordx4 v192, s[28:31], s97 offen offset:0 lds
    buffer_load_dwordx4 v193, s[28:31], s97 offen offset:1024 lds
    buffer_load_dwordx4 v194, s[28:31], s97 offen offset:2048 lds
    buffer_load_dwordx4 v195, s[28:31], s97 offen offset:3072 lds
    s_add_u32 m0, s52, 36864
    s_nop 0
    buffer_load_dwordx4 v196, s[28:31], s97 offen offset:0 lds
    s_add_u32 m0, s52, 37888
    s_nop 0
    buffer_load_dwordx4 v192, s[28:31], s40 offen offset:0 lds
    buffer_load_dwordx4 v193, s[28:31], s40 offen offset:1024 lds
    buffer_load_dwordx4 v194, s[28:31], s40 offen offset:2048 lds
    buffer_load_dwordx4 v195, s[28:31], s40 offen offset:3072 lds
    s_add_u32 m0, s52, 41984
    s_nop 0
    buffer_load_dwordx4 v196, s[28:31], s40 offen offset:0 lds
    s_waitcnt vmcnt(30)
    s_barrier
    s_waitcnt vmcnt(20)
    s_barrier
    s_waitcnt vmcnt(10)
    s_barrier
    s_waitcnt vmcnt(0)
    s_barrier
    s_branch L_gpub
L_qp:
    v_bfe_u32 v252, v249, 2, 2
    v_and_b32 v253, 3, v249
    v_and_b32 v254, 1, v250
    v_lshl_add_u32 v254, v254, 2, v252
    s_and_b32 s46, s3, 1
    s_lshl_b32 s46, s46, 2
    v_xor_b32 v254, s46, v254
    v_lshlrev_b32 v254, 5, v254
    v_lshl_add_u32 v254, v253, 3, v254
    v_lshl_add_u32 v255, v250, 3, v252
    v_lshl_add_u32 v254, v255, 8, v254
    s_bfe_u32 s46, s3, 0x10001
    s_lshl_b32 s46, s46, 13
    s_add_u32 s46, s46, 49152
    v_add_u32 v176, s46, v254
    v_xor_b32 v177, 32, v176
    v_xor_b32 v178, 64, v176
    v_xor_b32 v179, 0x60, v176
    v_lshrrev_b32 v252, 1, v251
    v_xor_b32 v252, v250, v252
    v_lshlrev_b32 v252, 4, v252
    v_lshl_add_u32 v252, v251, 7, v252
    v_add_u32 v180, 114688, v252
    v_xor_b32 v181, 64, v180
    v_xor_b32 v252, v250, v251
    v_lshlrev_b32 v252, 4, v252
    v_lshl_add_u32 v224, v251, 8, v252
    v_xor_b32 v225, 64, v224
    v_xor_b32 v226, 0x80, v224
    v_xor_b32 v227, 0xc0, v224
    v_bfe_u32 v252, v249, 2, 2
    v_and_b32 v253, 3, v249
    v_and_b32 v254, 1, v250
    v_lshl_add_u32 v254, v254, 2, v252
    v_lshlrev_b32 v254, 5, v254
    v_lshl_add_u32 v254, v253, 3, v254
    v_lshl_add_u32 v255, v250, 2, v252
    v_lshl_add_u32 v228, v255, 8, v254
    v_xor_b32 v229, 32, v228
    v_xor_b32 v230, 64, v228
    v_xor_b32 v231, 96, v228
    v_xor_b32 v232, 128, v228
    v_xor_b32 v233, 160, v228
    v_xor_b32 v234, 192, v228
    v_xor_b32 v235, 224, v228
    v_mov_b32 v240, 0x3f803f80
    v_mov_b32 v241, 0x3f803f80
    v_mov_b32 v242, 0x3f803f80
    v_mov_b32 v243, 0x3f803f80
    s_lshl_b32 s46, s3, 17
    v_lshlrev_b32 v248, 4, v249
    v_add_u32 v248, s46, v248
    s_mov_b32 s41, 0x3e0293ee
    s_lshl_b32 s96, s4, 3
    s_add_u32 s96, s96, s6
    s_mul_i32 s99, s96, 786432
    s_lshl_b32 s47, s5, 12
    s_add_u32 s50, s99, s47
    s_lshl_b32 s51, s96, 3
    s_add_u32 s51, s51, 128
    s_lshl_b32 s96, s96, 2
    s_add_u32 s96, s96, s95
    s_and_b32 s25, s25, 0xffff
    s_mov_b32 s26, 268435456
    s_mov_b32 s27, 0x20000
    s_and_b32 s37, s37, 0xffff
    s_mov_b32 s38, 256
    s_mov_b32 s39, 0x20000
    s_and_b32 s33, s33, 0xffff
    s_mov_b32 s34, 1966080
    s_mov_b32 s35, 0x20000
    s_waitcnt lgkmcnt(0)
    s_barrier
    ds_read_b128 v[112:115], v180 offset:0
    ds_read_b64_tr_b16 v[96:97], v176 offset:0
    ds_read_b64_tr_b16 v[98:99], v176 offset:1024
    ds_read_b128 v[116:119], v180 offset:2048
    ds_read_b128 v[120:123], v180 offset:4096
    ds_read_b128 v[124:127], v180 offset:6144
    ds_read_b128 v[128:131], v180 offset:8192
    ds_read_b128 v[132:135], v180 offset:10240
    ds_read_b64_tr_b16 v[100:101], v177 offset:0
    ds_read_b64_tr_b16 v[102:103], v177 offset:1024
    ds_read_b64_tr_b16 v[104:105], v178 offset:0
    ds_read_b64_tr_b16 v[106:107], v178 offset:1024
    ds_read_b64_tr_b16 v[108:109], v179 offset:0
    ds_read_b64_tr_b16 v[110:111], v179 offset:1024
    s_waitcnt lgkmcnt(0)
    s_barrier
    v_mfma_f32_16x16x32_bf16 v[0:3], v[96:99], v[112:115], 0
    ds_read_b128 v[152:155], v181 offset:0
    v_mfma_f32_16x16x32_bf16 v[4:7], v[96:99], v[116:119], 0
    ds_read_b64_tr_b16 v[136:137], v176 offset:16384
    v_mfma_f32_16x16x32_bf16 v[8:11], v[96:99], v[120:123], 0
    ds_read_b64_tr_b16 v[138:139], v176 offset:17408
    v_mfma_f32_16x16x32_bf16 v[12:15], v[96:99], v[124:127], 0
    ds_read_b128 v[156:159], v181 offset:2048
    v_mfma_f32_16x16x32_bf16 v[16:19], v[96:99], v[128:131], 0
    ds_read_b128 v[160:163], v181 offset:4096
    v_mfma_f32_16x16x32_bf16 v[20:23], v[96:99], v[132:135], 0
    ds_read_b128 v[164:167], v181 offset:6144
    v_mfma_f32_16x16x32_bf16 v[24:27], v[100:103], v[112:115], 0
    ds_read_b128 v[168:171], v181 offset:8192
    v_mfma_f32_16x16x32_bf16 v[28:31], v[100:103], v[116:119], 0
    ds_read_b128 v[172:175], v181 offset:10240
    v_mfma_f32_16x16x32_bf16 v[32:35], v[100:103], v[120:123], 0
    ds_read_b64_tr_b16 v[140:141], v177 offset:16384
    v_mfma_f32_16x16x32_bf16 v[36:39], v[100:103], v[124:127], 0
    ds_read_b64_tr_b16 v[142:143], v177 offset:17408
    v_mfma_f32_16x16x32_bf16 v[40:43], v[100:103], v[128:131], 0
    ds_read_b64_tr_b16 v[144:145], v178 offset:16384
    v_mfma_f32_16x16x32_bf16 v[44:47], v[100:103], v[132:135], 0
    ds_read_b64_tr_b16 v[146:147], v178 offset:17408
    v_mfma_f32_16x16x32_bf16 v[48:51], v[104:107], v[112:115], 0
    ds_read_b64_tr_b16 v[148:149], v179 offset:16384
    v_mfma_f32_16x16x32_bf16 v[52:55], v[104:107], v[116:119], 0
    ds_read_b64_tr_b16 v[150:151], v179 offset:17408
    v_mfma_f32_16x16x32_bf16 v[56:59], v[104:107], v[120:123], 0
    v_mfma_f32_16x16x32_bf16 v[60:63], v[104:107], v[124:127], 0
    v_mfma_f32_16x16x32_bf16 v[64:67], v[104:107], v[128:131], 0
    v_mfma_f32_16x16x32_bf16 v[68:71], v[104:107], v[132:135], 0
    v_mfma_f32_16x16x32_bf16 v[72:75], v[108:111], v[112:115], 0
    v_mfma_f32_16x16x32_bf16 v[76:79], v[108:111], v[116:119], 0
    v_mfma_f32_16x16x32_bf16 v[80:83], v[108:111], v[120:123], 0
    v_mfma_f32_16x16x32_bf16 v[84:87], v[108:111], v[124:127], 0
    v_mfma_f32_16x16x32_bf16 v[88:91], v[108:111], v[128:131], 0
    v_mfma_f32_16x16x32_bf16 v[92:95], v[108:111], v[132:135], 0
    s_waitcnt lgkmcnt(0)
    s_barrier
    v_mfma_f32_16x16x32_bf16 v[0:3], v[136:139], v[152:155], v[0:3]
    ds_read_b128 v[112:115], v180 offset:12288
    v_mfma_f32_16x16x32_bf16 v[4:7], v[136:139], v[156:159], v[4:7]
    ds_read_b64_tr_b16 v[96:97], v176 offset:32768
    v_mfma_f32_16x16x32_bf16 v[8:11], v[136:139], v[160:163], v[8:11]
    ds_read_b64_tr_b16 v[98:99], v176 offset:33792
    v_mfma_f32_16x16x32_bf16 v[12:15], v[136:139], v[164:167], v[12:15]
    ds_read_b128 v[116:119], v180 offset:14336
    v_mfma_f32_16x16x32_bf16 v[16:19], v[136:139], v[168:171], v[16:19]
    ds_read_b128 v[120:123], v180 offset:16384
    v_mfma_f32_16x16x32_bf16 v[20:23], v[136:139], v[172:175], v[20:23]
    ds_read_b128 v[124:127], v180 offset:18432
    v_mfma_f32_16x16x32_bf16 v[24:27], v[140:143], v[152:155], v[24:27]
    ds_read_b128 v[128:131], v180 offset:20480
    v_mfma_f32_16x16x32_bf16 v[28:31], v[140:143], v[156:159], v[28:31]
    ds_read_b128 v[132:135], v180 offset:22528
    v_mfma_f32_16x16x32_bf16 v[32:35], v[140:143], v[160:163], v[32:35]
    ds_read_b64_tr_b16 v[100:101], v177 offset:32768
    v_mfma_f32_16x16x32_bf16 v[36:39], v[140:143], v[164:167], v[36:39]
    ds_read_b64_tr_b16 v[102:103], v177 offset:33792
    v_mfma_f32_16x16x32_bf16 v[40:43], v[140:143], v[168:171], v[40:43]
    ds_read_b64_tr_b16 v[104:105], v178 offset:32768
    v_mfma_f32_16x16x32_bf16 v[44:47], v[140:143], v[172:175], v[44:47]
    ds_read_b64_tr_b16 v[106:107], v178 offset:33792
    v_mfma_f32_16x16x32_bf16 v[48:51], v[144:147], v[152:155], v[48:51]
    ds_read_b64_tr_b16 v[108:109], v179 offset:32768
    v_mfma_f32_16x16x32_bf16 v[52:55], v[144:147], v[156:159], v[52:55]
    ds_read_b64_tr_b16 v[110:111], v179 offset:33792
    v_mfma_f32_16x16x32_bf16 v[56:59], v[144:147], v[160:163], v[56:59]
    v_mfma_f32_16x16x32_bf16 v[60:63], v[144:147], v[164:167], v[60:63]
    v_mfma_f32_16x16x32_bf16 v[64:67], v[144:147], v[168:171], v[64:67]
    v_mfma_f32_16x16x32_bf16 v[68:71], v[144:147], v[172:175], v[68:71]
    v_mfma_f32_16x16x32_bf16 v[72:75], v[148:151], v[152:155], v[72:75]
    v_mfma_f32_16x16x32_bf16 v[76:79], v[148:151], v[156:159], v[76:79]
    v_mfma_f32_16x16x32_bf16 v[80:83], v[148:151], v[160:163], v[80:83]
    v_mfma_f32_16x16x32_bf16 v[84:87], v[148:151], v[164:167], v[84:87]
    v_mfma_f32_16x16x32_bf16 v[88:91], v[148:151], v[168:171], v[88:91]
    v_mfma_f32_16x16x32_bf16 v[92:95], v[148:151], v[172:175], v[92:95]
    s_waitcnt lgkmcnt(0)
    s_barrier
    v_mfma_f32_16x16x32_bf16 v[0:3], v[96:99], v[112:115], v[0:3]
    ds_read_b128 v[152:155], v181 offset:12288
    v_mfma_f32_16x16x32_bf16 v[4:7], v[96:99], v[116:119], v[4:7]
    ds_read_b64_tr_b16 v[136:137], v176 offset:49152
    v_mfma_f32_16x16x32_bf16 v[8:11], v[96:99], v[120:123], v[8:11]
    ds_read_b64_tr_b16 v[138:139], v176 offset:50176
    v_mfma_f32_16x16x32_bf16 v[12:15], v[96:99], v[124:127], v[12:15]
    ds_read_b128 v[156:159], v181 offset:14336
    v_mfma_f32_16x16x32_bf16 v[16:19], v[96:99], v[128:131], v[16:19]
    ds_read_b128 v[160:163], v181 offset:16384
    v_mfma_f32_16x16x32_bf16 v[20:23], v[96:99], v[132:135], v[20:23]
    ds_read_b128 v[164:167], v181 offset:18432
    v_mfma_f32_16x16x32_bf16 v[24:27], v[100:103], v[112:115], v[24:27]
    ds_read_b128 v[168:171], v181 offset:20480
    v_mfma_f32_16x16x32_bf16 v[28:31], v[100:103], v[116:119], v[28:31]
    ds_read_b128 v[172:175], v181 offset:22528
    v_mfma_f32_16x16x32_bf16 v[32:35], v[100:103], v[120:123], v[32:35]
    ds_read_b64_tr_b16 v[140:141], v177 offset:49152
    v_mfma_f32_16x16x32_bf16 v[36:39], v[100:103], v[124:127], v[36:39]
    ds_read_b64_tr_b16 v[142:143], v177 offset:50176
    v_mfma_f32_16x16x32_bf16 v[40:43], v[100:103], v[128:131], v[40:43]
    ds_read_b64_tr_b16 v[144:145], v178 offset:49152
    v_mfma_f32_16x16x32_bf16 v[44:47], v[100:103], v[132:135], v[44:47]
    ds_read_b64_tr_b16 v[146:147], v178 offset:50176
    v_mfma_f32_16x16x32_bf16 v[48:51], v[104:107], v[112:115], v[48:51]
    ds_read_b64_tr_b16 v[148:149], v179 offset:49152
    v_mfma_f32_16x16x32_bf16 v[52:55], v[104:107], v[116:119], v[52:55]
    ds_read_b64_tr_b16 v[150:151], v179 offset:50176
    v_mfma_f32_16x16x32_bf16 v[56:59], v[104:107], v[120:123], v[56:59]
    v_mfma_f32_16x16x32_bf16 v[60:63], v[104:107], v[124:127], v[60:63]
    v_mfma_f32_16x16x32_bf16 v[64:67], v[104:107], v[128:131], v[64:67]
    v_mfma_f32_16x16x32_bf16 v[68:71], v[104:107], v[132:135], v[68:71]
    v_mfma_f32_16x16x32_bf16 v[72:75], v[108:111], v[112:115], v[72:75]
    v_mfma_f32_16x16x32_bf16 v[76:79], v[108:111], v[116:119], v[76:79]
    v_mfma_f32_16x16x32_bf16 v[80:83], v[108:111], v[120:123], v[80:83]
    v_mfma_f32_16x16x32_bf16 v[84:87], v[108:111], v[124:127], v[84:87]
    v_mfma_f32_16x16x32_bf16 v[88:91], v[108:111], v[128:131], v[88:91]
    v_mfma_f32_16x16x32_bf16 v[92:95], v[108:111], v[132:135], v[92:95]
    s_waitcnt lgkmcnt(0)
    s_barrier
    v_mfma_f32_16x16x32_bf16 v[0:3], v[136:139], v[152:155], v[0:3]
    ds_read_b128 v[112:115], v180 offset:24576
    v_mfma_f32_16x16x32_bf16 v[4:7], v[136:139], v[156:159], v[4:7]
    ds_read_b64_tr_b16 v[96:97], v176 offset:0
    v_mfma_f32_16x16x32_bf16 v[8:11], v[136:139], v[160:163], v[8:11]
    ds_read_b64_tr_b16 v[98:99], v176 offset:1024
    v_mfma_f32_16x16x32_bf16 v[12:15], v[136:139], v[164:167], v[12:15]
    ds_read_b128 v[116:119], v180 offset:26624
    v_mfma_f32_16x16x32_bf16 v[16:19], v[136:139], v[168:171], v[16:19]
    ds_read_b128 v[120:123], v180 offset:28672
    v_mfma_f32_16x16x32_bf16 v[20:23], v[136:139], v[172:175], v[20:23]
    ds_read_b128 v[124:127], v180 offset:30720
    v_mfma_f32_16x16x32_bf16 v[24:27], v[140:143], v[152:155], v[24:27]
    ds_read_b128 v[128:131], v180 offset:32768
    v_mfma_f32_16x16x32_bf16 v[28:31], v[140:143], v[156:159], v[28:31]
    ds_read_b128 v[132:135], v180 offset:34816
    v_mfma_f32_16x16x32_bf16 v[32:35], v[140:143], v[160:163], v[32:35]
    ds_read_b64_tr_b16 v[100:101], v177 offset:0
    v_mfma_f32_16x16x32_bf16 v[36:39], v[140:143], v[164:167], v[36:39]
    ds_read_b64_tr_b16 v[102:103], v177 offset:1024
    v_mfma_f32_16x16x32_bf16 v[40:43], v[140:143], v[168:171], v[40:43]
    ds_read_b64_tr_b16 v[104:105], v178 offset:0
    v_mfma_f32_16x16x32_bf16 v[44:47], v[140:143], v[172:175], v[44:47]
    ds_read_b64_tr_b16 v[106:107], v178 offset:1024
    v_mfma_f32_16x16x32_bf16 v[48:51], v[144:147], v[152:155], v[48:51]
    ds_read_b64_tr_b16 v[108:109], v179 offset:0
    v_mfma_f32_16x16x32_bf16 v[52:55], v[144:147], v[156:159], v[52:55]
    ds_read_b64_tr_b16 v[110:111], v179 offset:1024
    v_mfma_f32_16x16x32_bf16 v[56:59], v[144:147], v[160:163], v[56:59]
    v_mfma_f32_16x16x32_bf16 v[60:63], v[144:147], v[164:167], v[60:63]
    v_mfma_f32_16x16x32_bf16 v[64:67], v[144:147], v[168:171], v[64:67]
    v_mfma_f32_16x16x32_bf16 v[68:71], v[144:147], v[172:175], v[68:71]
    v_mfma_f32_16x16x32_bf16 v[72:75], v[148:151], v[152:155], v[72:75]
    v_mfma_f32_16x16x32_bf16 v[76:79], v[148:151], v[156:159], v[76:79]
    v_mfma_f32_16x16x32_bf16 v[80:83], v[148:151], v[160:163], v[80:83]
    v_mfma_f32_16x16x32_bf16 v[84:87], v[148:151], v[164:167], v[84:87]
    v_mfma_f32_16x16x32_bf16 v[88:91], v[148:151], v[168:171], v[88:91]
    v_mfma_f32_16x16x32_bf16 v[92:95], v[148:151], v[172:175], v[92:95]
    s_waitcnt lgkmcnt(0)
    s_barrier
    v_mfma_f32_16x16x32_bf16 v[0:3], v[96:99], v[112:115], v[0:3]
    ds_read_b128 v[152:155], v181 offset:24576
    v_mfma_f32_16x16x32_bf16 v[4:7], v[96:99], v[116:119], v[4:7]
    ds_read_b64_tr_b16 v[136:137], v176 offset:16384
    v_mfma_f32_16x16x32_bf16 v[8:11], v[96:99], v[120:123], v[8:11]
    ds_read_b64_tr_b16 v[138:139], v176 offset:17408
    v_mfma_f32_16x16x32_bf16 v[12:15], v[96:99], v[124:127], v[12:15]
    ds_read_b128 v[156:159], v181 offset:26624
    v_mfma_f32_16x16x32_bf16 v[16:19], v[96:99], v[128:131], v[16:19]
    ds_read_b128 v[160:163], v181 offset:28672
    v_mfma_f32_16x16x32_bf16 v[20:23], v[96:99], v[132:135], v[20:23]
    ds_read_b128 v[164:167], v181 offset:30720
    v_mfma_f32_16x16x32_bf16 v[24:27], v[100:103], v[112:115], v[24:27]
    ds_read_b128 v[168:171], v181 offset:32768
    v_mfma_f32_16x16x32_bf16 v[28:31], v[100:103], v[116:119], v[28:31]
    ds_read_b128 v[172:175], v181 offset:34816
    v_mfma_f32_16x16x32_bf16 v[32:35], v[100:103], v[120:123], v[32:35]
    ds_read_b64_tr_b16 v[140:141], v177 offset:16384
    v_mfma_f32_16x16x32_bf16 v[36:39], v[100:103], v[124:127], v[36:39]
    ds_read_b64_tr_b16 v[142:143], v177 offset:17408
    v_mfma_f32_16x16x32_bf16 v[40:43], v[100:103], v[128:131], v[40:43]
    ds_read_b64_tr_b16 v[144:145], v178 offset:16384
    v_mfma_f32_16x16x32_bf16 v[44:47], v[100:103], v[132:135], v[44:47]
    ds_read_b64_tr_b16 v[146:147], v178 offset:17408
    v_mfma_f32_16x16x32_bf16 v[48:51], v[104:107], v[112:115], v[48:51]
    ds_read_b64_tr_b16 v[148:149], v179 offset:16384
    v_mfma_f32_16x16x32_bf16 v[52:55], v[104:107], v[116:119], v[52:55]
    ds_read_b64_tr_b16 v[150:151], v179 offset:17408
    v_mfma_f32_16x16x32_bf16 v[56:59], v[104:107], v[120:123], v[56:59]
    v_mfma_f32_16x16x32_bf16 v[60:63], v[104:107], v[124:127], v[60:63]
    v_mfma_f32_16x16x32_bf16 v[64:67], v[104:107], v[128:131], v[64:67]
    v_mfma_f32_16x16x32_bf16 v[68:71], v[104:107], v[132:135], v[68:71]
    v_mfma_f32_16x16x32_bf16 v[72:75], v[108:111], v[112:115], v[72:75]
    v_mfma_f32_16x16x32_bf16 v[76:79], v[108:111], v[116:119], v[76:79]
    v_mfma_f32_16x16x32_bf16 v[80:83], v[108:111], v[120:123], v[80:83]
    v_mfma_f32_16x16x32_bf16 v[84:87], v[108:111], v[124:127], v[84:87]
    v_mfma_f32_16x16x32_bf16 v[88:91], v[108:111], v[128:131], v[88:91]
    v_mfma_f32_16x16x32_bf16 v[92:95], v[108:111], v[132:135], v[92:95]
    s_waitcnt lgkmcnt(0)
    s_barrier
    v_mfma_f32_16x16x32_bf16 v[0:3], v[136:139], v[152:155], v[0:3]
    ds_read_b128 v[112:115], v180 offset:0
    v_mfma_f32_16x16x32_bf16 v[4:7], v[136:139], v[156:159], v[4:7]
    ds_read_b64_tr_b16 v[96:97], v176 offset:32768
    v_mfma_f32_16x16x32_bf16 v[8:11], v[136:139], v[160:163], v[8:11]
    ds_read_b64_tr_b16 v[98:99], v176 offset:33792
    v_mfma_f32_16x16x32_bf16 v[12:15], v[136:139], v[164:167], v[12:15]
    ds_read_b128 v[116:119], v180 offset:2048
    v_mfma_f32_16x16x32_bf16 v[16:19], v[136:139], v[168:171], v[16:19]
    ds_read_b128 v[120:123], v180 offset:4096
    v_mfma_f32_16x16x32_bf16 v[20:23], v[136:139], v[172:175], v[20:23]
    ds_read_b128 v[124:127], v180 offset:6144
    v_mfma_f32_16x16x32_bf16 v[24:27], v[140:143], v[152:155], v[24:27]
    ds_read_b128 v[128:131], v180 offset:8192
    v_mfma_f32_16x16x32_bf16 v[28:31], v[140:143], v[156:159], v[28:31]
    ds_read_b128 v[132:135], v180 offset:10240
    v_mfma_f32_16x16x32_bf16 v[32:35], v[140:143], v[160:163], v[32:35]
    ds_read_b64_tr_b16 v[100:101], v177 offset:32768
    v_mfma_f32_16x16x32_bf16 v[36:39], v[140:143], v[164:167], v[36:39]
    ds_read_b64_tr_b16 v[102:103], v177 offset:33792
    v_mfma_f32_16x16x32_bf16 v[40:43], v[140:143], v[168:171], v[40:43]
    ds_read_b64_tr_b16 v[104:105], v178 offset:32768
    v_mfma_f32_16x16x32_bf16 v[44:47], v[140:143], v[172:175], v[44:47]
    ds_read_b64_tr_b16 v[106:107], v178 offset:33792
    v_mfma_f32_16x16x32_bf16 v[48:51], v[144:147], v[152:155], v[48:51]
    ds_read_b64_tr_b16 v[108:109], v179 offset:32768
    v_mfma_f32_16x16x32_bf16 v[52:55], v[144:147], v[156:159], v[52:55]
    ds_read_b64_tr_b16 v[110:111], v179 offset:33792
    v_mfma_f32_16x16x32_bf16 v[56:59], v[144:147], v[160:163], v[56:59]
    v_mfma_f32_16x16x32_bf16 v[60:63], v[144:147], v[164:167], v[60:63]
    v_mfma_f32_16x16x32_bf16 v[64:67], v[144:147], v[168:171], v[64:67]
    v_mfma_f32_16x16x32_bf16 v[68:71], v[144:147], v[172:175], v[68:71]
    v_mfma_f32_16x16x32_bf16 v[72:75], v[148:151], v[152:155], v[72:75]
    v_mfma_f32_16x16x32_bf16 v[76:79], v[148:151], v[156:159], v[76:79]
    v_mfma_f32_16x16x32_bf16 v[80:83], v[148:151], v[160:163], v[80:83]
    v_mfma_f32_16x16x32_bf16 v[84:87], v[148:151], v[164:167], v[84:87]
    v_mfma_f32_16x16x32_bf16 v[88:91], v[148:151], v[168:171], v[88:91]
    v_mfma_f32_16x16x32_bf16 v[92:95], v[148:151], v[172:175], v[92:95]
    s_waitcnt lgkmcnt(0)
    s_barrier
    v_mfma_f32_16x16x32_bf16 v[0:3], v[96:99], v[112:115], v[0:3]
    ds_read_b128 v[152:155], v181 offset:0
    v_mfma_f32_16x16x32_bf16 v[4:7], v[96:99], v[116:119], v[4:7]
    ds_read_b64_tr_b16 v[136:137], v176 offset:49152
    v_mfma_f32_16x16x32_bf16 v[8:11], v[96:99], v[120:123], v[8:11]
    ds_read_b64_tr_b16 v[138:139], v176 offset:50176
    v_mfma_f32_16x16x32_bf16 v[12:15], v[96:99], v[124:127], v[12:15]
    ds_read_b128 v[156:159], v181 offset:2048
    v_mfma_f32_16x16x32_bf16 v[16:19], v[96:99], v[128:131], v[16:19]
    ds_read_b128 v[160:163], v181 offset:4096
    v_mfma_f32_16x16x32_bf16 v[20:23], v[96:99], v[132:135], v[20:23]
    ds_read_b128 v[164:167], v181 offset:6144
    v_mfma_f32_16x16x32_bf16 v[24:27], v[100:103], v[112:115], v[24:27]
    ds_read_b128 v[168:171], v181 offset:8192
    v_mfma_f32_16x16x32_bf16 v[28:31], v[100:103], v[116:119], v[28:31]
    ds_read_b128 v[172:175], v181 offset:10240
    v_mfma_f32_16x16x32_bf16 v[32:35], v[100:103], v[120:123], v[32:35]
    ds_read_b64_tr_b16 v[140:141], v177 offset:49152
    v_mfma_f32_16x16x32_bf16 v[36:39], v[100:103], v[124:127], v[36:39]
    ds_read_b64_tr_b16 v[142:143], v177 offset:50176
    v_mfma_f32_16x16x32_bf16 v[40:43], v[100:103], v[128:131], v[40:43]
    ds_read_b64_tr_b16 v[144:145], v178 offset:49152
    v_mfma_f32_16x16x32_bf16 v[44:47], v[100:103], v[132:135], v[44:47]
    ds_read_b64_tr_b16 v[146:147], v178 offset:50176
    v_mfma_f32_16x16x32_bf16 v[48:51], v[104:107], v[112:115], v[48:51]
    ds_read_b64_tr_b16 v[148:149], v179 offset:49152
    v_mfma_f32_16x16x32_bf16 v[52:55], v[104:107], v[116:119], v[52:55]
    ds_read_b64_tr_b16 v[150:151], v179 offset:50176
    v_mfma_f32_16x16x32_bf16 v[56:59], v[104:107], v[120:123], v[56:59]
    v_mfma_f32_16x16x32_bf16 v[60:63], v[104:107], v[124:127], v[60:63]
    v_mfma_f32_16x16x32_bf16 v[64:67], v[104:107], v[128:131], v[64:67]
    v_mfma_f32_16x16x32_bf16 v[68:71], v[104:107], v[132:135], v[68:71]
    v_mfma_f32_16x16x32_bf16 v[72:75], v[108:111], v[112:115], v[72:75]
    v_mfma_f32_16x16x32_bf16 v[76:79], v[108:111], v[116:119], v[76:79]
    v_mfma_f32_16x16x32_bf16 v[80:83], v[108:111], v[120:123], v[80:83]
    v_mfma_f32_16x16x32_bf16 v[84:87], v[108:111], v[124:127], v[84:87]
    v_mfma_f32_16x16x32_bf16 v[88:91], v[108:111], v[128:131], v[88:91]
    v_mfma_f32_16x16x32_bf16 v[92:95], v[108:111], v[132:135], v[92:95]
    s_waitcnt lgkmcnt(0)
    s_barrier
    v_mfma_f32_16x16x32_bf16 v[0:3], v[136:139], v[152:155], v[0:3]
    ds_read_b128 v[112:115], v180 offset:12288
    v_mfma_f32_16x16x32_bf16 v[4:7], v[136:139], v[156:159], v[4:7]
    ds_read_b64_tr_b16 v[96:97], v176 offset:0
    v_mfma_f32_16x16x32_bf16 v[8:11], v[136:139], v[160:163], v[8:11]
    ds_read_b64_tr_b16 v[98:99], v176 offset:1024
    v_mfma_f32_16x16x32_bf16 v[12:15], v[136:139], v[164:167], v[12:15]
    ds_read_b128 v[116:119], v180 offset:14336
    v_mfma_f32_16x16x32_bf16 v[16:19], v[136:139], v[168:171], v[16:19]
    ds_read_b128 v[120:123], v180 offset:16384
    v_mfma_f32_16x16x32_bf16 v[20:23], v[136:139], v[172:175], v[20:23]
    ds_read_b128 v[124:127], v180 offset:18432
    v_mfma_f32_16x16x32_bf16 v[24:27], v[140:143], v[152:155], v[24:27]
    ds_read_b128 v[128:131], v180 offset:20480
    v_mfma_f32_16x16x32_bf16 v[28:31], v[140:143], v[156:159], v[28:31]
    ds_read_b128 v[132:135], v180 offset:22528
    v_mfma_f32_16x16x32_bf16 v[32:35], v[140:143], v[160:163], v[32:35]
    ds_read_b64_tr_b16 v[100:101], v177 offset:0
    v_mfma_f32_16x16x32_bf16 v[36:39], v[140:143], v[164:167], v[36:39]
    ds_read_b64_tr_b16 v[102:103], v177 offset:1024
    v_mfma_f32_16x16x32_bf16 v[40:43], v[140:143], v[168:171], v[40:43]
    ds_read_b64_tr_b16 v[104:105], v178 offset:0
    v_mfma_f32_16x16x32_bf16 v[44:47], v[140:143], v[172:175], v[44:47]
    ds_read_b64_tr_b16 v[106:107], v178 offset:1024
    v_mfma_f32_16x16x32_bf16 v[48:51], v[144:147], v[152:155], v[48:51]
    ds_read_b64_tr_b16 v[108:109], v179 offset:0
    v_mfma_f32_16x16x32_bf16 v[52:55], v[144:147], v[156:159], v[52:55]
    ds_read_b64_tr_b16 v[110:111], v179 offset:1024
    v_mfma_f32_16x16x32_bf16 v[56:59], v[144:147], v[160:163], v[56:59]
    v_mfma_f32_16x16x32_bf16 v[60:63], v[144:147], v[164:167], v[60:63]
    v_mfma_f32_16x16x32_bf16 v[64:67], v[144:147], v[168:171], v[64:67]
    v_mfma_f32_16x16x32_bf16 v[68:71], v[144:147], v[172:175], v[68:71]
    v_mfma_f32_16x16x32_bf16 v[72:75], v[148:151], v[152:155], v[72:75]
    v_mfma_f32_16x16x32_bf16 v[76:79], v[148:151], v[156:159], v[76:79]
    v_mfma_f32_16x16x32_bf16 v[80:83], v[148:151], v[160:163], v[80:83]
    v_mfma_f32_16x16x32_bf16 v[84:87], v[148:151], v[164:167], v[84:87]
    v_mfma_f32_16x16x32_bf16 v[88:91], v[148:151], v[168:171], v[88:91]
    v_mfma_f32_16x16x32_bf16 v[92:95], v[148:151], v[172:175], v[92:95]
    s_waitcnt lgkmcnt(0)
    s_barrier
    v_mfma_f32_16x16x32_bf16 v[0:3], v[96:99], v[112:115], v[0:3]
    ds_read_b128 v[152:155], v181 offset:12288
    v_mfma_f32_16x16x32_bf16 v[4:7], v[96:99], v[116:119], v[4:7]
    ds_read_b64_tr_b16 v[136:137], v176 offset:16384
    v_mfma_f32_16x16x32_bf16 v[8:11], v[96:99], v[120:123], v[8:11]
    ds_read_b64_tr_b16 v[138:139], v176 offset:17408
    v_mfma_f32_16x16x32_bf16 v[12:15], v[96:99], v[124:127], v[12:15]
    ds_read_b128 v[156:159], v181 offset:14336
    v_mfma_f32_16x16x32_bf16 v[16:19], v[96:99], v[128:131], v[16:19]
    ds_read_b128 v[160:163], v181 offset:16384
    v_mfma_f32_16x16x32_bf16 v[20:23], v[96:99], v[132:135], v[20:23]
    ds_read_b128 v[164:167], v181 offset:18432
    v_mfma_f32_16x16x32_bf16 v[24:27], v[100:103], v[112:115], v[24:27]
    ds_read_b128 v[168:171], v181 offset:20480
    v_mfma_f32_16x16x32_bf16 v[28:31], v[100:103], v[116:119], v[28:31]
    ds_read_b128 v[172:175], v181 offset:22528
    v_mfma_f32_16x16x32_bf16 v[32:35], v[100:103], v[120:123], v[32:35]
    ds_read_b64_tr_b16 v[140:141], v177 offset:16384
    v_mfma_f32_16x16x32_bf16 v[36:39], v[100:103], v[124:127], v[36:39]
    ds_read_b64_tr_b16 v[142:143], v177 offset:17408
    v_mfma_f32_16x16x32_bf16 v[40:43], v[100:103], v[128:131], v[40:43]
    ds_read_b64_tr_b16 v[144:145], v178 offset:16384
    v_mfma_f32_16x16x32_bf16 v[44:47], v[100:103], v[132:135], v[44:47]
    ds_read_b64_tr_b16 v[146:147], v178 offset:17408
    v_mfma_f32_16x16x32_bf16 v[48:51], v[104:107], v[112:115], v[48:51]
    ds_read_b64_tr_b16 v[148:149], v179 offset:16384
    v_mfma_f32_16x16x32_bf16 v[52:55], v[104:107], v[116:119], v[52:55]
    ds_read_b64_tr_b16 v[150:151], v179 offset:17408
    v_mfma_f32_16x16x32_bf16 v[56:59], v[104:107], v[120:123], v[56:59]
    v_mfma_f32_16x16x32_bf16 v[60:63], v[104:107], v[124:127], v[60:63]
    v_mfma_f32_16x16x32_bf16 v[64:67], v[104:107], v[128:131], v[64:67]
    v_mfma_f32_16x16x32_bf16 v[68:71], v[104:107], v[132:135], v[68:71]
    v_mfma_f32_16x16x32_bf16 v[72:75], v[108:111], v[112:115], v[72:75]
    v_mfma_f32_16x16x32_bf16 v[76:79], v[108:111], v[116:119], v[76:79]
    v_mfma_f32_16x16x32_bf16 v[80:83], v[108:111], v[120:123], v[80:83]
    v_mfma_f32_16x16x32_bf16 v[84:87], v[108:111], v[124:127], v[84:87]
    v_mfma_f32_16x16x32_bf16 v[88:91], v[108:111], v[128:131], v[88:91]
    v_mfma_f32_16x16x32_bf16 v[92:95], v[108:111], v[132:135], v[92:95]
    s_waitcnt lgkmcnt(0)
    s_barrier
    v_mfma_f32_16x16x32_bf16 v[0:3], v[136:139], v[152:155], v[0:3]
    ds_read_b128 v[112:115], v180 offset:24576
    v_mfma_f32_16x16x32_bf16 v[4:7], v[136:139], v[156:159], v[4:7]
    ds_read_b64_tr_b16 v[96:97], v176 offset:32768
    v_mfma_f32_16x16x32_bf16 v[8:11], v[136:139], v[160:163], v[8:11]
    ds_read_b64_tr_b16 v[98:99], v176 offset:33792
    v_mfma_f32_16x16x32_bf16 v[12:15], v[136:139], v[164:167], v[12:15]
    ds_read_b128 v[116:119], v180 offset:26624
    v_mfma_f32_16x16x32_bf16 v[16:19], v[136:139], v[168:171], v[16:19]
    ds_read_b128 v[120:123], v180 offset:28672
    v_mfma_f32_16x16x32_bf16 v[20:23], v[136:139], v[172:175], v[20:23]
    ds_read_b128 v[124:127], v180 offset:30720
    v_mfma_f32_16x16x32_bf16 v[24:27], v[140:143], v[152:155], v[24:27]
    ds_read_b128 v[128:131], v180 offset:32768
    v_mfma_f32_16x16x32_bf16 v[28:31], v[140:143], v[156:159], v[28:31]
    ds_read_b128 v[132:135], v180 offset:34816
    v_mfma_f32_16x16x32_bf16 v[32:35], v[140:143], v[160:163], v[32:35]
    ds_read_b64_tr_b16 v[100:101], v177 offset:32768
    v_mfma_f32_16x16x32_bf16 v[36:39], v[140:143], v[164:167], v[36:39]
    ds_read_b64_tr_b16 v[102:103], v177 offset:33792
    v_mfma_f32_16x16x32_bf16 v[40:43], v[140:143], v[168:171], v[40:43]
    ds_read_b64_tr_b16 v[104:105], v178 offset:32768
    v_mfma_f32_16x16x32_bf16 v[44:47], v[140:143], v[172:175], v[44:47]
    ds_read_b64_tr_b16 v[106:107], v178 offset:33792
    v_mfma_f32_16x16x32_bf16 v[48:51], v[144:147], v[152:155], v[48:51]
    ds_read_b64_tr_b16 v[108:109], v179 offset:32768
    v_mfma_f32_16x16x32_bf16 v[52:55], v[144:147], v[156:159], v[52:55]
    ds_read_b64_tr_b16 v[110:111], v179 offset:33792
    v_mfma_f32_16x16x32_bf16 v[56:59], v[144:147], v[160:163], v[56:59]
    v_mfma_f32_16x16x32_bf16 v[60:63], v[144:147], v[164:167], v[60:63]
    v_mfma_f32_16x16x32_bf16 v[64:67], v[144:147], v[168:171], v[64:67]
    v_mfma_f32_16x16x32_bf16 v[68:71], v[144:147], v[172:175], v[68:71]
    v_mfma_f32_16x16x32_bf16 v[72:75], v[148:151], v[152:155], v[72:75]
    v_mfma_f32_16x16x32_bf16 v[76:79], v[148:151], v[156:159], v[76:79]
    v_mfma_f32_16x16x32_bf16 v[80:83], v[148:151], v[160:163], v[80:83]
    v_mfma_f32_16x16x32_bf16 v[84:87], v[148:151], v[164:167], v[84:87]
    v_mfma_f32_16x16x32_bf16 v[88:91], v[148:151], v[168:171], v[88:91]
    v_mfma_f32_16x16x32_bf16 v[92:95], v[148:151], v[172:175], v[92:95]
    s_waitcnt lgkmcnt(0)
    s_barrier
    v_mfma_f32_16x16x32_bf16 v[0:3], v[96:99], v[112:115], v[0:3]
    ds_read_b128 v[152:155], v181 offset:24576
    v_mfma_f32_16x16x32_bf16 v[4:7], v[96:99], v[116:119], v[4:7]
    ds_read_b64_tr_b16 v[136:137], v176 offset:49152
    v_mfma_f32_16x16x32_bf16 v[8:11], v[96:99], v[120:123], v[8:11]
    ds_read_b64_tr_b16 v[138:139], v176 offset:50176
    v_mfma_f32_16x16x32_bf16 v[12:15], v[96:99], v[124:127], v[12:15]
    ds_read_b128 v[156:159], v181 offset:26624
    v_mfma_f32_16x16x32_bf16 v[16:19], v[96:99], v[128:131], v[16:19]
    ds_read_b128 v[160:163], v181 offset:28672
    v_mfma_f32_16x16x32_bf16 v[20:23], v[96:99], v[132:135], v[20:23]
    ds_read_b128 v[164:167], v181 offset:30720
    v_mfma_f32_16x16x32_bf16 v[24:27], v[100:103], v[112:115], v[24:27]
    ds_read_b128 v[168:171], v181 offset:32768
    v_mfma_f32_16x16x32_bf16 v[28:31], v[100:103], v[116:119], v[28:31]
    ds_read_b128 v[172:175], v181 offset:34816
    v_mfma_f32_16x16x32_bf16 v[32:35], v[100:103], v[120:123], v[32:35]
    ds_read_b64_tr_b16 v[140:141], v177 offset:49152
    v_mfma_f32_16x16x32_bf16 v[36:39], v[100:103], v[124:127], v[36:39]
    ds_read_b64_tr_b16 v[142:143], v177 offset:50176
    v_mfma_f32_16x16x32_bf16 v[40:43], v[100:103], v[128:131], v[40:43]
    ds_read_b64_tr_b16 v[144:145], v178 offset:49152
    v_mfma_f32_16x16x32_bf16 v[44:47], v[100:103], v[132:135], v[44:47]
    ds_read_b64_tr_b16 v[146:147], v178 offset:50176
    v_mfma_f32_16x16x32_bf16 v[48:51], v[104:107], v[112:115], v[48:51]
    ds_read_b64_tr_b16 v[148:149], v179 offset:49152
    v_mfma_f32_16x16x32_bf16 v[52:55], v[104:107], v[116:119], v[52:55]
    ds_read_b64_tr_b16 v[150:151], v179 offset:50176
    v_mfma_f32_16x16x32_bf16 v[56:59], v[104:107], v[120:123], v[56:59]
    v_mfma_f32_16x16x32_bf16 v[60:63], v[104:107], v[124:127], v[60:63]
    v_mfma_f32_16x16x32_bf16 v[64:67], v[104:107], v[128:131], v[64:67]
    v_mfma_f32_16x16x32_bf16 v[68:71], v[104:107], v[132:135], v[68:71]
    v_mfma_f32_16x16x32_bf16 v[72:75], v[108:111], v[112:115], v[72:75]
    v_mfma_f32_16x16x32_bf16 v[76:79], v[108:111], v[116:119], v[76:79]
    v_mfma_f32_16x16x32_bf16 v[80:83], v[108:111], v[120:123], v[80:83]
    v_mfma_f32_16x16x32_bf16 v[84:87], v[108:111], v[124:127], v[84:87]
    v_mfma_f32_16x16x32_bf16 v[88:91], v[108:111], v[128:131], v[88:91]
    v_mfma_f32_16x16x32_bf16 v[92:95], v[108:111], v[132:135], v[92:95]
    s_waitcnt lgkmcnt(0)
    s_barrier
    v_mfma_f32_16x16x32_bf16 v[0:3], v[136:139], v[152:155], v[0:3]
    ds_read_b128 v[112:115], v180 offset:0
    v_mfma_f32_16x16x32_bf16 v[4:7], v[136:139], v[156:159], v[4:7]
    ds_read_b64_tr_b16 v[96:97], v176 offset:0
    v_mfma_f32_16x16x32_bf16 v[8:11], v[136:139], v[160:163], v[8:11]
    ds_read_b64_tr_b16 v[98:99], v176 offset:1024
    v_mfma_f32_16x16x32_bf16 v[12:15], v[136:139], v[164:167], v[12:15]
    ds_read_b128 v[116:119], v180 offset:2048
    v_mfma_f32_16x16x32_bf16 v[16:19], v[136:139], v[168:171], v[16:19]
    ds_read_b128 v[120:123], v180 offset:4096
    v_mfma_f32_16x16x32_bf16 v[20:23], v[136:139], v[172:175], v[20:23]
    ds_read_b128 v[124:127], v180 offset:6144
    v_mfma_f32_16x16x32_bf16 v[24:27], v[140:143], v[152:155], v[24:27]
    ds_read_b128 v[128:131], v180 offset:8192
    v_mfma_f32_16x16x32_bf16 v[28:31], v[140:143], v[156:159], v[28:31]
    ds_read_b128 v[132:135], v180 offset:10240
    v_mfma_f32_16x16x32_bf16 v[32:35], v[140:143], v[160:163], v[32:35]
    ds_read_b64_tr_b16 v[100:101], v177 offset:0
    v_mfma_f32_16x16x32_bf16 v[36:39], v[140:143], v[164:167], v[36:39]
    ds_read_b64_tr_b16 v[102:103], v177 offset:1024
    v_mfma_f32_16x16x32_bf16 v[40:43], v[140:143], v[168:171], v[40:43]
    ds_read_b64_tr_b16 v[104:105], v178 offset:0
    v_mfma_f32_16x16x32_bf16 v[44:47], v[140:143], v[172:175], v[44:47]
    ds_read_b64_tr_b16 v[106:107], v178 offset:1024
    v_mfma_f32_16x16x32_bf16 v[48:51], v[144:147], v[152:155], v[48:51]
    ds_read_b64_tr_b16 v[108:109], v179 offset:0
    v_mfma_f32_16x16x32_bf16 v[52:55], v[144:147], v[156:159], v[52:55]
    ds_read_b64_tr_b16 v[110:111], v179 offset:1024
    v_mfma_f32_16x16x32_bf16 v[56:59], v[144:147], v[160:163], v[56:59]
    v_mfma_f32_16x16x32_bf16 v[60:63], v[144:147], v[164:167], v[60:63]
    v_mfma_f32_16x16x32_bf16 v[64:67], v[144:147], v[168:171], v[64:67]
    v_mfma_f32_16x16x32_bf16 v[68:71], v[144:147], v[172:175], v[68:71]
    v_mfma_f32_16x16x32_bf16 v[72:75], v[148:151], v[152:155], v[72:75]
    v_mfma_f32_16x16x32_bf16 v[76:79], v[148:151], v[156:159], v[76:79]
    v_mfma_f32_16x16x32_bf16 v[80:83], v[148:151], v[160:163], v[80:83]
    v_mfma_f32_16x16x32_bf16 v[84:87], v[148:151], v[164:167], v[84:87]
    v_mfma_f32_16x16x32_bf16 v[88:91], v[148:151], v[168:171], v[88:91]
    v_mfma_f32_16x16x32_bf16 v[92:95], v[148:151], v[172:175], v[92:95]
    s_waitcnt lgkmcnt(0)
    s_barrier
    v_mfma_f32_16x16x32_bf16 v[0:3], v[96:99], v[112:115], v[0:3]
    ds_read_b128 v[152:155], v181 offset:0
    v_mfma_f32_16x16x32_bf16 v[4:7], v[96:99], v[116:119], v[4:7]
    ds_read_b64_tr_b16 v[136:137], v176 offset:16384
    v_mfma_f32_16x16x32_bf16 v[8:11], v[96:99], v[120:123], v[8:11]
    ds_read_b64_tr_b16 v[138:139], v176 offset:17408
    v_mfma_f32_16x16x32_bf16 v[12:15], v[96:99], v[124:127], v[12:15]
    ds_read_b128 v[156:159], v181 offset:2048
    v_mfma_f32_16x16x32_bf16 v[16:19], v[96:99], v[128:131], v[16:19]
    ds_read_b128 v[160:163], v181 offset:4096
    v_mfma_f32_16x16x32_bf16 v[20:23], v[96:99], v[132:135], v[20:23]
    ds_read_b128 v[164:167], v181 offset:6144
    v_mfma_f32_16x16x32_bf16 v[24:27], v[100:103], v[112:115], v[24:27]
    ds_read_b128 v[168:171], v181 offset:8192
    v_mfma_f32_16x16x32_bf16 v[28:31], v[100:103], v[116:119], v[28:31]
    ds_read_b128 v[172:175], v181 offset:10240
    v_mfma_f32_16x16x32_bf16 v[32:35], v[100:103], v[120:123], v[32:35]
    ds_read_b64_tr_b16 v[140:141], v177 offset:16384
    v_mfma_f32_16x16x32_bf16 v[36:39], v[100:103], v[124:127], v[36:39]
    ds_read_b64_tr_b16 v[142:143], v177 offset:17408
    v_mfma_f32_16x16x32_bf16 v[40:43], v[100:103], v[128:131], v[40:43]
    ds_read_b64_tr_b16 v[144:145], v178 offset:16384
    v_mfma_f32_16x16x32_bf16 v[44:47], v[100:103], v[132:135], v[44:47]
    ds_read_b64_tr_b16 v[146:147], v178 offset:17408
    v_mfma_f32_16x16x32_bf16 v[48:51], v[104:107], v[112:115], v[48:51]
    ds_read_b64_tr_b16 v[148:149], v179 offset:16384
    v_mfma_f32_16x16x32_bf16 v[52:55], v[104:107], v[116:119], v[52:55]
    ds_read_b64_tr_b16 v[150:151], v179 offset:17408
    v_mfma_f32_16x16x32_bf16 v[56:59], v[104:107], v[120:123], v[56:59]
    v_mfma_f32_16x16x32_bf16 v[60:63], v[104:107], v[124:127], v[60:63]
    v_mfma_f32_16x16x32_bf16 v[64:67], v[104:107], v[128:131], v[64:67]
    v_mfma_f32_16x16x32_bf16 v[68:71], v[104:107], v[132:135], v[68:71]
    v_mfma_f32_16x16x32_bf16 v[72:75], v[108:111], v[112:115], v[72:75]
    v_mfma_f32_16x16x32_bf16 v[76:79], v[108:111], v[116:119], v[76:79]
    v_mfma_f32_16x16x32_bf16 v[80:83], v[108:111], v[120:123], v[80:83]
    v_mfma_f32_16x16x32_bf16 v[84:87], v[108:111], v[124:127], v[84:87]
    v_mfma_f32_16x16x32_bf16 v[88:91], v[108:111], v[128:131], v[88:91]
    v_mfma_f32_16x16x32_bf16 v[92:95], v[108:111], v[132:135], v[92:95]
    s_waitcnt lgkmcnt(0)
    s_barrier
    v_mfma_f32_16x16x32_bf16 v[0:3], v[136:139], v[152:155], v[0:3]
    ds_read_b128 v[112:115], v180 offset:12288
    v_mfma_f32_16x16x32_bf16 v[4:7], v[136:139], v[156:159], v[4:7]
    ds_read_b64_tr_b16 v[96:97], v176 offset:32768
    v_mfma_f32_16x16x32_bf16 v[8:11], v[136:139], v[160:163], v[8:11]
    ds_read_b64_tr_b16 v[98:99], v176 offset:33792
    v_mfma_f32_16x16x32_bf16 v[12:15], v[136:139], v[164:167], v[12:15]
    ds_read_b128 v[116:119], v180 offset:14336
    v_mfma_f32_16x16x32_bf16 v[16:19], v[136:139], v[168:171], v[16:19]
    ds_read_b128 v[120:123], v180 offset:16384
    v_mfma_f32_16x16x32_bf16 v[20:23], v[136:139], v[172:175], v[20:23]
    ds_read_b128 v[124:127], v180 offset:18432
    v_mfma_f32_16x16x32_bf16 v[24:27], v[140:143], v[152:155], v[24:27]
    ds_read_b128 v[128:131], v180 offset:20480
    v_mfma_f32_16x16x32_bf16 v[28:31], v[140:143], v[156:159], v[28:31]
    ds_read_b128 v[132:135], v180 offset:22528
    v_mfma_f32_16x16x32_bf16 v[32:35], v[140:143], v[160:163], v[32:35]
    ds_read_b64_tr_b16 v[100:101], v177 offset:32768
    v_mfma_f32_16x16x32_bf16 v[36:39], v[140:143], v[164:167], v[36:39]
    ds_read_b64_tr_b16 v[102:103], v177 offset:33792
    v_mfma_f32_16x16x32_bf16 v[40:43], v[140:143], v[168:171], v[40:43]
    ds_read_b64_tr_b16 v[104:105], v178 offset:32768
    v_mfma_f32_16x16x32_bf16 v[44:47], v[140:143], v[172:175], v[44:47]
    ds_read_b64_tr_b16 v[106:107], v178 offset:33792
    v_mfma_f32_16x16x32_bf16 v[48:51], v[144:147], v[152:155], v[48:51]
    ds_read_b64_tr_b16 v[108:109], v179 offset:32768
    v_mfma_f32_16x16x32_bf16 v[52:55], v[144:147], v[156:159], v[52:55]
    ds_read_b64_tr_b16 v[110:111], v179 offset:33792
    v_mfma_f32_16x16x32_bf16 v[56:59], v[144:147], v[160:163], v[56:59]
    v_mfma_f32_16x16x32_bf16 v[60:63], v[144:147], v[164:167], v[60:63]
    v_mfma_f32_16x16x32_bf16 v[64:67], v[144:147], v[168:171], v[64:67]
    v_mfma_f32_16x16x32_bf16 v[68:71], v[144:147], v[172:175], v[68:71]
    v_mfma_f32_16x16x32_bf16 v[72:75], v[148:151], v[152:155], v[72:75]
    v_mfma_f32_16x16x32_bf16 v[76:79], v[148:151], v[156:159], v[76:79]
    v_mfma_f32_16x16x32_bf16 v[80:83], v[148:151], v[160:163], v[80:83]
    v_mfma_f32_16x16x32_bf16 v[84:87], v[148:151], v[164:167], v[84:87]
    v_mfma_f32_16x16x32_bf16 v[88:91], v[148:151], v[168:171], v[88:91]
    v_mfma_f32_16x16x32_bf16 v[92:95], v[148:151], v[172:175], v[92:95]
    s_waitcnt lgkmcnt(0)
    s_barrier
    v_mfma_f32_16x16x32_bf16 v[0:3], v[96:99], v[112:115], v[0:3]
    ds_read_b128 v[152:155], v181 offset:12288
    v_mfma_f32_16x16x32_bf16 v[4:7], v[96:99], v[116:119], v[4:7]
    ds_read_b64_tr_b16 v[136:137], v176 offset:49152
    v_mfma_f32_16x16x32_bf16 v[8:11], v[96:99], v[120:123], v[8:11]
    ds_read_b64_tr_b16 v[138:139], v176 offset:50176
    v_mfma_f32_16x16x32_bf16 v[12:15], v[96:99], v[124:127], v[12:15]
    ds_read_b128 v[156:159], v181 offset:14336
    v_mfma_f32_16x16x32_bf16 v[16:19], v[96:99], v[128:131], v[16:19]
    ds_read_b128 v[160:163], v181 offset:16384
    v_mfma_f32_16x16x32_bf16 v[20:23], v[96:99], v[132:135], v[20:23]
    ds_read_b128 v[164:167], v181 offset:18432
    v_mfma_f32_16x16x32_bf16 v[24:27], v[100:103], v[112:115], v[24:27]
    ds_read_b128 v[168:171], v181 offset:20480
    v_mfma_f32_16x16x32_bf16 v[28:31], v[100:103], v[116:119], v[28:31]
    ds_read_b128 v[172:175], v181 offset:22528
    v_mfma_f32_16x16x32_bf16 v[32:35], v[100:103], v[120:123], v[32:35]
    ds_read_b64_tr_b16 v[140:141], v177 offset:49152
    v_mfma_f32_16x16x32_bf16 v[36:39], v[100:103], v[124:127], v[36:39]
    ds_read_b64_tr_b16 v[142:143], v177 offset:50176
    v_mfma_f32_16x16x32_bf16 v[40:43], v[100:103], v[128:131], v[40:43]
    ds_read_b64_tr_b16 v[144:145], v178 offset:49152
    v_mfma_f32_16x16x32_bf16 v[44:47], v[100:103], v[132:135], v[44:47]
    ds_read_b64_tr_b16 v[146:147], v178 offset:50176
    v_mfma_f32_16x16x32_bf16 v[48:51], v[104:107], v[112:115], v[48:51]
    ds_read_b64_tr_b16 v[148:149], v179 offset:49152
    v_mfma_f32_16x16x32_bf16 v[52:55], v[104:107], v[116:119], v[52:55]
    ds_read_b64_tr_b16 v[150:151], v179 offset:50176
    v_mfma_f32_16x16x32_bf16 v[56:59], v[104:107], v[120:123], v[56:59]
    v_mfma_f32_16x16x32_bf16 v[60:63], v[104:107], v[124:127], v[60:63]
    v_mfma_f32_16x16x32_bf16 v[64:67], v[104:107], v[128:131], v[64:67]
    v_mfma_f32_16x16x32_bf16 v[68:71], v[104:107], v[132:135], v[68:71]
    v_mfma_f32_16x16x32_bf16 v[72:75], v[108:111], v[112:115], v[72:75]
    v_mfma_f32_16x16x32_bf16 v[76:79], v[108:111], v[116:119], v[76:79]
    v_mfma_f32_16x16x32_bf16 v[80:83], v[108:111], v[120:123], v[80:83]
    v_mfma_f32_16x16x32_bf16 v[84:87], v[108:111], v[124:127], v[84:87]
    v_mfma_f32_16x16x32_bf16 v[88:91], v[108:111], v[128:131], v[88:91]
    v_mfma_f32_16x16x32_bf16 v[92:95], v[108:111], v[132:135], v[92:95]
    s_waitcnt lgkmcnt(0)
    s_barrier
    v_mfma_f32_16x16x32_bf16 v[0:3], v[136:139], v[152:155], v[0:3]
    ds_read_b128 v[112:115], v180 offset:24576
    v_mfma_f32_16x16x32_bf16 v[4:7], v[136:139], v[156:159], v[4:7]
    ds_read_b64_tr_b16 v[96:97], v176 offset:0
    v_mfma_f32_16x16x32_bf16 v[8:11], v[136:139], v[160:163], v[8:11]
    ds_read_b64_tr_b16 v[98:99], v176 offset:1024
    v_mfma_f32_16x16x32_bf16 v[12:15], v[136:139], v[164:167], v[12:15]
    ds_read_b128 v[116:119], v180 offset:26624
    v_mfma_f32_16x16x32_bf16 v[16:19], v[136:139], v[168:171], v[16:19]
    ds_read_b128 v[120:123], v180 offset:28672
    v_mfma_f32_16x16x32_bf16 v[20:23], v[136:139], v[172:175], v[20:23]
    ds_read_b128 v[124:127], v180 offset:30720
    v_mfma_f32_16x16x32_bf16 v[24:27], v[140:143], v[152:155], v[24:27]
    ds_read_b128 v[128:131], v180 offset:32768
    v_mfma_f32_16x16x32_bf16 v[28:31], v[140:143], v[156:159], v[28:31]
    ds_read_b128 v[132:135], v180 offset:34816
    v_mfma_f32_16x16x32_bf16 v[32:35], v[140:143], v[160:163], v[32:35]
    ds_read_b64_tr_b16 v[100:101], v177 offset:0
    v_mfma_f32_16x16x32_bf16 v[36:39], v[140:143], v[164:167], v[36:39]
    ds_read_b64_tr_b16 v[102:103], v177 offset:1024
    v_mfma_f32_16x16x32_bf16 v[40:43], v[140:143], v[168:171], v[40:43]
    ds_read_b64_tr_b16 v[104:105], v178 offset:0
    v_mfma_f32_16x16x32_bf16 v[44:47], v[140:143], v[172:175], v[44:47]
    ds_read_b64_tr_b16 v[106:107], v178 offset:1024
    v_mfma_f32_16x16x32_bf16 v[48:51], v[144:147], v[152:155], v[48:51]
    ds_read_b64_tr_b16 v[108:109], v179 offset:0
    v_mfma_f32_16x16x32_bf16 v[52:55], v[144:147], v[156:159], v[52:55]
    ds_read_b64_tr_b16 v[110:111], v179 offset:1024
    v_mfma_f32_16x16x32_bf16 v[56:59], v[144:147], v[160:163], v[56:59]
    v_mfma_f32_16x16x32_bf16 v[60:63], v[144:147], v[164:167], v[60:63]
    v_mfma_f32_16x16x32_bf16 v[64:67], v[144:147], v[168:171], v[64:67]
    v_mfma_f32_16x16x32_bf16 v[68:71], v[144:147], v[172:175], v[68:71]
    v_mfma_f32_16x16x32_bf16 v[72:75], v[148:151], v[152:155], v[72:75]
    v_mfma_f32_16x16x32_bf16 v[76:79], v[148:151], v[156:159], v[76:79]
    v_mfma_f32_16x16x32_bf16 v[80:83], v[148:151], v[160:163], v[80:83]
    v_mfma_f32_16x16x32_bf16 v[84:87], v[148:151], v[164:167], v[84:87]
    v_mfma_f32_16x16x32_bf16 v[88:91], v[148:151], v[168:171], v[88:91]
    v_mfma_f32_16x16x32_bf16 v[92:95], v[148:151], v[172:175], v[92:95]
    s_waitcnt lgkmcnt(0)
    s_barrier
    v_mfma_f32_16x16x32_bf16 v[0:3], v[96:99], v[112:115], v[0:3]
    ds_read_b128 v[152:155], v181 offset:24576
    v_mfma_f32_16x16x32_bf16 v[4:7], v[96:99], v[116:119], v[4:7]
    ds_read_b64_tr_b16 v[136:137], v176 offset:16384
    v_mfma_f32_16x16x32_bf16 v[8:11], v[96:99], v[120:123], v[8:11]
    ds_read_b64_tr_b16 v[138:139], v176 offset:17408
    v_mfma_f32_16x16x32_bf16 v[12:15], v[96:99], v[124:127], v[12:15]
    ds_read_b128 v[156:159], v181 offset:26624
    v_mfma_f32_16x16x32_bf16 v[16:19], v[96:99], v[128:131], v[16:19]
    ds_read_b128 v[160:163], v181 offset:28672
    v_mfma_f32_16x16x32_bf16 v[20:23], v[96:99], v[132:135], v[20:23]
    ds_read_b128 v[164:167], v181 offset:30720
    v_mfma_f32_16x16x32_bf16 v[24:27], v[100:103], v[112:115], v[24:27]
    ds_read_b128 v[168:171], v181 offset:32768
    v_mfma_f32_16x16x32_bf16 v[28:31], v[100:103], v[116:119], v[28:31]
    ds_read_b128 v[172:175], v181 offset:34816
    v_mfma_f32_16x16x32_bf16 v[32:35], v[100:103], v[120:123], v[32:35]
    ds_read_b64_tr_b16 v[140:141], v177 offset:16384
    v_mfma_f32_16x16x32_bf16 v[36:39], v[100:103], v[124:127], v[36:39]
    ds_read_b64_tr_b16 v[142:143], v177 offset:17408
    v_mfma_f32_16x16x32_bf16 v[40:43], v[100:103], v[128:131], v[40:43]
    ds_read_b64_tr_b16 v[144:145], v178 offset:16384
    v_mfma_f32_16x16x32_bf16 v[44:47], v[100:103], v[132:135], v[44:47]
    ds_read_b64_tr_b16 v[146:147], v178 offset:17408
    v_mfma_f32_16x16x32_bf16 v[48:51], v[104:107], v[112:115], v[48:51]
    ds_read_b64_tr_b16 v[148:149], v179 offset:16384
    v_mfma_f32_16x16x32_bf16 v[52:55], v[104:107], v[116:119], v[52:55]
    ds_read_b64_tr_b16 v[150:151], v179 offset:17408
    v_mfma_f32_16x16x32_bf16 v[56:59], v[104:107], v[120:123], v[56:59]
    v_mfma_f32_16x16x32_bf16 v[60:63], v[104:107], v[124:127], v[60:63]
    v_mfma_f32_16x16x32_bf16 v[64:67], v[104:107], v[128:131], v[64:67]
    v_mfma_f32_16x16x32_bf16 v[68:71], v[104:107], v[132:135], v[68:71]
    v_mfma_f32_16x16x32_bf16 v[72:75], v[108:111], v[112:115], v[72:75]
    v_mfma_f32_16x16x32_bf16 v[76:79], v[108:111], v[116:119], v[76:79]
    v_mfma_f32_16x16x32_bf16 v[80:83], v[108:111], v[120:123], v[80:83]
    v_mfma_f32_16x16x32_bf16 v[84:87], v[108:111], v[124:127], v[84:87]
    v_mfma_f32_16x16x32_bf16 v[88:91], v[108:111], v[128:131], v[88:91]
    v_mfma_f32_16x16x32_bf16 v[92:95], v[108:111], v[132:135], v[92:95]
    s_waitcnt lgkmcnt(0)
    s_barrier
    v_mfma_f32_16x16x32_bf16 v[0:3], v[136:139], v[152:155], v[0:3]
    ds_read_b128 v[112:115], v180 offset:0
    v_mfma_f32_16x16x32_bf16 v[4:7], v[136:139], v[156:159], v[4:7]
    ds_read_b64_tr_b16 v[96:97], v176 offset:32768
    v_mfma_f32_16x16x32_bf16 v[8:11], v[136:139], v[160:163], v[8:11]
    ds_read_b64_tr_b16 v[98:99], v176 offset:33792
    v_mfma_f32_16x16x32_bf16 v[12:15], v[136:139], v[164:167], v[12:15]
    ds_read_b128 v[116:119], v180 offset:2048
    v_mfma_f32_16x16x32_bf16 v[16:19], v[136:139], v[168:171], v[16:19]
    ds_read_b128 v[120:123], v180 offset:4096
    v_mfma_f32_16x16x32_bf16 v[20:23], v[136:139], v[172:175], v[20:23]
    ds_read_b128 v[124:127], v180 offset:6144
    v_mfma_f32_16x16x32_bf16 v[24:27], v[140:143], v[152:155], v[24:27]
    ds_read_b128 v[128:131], v180 offset:8192
    v_mfma_f32_16x16x32_bf16 v[28:31], v[140:143], v[156:159], v[28:31]
    ds_read_b128 v[132:135], v180 offset:10240
    v_mfma_f32_16x16x32_bf16 v[32:35], v[140:143], v[160:163], v[32:35]
    ds_read_b64_tr_b16 v[100:101], v177 offset:32768
    v_mfma_f32_16x16x32_bf16 v[36:39], v[140:143], v[164:167], v[36:39]
    ds_read_b64_tr_b16 v[102:103], v177 offset:33792
    v_mfma_f32_16x16x32_bf16 v[40:43], v[140:143], v[168:171], v[40:43]
    ds_read_b64_tr_b16 v[104:105], v178 offset:32768
    v_mfma_f32_16x16x32_bf16 v[44:47], v[140:143], v[172:175], v[44:47]
    ds_read_b64_tr_b16 v[106:107], v178 offset:33792
    v_mfma_f32_16x16x32_bf16 v[48:51], v[144:147], v[152:155], v[48:51]
    ds_read_b64_tr_b16 v[108:109], v179 offset:32768
    v_mfma_f32_16x16x32_bf16 v[52:55], v[144:147], v[156:159], v[52:55]
    ds_read_b64_tr_b16 v[110:111], v179 offset:33792
    v_mfma_f32_16x16x32_bf16 v[56:59], v[144:147], v[160:163], v[56:59]
    v_mfma_f32_16x16x32_bf16 v[60:63], v[144:147], v[164:167], v[60:63]
    v_mfma_f32_16x16x32_bf16 v[64:67], v[144:147], v[168:171], v[64:67]
    v_mfma_f32_16x16x32_bf16 v[68:71], v[144:147], v[172:175], v[68:71]
    v_mfma_f32_16x16x32_bf16 v[72:75], v[148:151], v[152:155], v[72:75]
    v_mfma_f32_16x16x32_bf16 v[76:79], v[148:151], v[156:159], v[76:79]
    v_mfma_f32_16x16x32_bf16 v[80:83], v[148:151], v[160:163], v[80:83]
    v_mfma_f32_16x16x32_bf16 v[84:87], v[148:151], v[164:167], v[84:87]
    v_mfma_f32_16x16x32_bf16 v[88:91], v[148:151], v[168:171], v[88:91]
    v_mfma_f32_16x16x32_bf16 v[92:95], v[148:151], v[172:175], v[92:95]
    s_waitcnt lgkmcnt(0)
    s_barrier
    v_mfma_f32_16x16x32_bf16 v[0:3], v[96:99], v[112:115], v[0:3]
    ds_read_b128 v[152:155], v181 offset:0
    v_mfma_f32_16x16x32_bf16 v[4:7], v[96:99], v[116:119], v[4:7]
    ds_read_b64_tr_b16 v[136:137], v176 offset:49152
    v_mfma_f32_16x16x32_bf16 v[8:11], v[96:99], v[120:123], v[8:11]
    ds_read_b64_tr_b16 v[138:139], v176 offset:50176
    v_mfma_f32_16x16x32_bf16 v[12:15], v[96:99], v[124:127], v[12:15]
    ds_read_b128 v[156:159], v181 offset:2048
    v_mfma_f32_16x16x32_bf16 v[16:19], v[96:99], v[128:131], v[16:19]
    ds_read_b128 v[160:163], v181 offset:4096
    v_mfma_f32_16x16x32_bf16 v[20:23], v[96:99], v[132:135], v[20:23]
    ds_read_b128 v[164:167], v181 offset:6144
    v_mfma_f32_16x16x32_bf16 v[24:27], v[100:103], v[112:115], v[24:27]
    ds_read_b128 v[168:171], v181 offset:8192
    v_mfma_f32_16x16x32_bf16 v[28:31], v[100:103], v[116:119], v[28:31]
    ds_read_b128 v[172:175], v181 offset:10240
    v_mfma_f32_16x16x32_bf16 v[32:35], v[100:103], v[120:123], v[32:35]
    ds_read_b64_tr_b16 v[140:141], v177 offset:49152
    v_mfma_f32_16x16x32_bf16 v[36:39], v[100:103], v[124:127], v[36:39]
    ds_read_b64_tr_b16 v[142:143], v177 offset:50176
    v_mfma_f32_16x16x32_bf16 v[40:43], v[100:103], v[128:131], v[40:43]
    ds_read_b64_tr_b16 v[144:145], v178 offset:49152
    v_mfma_f32_16x16x32_bf16 v[44:47], v[100:103], v[132:135], v[44:47]
    ds_read_b64_tr_b16 v[146:147], v178 offset:50176
    v_mfma_f32_16x16x32_bf16 v[48:51], v[104:107], v[112:115], v[48:51]
    ds_read_b64_tr_b16 v[148:149], v179 offset:49152
    v_mfma_f32_16x16x32_bf16 v[52:55], v[104:107], v[116:119], v[52:55]
    ds_read_b64_tr_b16 v[150:151], v179 offset:50176
    v_mfma_f32_16x16x32_bf16 v[56:59], v[104:107], v[120:123], v[56:59]
    v_mfma_f32_16x16x32_bf16 v[60:63], v[104:107], v[124:127], v[60:63]
    v_mfma_f32_16x16x32_bf16 v[64:67], v[104:107], v[128:131], v[64:67]
    v_mfma_f32_16x16x32_bf16 v[68:71], v[104:107], v[132:135], v[68:71]
    v_mfma_f32_16x16x32_bf16 v[72:75], v[108:111], v[112:115], v[72:75]
    v_mfma_f32_16x16x32_bf16 v[76:79], v[108:111], v[116:119], v[76:79]
    v_mfma_f32_16x16x32_bf16 v[80:83], v[108:111], v[120:123], v[80:83]
    v_mfma_f32_16x16x32_bf16 v[84:87], v[108:111], v[124:127], v[84:87]
    v_mfma_f32_16x16x32_bf16 v[88:91], v[108:111], v[128:131], v[88:91]
    v_mfma_f32_16x16x32_bf16 v[92:95], v[108:111], v[132:135], v[92:95]
    s_waitcnt lgkmcnt(0)
    s_barrier
    s_and_b32 s46, s3, 1
    s_lshl_b32 s46, s46, 3
    v_lshrrev_b32 v252, 1, v250
    v_or_b32 v252, s46, v252
    v_xor_b32 v252, v252, v251
    v_lshlrev_b32 v252, 4, v252
    v_and_b32 v253, 1, v250
    v_lshl_add_u32 v252, v253, 3, v252
    v_lshl_add_u32 v252, v251, 9, v252
    s_bfe_u32 s47, s3, 0x10001
    s_lshl_b32 s47, s47, 8
    s_add_u32 s47, s47, 114688
    v_add_u32 v252, s47, v252
    v_xor_b32 v253, 32, v252
    v_xor_b32 v254, 64, v252
    v_xor_b32 v255, 0x60, v252
    v_mfma_f32_16x16x32_bf16 v[0:3], v[136:139], v[152:155], v[0:3]
    v_mfma_f32_16x16x32_bf16 v[4:7], v[136:139], v[156:159], v[4:7]
    v_mfma_f32_16x16x32_bf16 v[8:11], v[136:139], v[160:163], v[8:11]
    v_mfma_f32_16x16x32_bf16 v[12:15], v[136:139], v[164:167], v[12:15]
    v_mfma_f32_16x16x32_bf16 v[16:19], v[136:139], v[168:171], v[16:19]
    v_mfma_f32_16x16x32_bf16 v[20:23], v[136:139], v[172:175], v[20:23]
    v_mfma_f32_16x16x32_bf16 v[24:27], v[140:143], v[152:155], v[24:27]
    v_mfma_f32_16x16x32_bf16 v[28:31], v[140:143], v[156:159], v[28:31]
    v_mfma_f32_16x16x32_bf16 v[32:35], v[140:143], v[160:163], v[32:35]
    v_cvt_pk_bf16_f32 v0, v0, v1
    v_cvt_pk_bf16_f32 v1, v2, v3
    ds_write_b64 v252, v[0:1] offset:0
    v_mfma_f32_16x16x32_bf16 v[36:39], v[140:143], v[164:167], v[36:39]
    v_cvt_pk_bf16_f32 v4, v4, v5
    v_cvt_pk_bf16_f32 v5, v6, v7
    ds_write_b64 v252, v[4:5] offset:8192
    v_mfma_f32_16x16x32_bf16 v[40:43], v[140:143], v[168:171], v[40:43]
    v_cvt_pk_bf16_f32 v8, v8, v9
    v_cvt_pk_bf16_f32 v9, v10, v11
    ds_write_b64 v252, v[8:9] offset:16384
    v_mfma_f32_16x16x32_bf16 v[44:47], v[140:143], v[172:175], v[44:47]
    v_cvt_pk_bf16_f32 v12, v12, v13
    v_cvt_pk_bf16_f32 v13, v14, v15
    ds_write_b64 v252, v[12:13] offset:24576
    v_mfma_f32_16x16x32_bf16 v[48:51], v[144:147], v[152:155], v[48:51]
    v_cvt_pk_bf16_f32 v16, v16, v17
    v_cvt_pk_bf16_f32 v17, v18, v19
    ds_write_b64 v252, v[16:17] offset:32768
    v_mfma_f32_16x16x32_bf16 v[52:55], v[144:147], v[156:159], v[52:55]
    v_cvt_pk_bf16_f32 v20, v20, v21
    v_cvt_pk_bf16_f32 v21, v22, v23
    ds_write_b64 v252, v[20:21] offset:40960
    v_mfma_f32_16x16x32_bf16 v[56:59], v[144:147], v[160:163], v[56:59]
    v_cvt_pk_bf16_f32 v24, v24, v25
    v_cvt_pk_bf16_f32 v25, v26, v27
    ds_write_b64 v253, v[24:25] offset:0
    v_mfma_f32_16x16x32_bf16 v[60:63], v[144:147], v[164:167], v[60:63]
    v_cvt_pk_bf16_f32 v28, v28, v29
    v_cvt_pk_bf16_f32 v29, v30, v31
    ds_write_b64 v253, v[28:29] offset:8192
    v_mfma_f32_16x16x32_bf16 v[64:67], v[144:147], v[168:171], v[64:67]
    v_cvt_pk_bf16_f32 v32, v32, v33
    v_cvt_pk_bf16_f32 v33, v34, v35
    ds_write_b64 v253, v[32:33] offset:16384
    v_mfma_f32_16x16x32_bf16 v[68:71], v[144:147], v[172:175], v[68:71]
    v_cvt_pk_bf16_f32 v36, v36, v37
    v_cvt_pk_bf16_f32 v37, v38, v39
    ds_write_b64 v253, v[36:37] offset:24576
    v_mfma_f32_16x16x32_bf16 v[72:75], v[148:151], v[152:155], v[72:75]
    v_cvt_pk_bf16_f32 v40, v40, v41
    v_cvt_pk_bf16_f32 v41, v42, v43
    ds_write_b64 v253, v[40:41] offset:32768
    v_mfma_f32_16x16x32_bf16 v[76:79], v[148:151], v[156:159], v[76:79]
    v_cvt_pk_bf16_f32 v44, v44, v45
    v_cvt_pk_bf16_f32 v45, v46, v47
    ds_write_b64 v253, v[44:45] offset:40960
    v_mfma_f32_16x16x32_bf16 v[80:83], v[148:151], v[160:163], v[80:83]
    v_cvt_pk_bf16_f32 v48, v48, v49
    v_cvt_pk_bf16_f32 v49, v50, v51
    ds_write_b64 v254, v[48:49] offset:0
    v_mfma_f32_16x16x32_bf16 v[84:87], v[148:151], v[164:167], v[84:87]
    v_cvt_pk_bf16_f32 v52, v52, v53
    v_cvt_pk_bf16_f32 v53, v54, v55
    ds_write_b64 v254, v[52:53] offset:8192
    v_mfma_f32_16x16x32_bf16 v[88:91], v[148:151], v[168:171], v[88:91]
    v_cvt_pk_bf16_f32 v56, v56, v57
    v_cvt_pk_bf16_f32 v57, v58, v59
    ds_write_b64 v254, v[56:57] offset:16384
    v_mfma_f32_16x16x32_bf16 v[92:95], v[148:151], v[172:175], v[92:95]
    v_cvt_pk_bf16_f32 v60, v60, v61
    v_cvt_pk_bf16_f32 v61, v62, v63
    ds_write_b64 v254, v[60:61] offset:24576
    s_nop 1
    v_cvt_pk_bf16_f32 v64, v64, v65
    v_cvt_pk_bf16_f32 v65, v66, v67
    ds_write_b64 v254, v[64:65] offset:32768
    v_cvt_pk_bf16_f32 v68, v68, v69
    v_cvt_pk_bf16_f32 v69, v70, v71
    ds_write_b64 v254, v[68:69] offset:40960
    v_cvt_pk_bf16_f32 v72, v72, v73
    v_cvt_pk_bf16_f32 v73, v74, v75
    ds_write_b64 v255, v[72:73] offset:0
    v_cvt_pk_bf16_f32 v76, v76, v77
    v_cvt_pk_bf16_f32 v77, v78, v79
    ds_write_b64 v255, v[76:77] offset:8192
    v_cvt_pk_bf16_f32 v80, v80, v81
    v_cvt_pk_bf16_f32 v81, v82, v83
    ds_write_b64 v255, v[80:81] offset:16384
    v_cvt_pk_bf16_f32 v84, v84, v85
    v_cvt_pk_bf16_f32 v85, v86, v87
    ds_write_b64 v255, v[84:85] offset:24576
    v_cvt_pk_bf16_f32 v88, v88, v89
    v_cvt_pk_bf16_f32 v89, v90, v91
    ds_write_b64 v255, v[88:89] offset:32768
    v_cvt_pk_bf16_f32 v92, v92, v93
    v_cvt_pk_bf16_f32 v93, v94, v95
    ds_write_b64 v255, v[92:93] offset:40960
    s_waitcnt lgkmcnt(0)
    s_barrier
L_attn:
    s_lshl_b32 s46, s3, 13
    s_add_u32 s46, s46, 114688
    v_lshlrev_b32 v252, 8, v251
    v_add_u32 v252, s46, v252
    v_add_u32 v253, v252, v224
    ds_read_b128 v[144:147], v253 offset:0
    ds_read_b128 v[128:131], v253 offset:256
    v_add_u32 v253, v252, v225
    ds_read_b128 v[148:151], v253 offset:0
    ds_read_b128 v[132:135], v253 offset:256
    v_add_u32 v253, v252, v226
    ds_read_b128 v[152:155], v253 offset:0
    ds_read_b128 v[136:139], v253 offset:256
    v_add_u32 v253, v252, v227
    ds_read_b128 v[156:159], v253 offset:0
    ds_read_b128 v[140:143], v253 offset:256
    s_lshl_b32 s46, s3, 11
    s_add_u32 s46, s46, 20480
    v_lshlrev_b32 v255, 4, v249
    v_add_u32 v255, s46, v255
    s_waitcnt lgkmcnt(0)
    s_barrier
    ds_read_b128 v[176:179], v224 offset:0
    ds_read_b128 v[180:183], v225 offset:0
    ds_read_b128 v[184:187], v226 offset:0
    ds_read_b128 v[188:191], v227 offset:0
    ds_read_b128 v[192:195], v224 offset:4096
    ds_read_b128 v[196:199], v225 offset:4096
    ds_read_b128 v[200:203], v226 offset:4096
    ds_read_b128 v[204:207], v227 offset:4096
    ds_read_b128 v[208:211], v224 offset:8192
    ds_read_b128 v[212:215], v225 offset:8192
    ds_read_b128 v[216:219], v226 offset:8192
    s_waitcnt lgkmcnt(10)
    v_mfma_f32_16x16x32_bf16 v[0:3], v[176:179], v[144:147], 0
    ds_read_b128 v[220:223], v227 offset:8192
    s_waitcnt lgkmcnt(10)
    v_mfma_f32_16x16x32_bf16 v[0:3], v[180:183], v[148:151], v[0:3]
    ds_read_b128 v[176:179], v224 offset:12288
    s_waitcnt lgkmcnt(10)
    v_mfma_f32_16x16x32_bf16 v[0:3], v[184:187], v[152:155], v[0:3]
    ds_read_b128 v[180:183], v225 offset:12288
    s_waitcnt lgkmcnt(10)
    v_mfma_f32_16x16x32_bf16 v[0:3], v[188:191], v[156:159], v[0:3]
    ds_read_b128 v[184:187], v226 offset:12288
    s_waitcnt lgkmcnt(10)
    v_mfma_f32_16x16x32_bf16 v[4:7], v[192:195], v[144:147], 0
    ds_read_b128 v[188:191], v227 offset:12288
    s_waitcnt lgkmcnt(10)
    v_mfma_f32_16x16x32_bf16 v[4:7], v[196:199], v[148:151], v[4:7]
    s_barrier
    ds_read_b128 v[192:195], v224 offset:16384
    s_waitcnt lgkmcnt(10)
    v_mfma_f32_16x16x32_bf16 v[4:7], v[200:203], v[152:155], v[4:7]
    ds_read_b128 v[196:199], v225 offset:16384
    s_waitcnt lgkmcnt(10)
    v_mfma_f32_16x16x32_bf16 v[4:7], v[204:207], v[156:159], v[4:7]
    ds_read_b128 v[200:203], v226 offset:16384
    s_waitcnt lgkmcnt(10)
    v_mfma_f32_16x16x32_bf16 v[8:11], v[208:211], v[144:147], 0
    ds_read_b128 v[204:207], v227 offset:16384
    s_waitcnt lgkmcnt(10)
    v_mfma_f32_16x16x32_bf16 v[8:11], v[212:215], v[148:151], v[8:11]
    ds_read_b128 v[208:211], v224 offset:20480
    s_waitcnt lgkmcnt(10)
    v_mfma_f32_16x16x32_bf16 v[8:11], v[216:219], v[152:155], v[8:11]
    ds_read_b128 v[212:215], v225 offset:20480
    s_waitcnt lgkmcnt(10)
    v_mfma_f32_16x16x32_bf16 v[8:11], v[220:223], v[156:159], v[8:11]
    v_max3_f32 v244, v0, v1, v2
    v_max_f32 v244, v244, v3
    ds_read_b128 v[216:219], v226 offset:20480
    s_waitcnt lgkmcnt(10)
    v_mfma_f32_16x16x32_bf16 v[12:15], v[176:179], v[144:147], 0
    ds_read_b128 v[220:223], v227 offset:20480
    s_waitcnt lgkmcnt(10)
    v_mfma_f32_16x16x32_bf16 v[12:15], v[180:183], v[148:151], v[12:15]
    ds_read_b128 v[176:179], v224 offset:24576
    s_waitcnt lgkmcnt(10)
    v_mfma_f32_16x16x32_bf16 v[12:15], v[184:187], v[152:155], v[12:15]
    ds_read_b128 v[180:183], v225 offset:24576
    s_waitcnt lgkmcnt(10)
    v_mfma_f32_16x16x32_bf16 v[12:15], v[188:191], v[156:159], v[12:15]
    v_max3_f32 v245, v4, v5, v6
    v_max_f32 v245, v245, v7
    ds_read_b128 v[184:187], v226 offset:24576
    s_waitcnt lgkmcnt(10)
    v_mfma_f32_16x16x32_bf16 v[16:19], v[192:195], v[144:147], 0
    ds_read_b128 v[188:191], v227 offset:24576
    s_waitcnt lgkmcnt(10)
    v_mfma_f32_16x16x32_bf16 v[16:19], v[196:199], v[148:151], v[16:19]
    ds_read_b128 v[192:195], v224 offset:28672
    s_waitcnt lgkmcnt(10)
    v_mfma_f32_16x16x32_bf16 v[16:19], v[200:203], v[152:155], v[16:19]
    ds_read_b128 v[196:199], v225 offset:28672
    s_waitcnt lgkmcnt(10)
    v_mfma_f32_16x16x32_bf16 v[16:19], v[204:207], v[156:159], v[16:19]
    v_max3_f32 v244, v244, v8, v9
    v_max3_f32 v244, v244, v10, v11
    ds_read_b128 v[200:203], v226 offset:28672
    s_waitcnt lgkmcnt(10)
    v_mfma_f32_16x16x32_bf16 v[20:23], v[208:211], v[144:147], 0
    ds_read_b128 v[204:207], v227 offset:28672
    s_waitcnt lgkmcnt(10)
    v_mfma_f32_16x16x32_bf16 v[20:23], v[212:215], v[148:151], v[20:23]
    s_barrier
    ds_read_b128 v[208:211], v224 offset:32768
    s_waitcnt lgkmcnt(10)
    v_mfma_f32_16x16x32_bf16 v[20:23], v[216:219], v[152:155], v[20:23]
    ds_read_b128 v[212:215], v225 offset:32768
    s_waitcnt lgkmcnt(10)
    v_mfma_f32_16x16x32_bf16 v[20:23], v[220:223], v[156:159], v[20:23]
    v_max3_f32 v245, v245, v12, v13
    v_max3_f32 v245, v245, v14, v15
    ds_read_b128 v[216:219], v226 offset:32768
    s_waitcnt lgkmcnt(10)
    v_mfma_f32_16x16x32_bf16 v[24:27], v[176:179], v[144:147], 0
    ds_read_b128 v[220:223], v227 offset:32768
    s_waitcnt lgkmcnt(10)
    v_mfma_f32_16x16x32_bf16 v[24:27], v[180:183], v[148:151], v[24:27]
    ds_read_b128 v[176:179], v224 offset:36864
    s_waitcnt lgkmcnt(10)
    v_mfma_f32_16x16x32_bf16 v[24:27], v[184:187], v[152:155], v[24:27]
    ds_read_b128 v[180:183], v225 offset:36864
    s_waitcnt lgkmcnt(10)
    v_mfma_f32_16x16x32_bf16 v[24:27], v[188:191], v[156:159], v[24:27]
    v_max3_f32 v244, v244, v16, v17
    v_max3_f32 v244, v244, v18, v19
    ds_read_b128 v[184:187], v226 offset:36864
    s_waitcnt lgkmcnt(10)
    v_mfma_f32_16x16x32_bf16 v[28:31], v[192:195], v[144:147], 0
    ds_read_b128 v[188:191], v227 offset:36864
    s_waitcnt lgkmcnt(10)
    v_mfma_f32_16x16x32_bf16 v[28:31], v[196:199], v[148:151], v[28:31]
    ds_read_b128 v[192:195], v224 offset:40960
    s_waitcnt lgkmcnt(10)
    v_mfma_f32_16x16x32_bf16 v[28:31], v[200:203], v[152:155], v[28:31]
    ds_read_b128 v[196:199], v225 offset:40960
    s_waitcnt lgkmcnt(10)
    v_mfma_f32_16x16x32_bf16 v[28:31], v[204:207], v[156:159], v[28:31]
    v_max3_f32 v245, v245, v20, v21
    v_max3_f32 v245, v245, v22, v23
    ds_read_b128 v[200:203], v226 offset:40960
    s_waitcnt lgkmcnt(10)
    v_mfma_f32_16x16x32_bf16 v[32:35], v[208:211], v[144:147], 0
    ds_read_b128 v[204:207], v227 offset:40960
    s_waitcnt lgkmcnt(10)
    v_mfma_f32_16x16x32_bf16 v[32:35], v[212:215], v[148:151], v[32:35]
    ds_read_b128 v[208:211], v224 offset:45056
    s_waitcnt lgkmcnt(10)
    v_mfma_f32_16x16x32_bf16 v[32:35], v[216:219], v[152:155], v[32:35]
    ds_read_b128 v[212:215], v225 offset:45056
    s_waitcnt lgkmcnt(10)
    v_mfma_f32_16x16x32_bf16 v[32:35], v[220:223], v[156:159], v[32:35]
    v_max3_f32 v244, v244, v24, v25
    v_max3_f32 v244, v244, v26, v27
    ds_read_b128 v[216:219], v226 offset:45056
    s_waitcnt lgkmcnt(10)
    v_mfma_f32_16x16x32_bf16 v[36:39], v[176:179], v[144:147], 0
    ds_read_b128 v[220:223], v227 offset:45056
    s_waitcnt lgkmcnt(10)
    v_mfma_f32_16x16x32_bf16 v[36:39], v[180:183], v[148:151], v[36:39]
    s_barrier
    ds_read_b128 v[176:179], v224 offset:49152
    s_waitcnt lgkmcnt(10)
    v_mfma_f32_16x16x32_bf16 v[36:39], v[184:187], v[152:155], v[36:39]
    ds_read_b128 v[180:183], v225 offset:49152
    s_waitcnt lgkmcnt(10)
    v_mfma_f32_16x16x32_bf16 v[36:39], v[188:191], v[156:159], v[36:39]
    v_max3_f32 v245, v245, v28, v29
    v_max3_f32 v245, v245, v30, v31
    ds_read_b128 v[184:187], v226 offset:49152
    s_waitcnt lgkmcnt(10)
    v_mfma_f32_16x16x32_bf16 v[40:43], v[192:195], v[144:147], 0
    ds_read_b128 v[188:191], v227 offset:49152
    s_waitcnt lgkmcnt(10)
    v_mfma_f32_16x16x32_bf16 v[40:43], v[196:199], v[148:151], v[40:43]
    ds_read_b128 v[192:195], v224 offset:53248
    s_waitcnt lgkmcnt(10)
    v_mfma_f32_16x16x32_bf16 v[40:43], v[200:203], v[152:155], v[40:43]
    ds_read_b128 v[196:199], v225 offset:53248
    s_waitcnt lgkmcnt(10)
    v_mfma_f32_16x16x32_bf16 v[40:43], v[204:207], v[156:159], v[40:43]
    v_max3_f32 v244, v244, v32, v33
    v_max3_f32 v244, v244, v34, v35
    ds_read_b128 v[200:203], v226 offset:53248
    s_waitcnt lgkmcnt(10)
    v_mfma_f32_16x16x32_bf16 v[44:47], v[208:211], v[144:147], 0
    ds_read_b128 v[204:207], v227 offset:53248
    s_waitcnt lgkmcnt(10)
    v_mfma_f32_16x16x32_bf16 v[44:47], v[212:215], v[148:151], v[44:47]
    ds_read_b128 v[208:211], v224 offset:57344
    s_waitcnt lgkmcnt(10)
    v_mfma_f32_16x16x32_bf16 v[44:47], v[216:219], v[152:155], v[44:47]
    ds_read_b128 v[212:215], v225 offset:57344
    s_waitcnt lgkmcnt(10)
    v_mfma_f32_16x16x32_bf16 v[44:47], v[220:223], v[156:159], v[44:47]
    v_max3_f32 v245, v245, v36, v37
    v_max3_f32 v245, v245, v38, v39
    ds_read_b128 v[216:219], v226 offset:57344
    s_waitcnt lgkmcnt(10)
    v_mfma_f32_16x16x32_bf16 v[48:51], v[176:179], v[144:147], 0
    ds_read_b128 v[220:223], v227 offset:57344
    s_waitcnt lgkmcnt(10)
    v_mfma_f32_16x16x32_bf16 v[48:51], v[180:183], v[148:151], v[48:51]
    ds_read_b128 v[176:179], v224 offset:61440
    s_waitcnt lgkmcnt(10)
    v_mfma_f32_16x16x32_bf16 v[48:51], v[184:187], v[152:155], v[48:51]
    ds_read_b128 v[180:183], v225 offset:61440
    s_waitcnt lgkmcnt(10)
    v_mfma_f32_16x16x32_bf16 v[48:51], v[188:191], v[156:159], v[48:51]
    v_max3_f32 v244, v244, v40, v41
    v_max3_f32 v244, v244, v42, v43
    ds_read_b128 v[184:187], v226 offset:61440
    s_waitcnt lgkmcnt(10)
    v_mfma_f32_16x16x32_bf16 v[52:55], v[192:195], v[144:147], 0
    ds_read_b128 v[188:191], v227 offset:61440
    s_waitcnt lgkmcnt(10)
    v_mfma_f32_16x16x32_bf16 v[52:55], v[196:199], v[148:151], v[52:55]
    s_barrier
    ds_read_b128 v[192:195], v224 offset:0
    s_waitcnt lgkmcnt(10)
    v_mfma_f32_16x16x32_bf16 v[52:55], v[200:203], v[152:155], v[52:55]
    ds_read_b128 v[196:199], v225 offset:0
    s_waitcnt lgkmcnt(10)
    v_mfma_f32_16x16x32_bf16 v[52:55], v[204:207], v[156:159], v[52:55]
    v_max3_f32 v245, v245, v44, v45
    v_max3_f32 v245, v245, v46, v47
    ds_read_b128 v[200:203], v226 offset:0
    s_waitcnt lgkmcnt(10)
    v_mfma_f32_16x16x32_bf16 v[56:59], v[208:211], v[144:147], 0
    ds_read_b128 v[204:207], v227 offset:0
    s_waitcnt lgkmcnt(10)
    v_mfma_f32_16x16x32_bf16 v[56:59], v[212:215], v[148:151], v[56:59]
    ds_read_b128 v[208:211], v224 offset:4096
    s_waitcnt lgkmcnt(10)
    v_mfma_f32_16x16x32_bf16 v[56:59], v[216:219], v[152:155], v[56:59]
    ds_read_b128 v[212:215], v225 offset:4096
    s_waitcnt lgkmcnt(10)
    v_mfma_f32_16x16x32_bf16 v[56:59], v[220:223], v[156:159], v[56:59]
    v_max3_f32 v244, v244, v48, v49
    v_max3_f32 v244, v244, v50, v51
    ds_read_b128 v[216:219], v226 offset:4096
    s_waitcnt lgkmcnt(10)
    v_mfma_f32_16x16x32_bf16 v[60:63], v[176:179], v[144:147], 0
    ds_read_b128 v[220:223], v227 offset:4096
    s_waitcnt lgkmcnt(10)
    v_mfma_f32_16x16x32_bf16 v[60:63], v[180:183], v[148:151], v[60:63]
    ds_read_b128 v[176:179], v224 offset:8192
    s_waitcnt lgkmcnt(10)
    v_mfma_f32_16x16x32_bf16 v[60:63], v[184:187], v[152:155], v[60:63]
    ds_read_b128 v[180:183], v225 offset:8192
    s_waitcnt lgkmcnt(10)
    v_mfma_f32_16x16x32_bf16 v[60:63], v[188:191], v[156:159], v[60:63]
    v_max3_f32 v245, v245, v52, v53
    v_max3_f32 v245, v245, v54, v55
    ds_read_b128 v[184:187], v226 offset:8192
    s_waitcnt lgkmcnt(10)
    v_mfma_f32_16x16x32_bf16 v[64:67], v[192:195], v[144:147], 0
    ds_read_b128 v[188:191], v227 offset:8192
    s_waitcnt lgkmcnt(10)
    v_mfma_f32_16x16x32_bf16 v[64:67], v[196:199], v[148:151], v[64:67]
    ds_read_b128 v[192:195], v224 offset:12288
    s_waitcnt lgkmcnt(10)
    v_mfma_f32_16x16x32_bf16 v[64:67], v[200:203], v[152:155], v[64:67]
    ds_read_b128 v[196:199], v225 offset:12288
    s_waitcnt lgkmcnt(10)
    v_mfma_f32_16x16x32_bf16 v[64:67], v[204:207], v[156:159], v[64:67]
    v_max3_f32 v244, v244, v56, v57
    v_max3_f32 v244, v244, v58, v59
    ds_read_b128 v[200:203], v226 offset:12288
    s_waitcnt lgkmcnt(10)
    v_mfma_f32_16x16x32_bf16 v[68:71], v[208:211], v[144:147], 0
    ds_read_b128 v[204:207], v227 offset:12288
    s_waitcnt lgkmcnt(10)
    v_mfma_f32_16x16x32_bf16 v[68:71], v[212:215], v[148:151], v[68:71]
    s_barrier
    ds_read_b128 v[208:211], v224 offset:16384
    s_waitcnt lgkmcnt(10)
    v_mfma_f32_16x16x32_bf16 v[68:71], v[216:219], v[152:155], v[68:71]
    ds_read_b128 v[212:215], v225 offset:16384
    s_waitcnt lgkmcnt(10)
    v_mfma_f32_16x16x32_bf16 v[68:71], v[220:223], v[156:159], v[68:71]
    v_max3_f32 v245, v245, v60, v61
    v_max3_f32 v245, v245, v62, v63
    ds_read_b128 v[216:219], v226 offset:16384
    s_waitcnt lgkmcnt(10)
    v_mfma_f32_16x16x32_bf16 v[72:75], v[176:179], v[144:147], 0
    ds_read_b128 v[220:223], v227 offset:16384
    s_waitcnt lgkmcnt(10)
    v_mfma_f32_16x16x32_bf16 v[72:75], v[180:183], v[148:151], v[72:75]
    ds_read_b128 v[176:179], v224 offset:20480
    s_waitcnt lgkmcnt(10)
    v_mfma_f32_16x16x32_bf16 v[72:75], v[184:187], v[152:155], v[72:75]
    ds_read_b128 v[180:183], v225 offset:20480
    s_waitcnt lgkmcnt(10)
    v_mfma_f32_16x16x32_bf16 v[72:75], v[188:191], v[156:159], v[72:75]
    v_max3_f32 v244, v244, v64, v65
    v_max3_f32 v244, v244, v66, v67
    ds_read_b128 v[184:187], v226 offset:20480
    s_waitcnt lgkmcnt(10)
    v_mfma_f32_16x16x32_bf16 v[76:79], v[192:195], v[144:147], 0
    ds_read_b128 v[188:191], v227 offset:20480
    s_waitcnt lgkmcnt(10)
    v_mfma_f32_16x16x32_bf16 v[76:79], v[196:199], v[148:151], v[76:79]
    ds_read_b128 v[192:195], v224 offset:24576
    s_waitcnt lgkmcnt(10)
    v_mfma_f32_16x16x32_bf16 v[76:79], v[200:203], v[152:155], v[76:79]
    ds_read_b128 v[196:199], v225 offset:24576
    s_waitcnt lgkmcnt(10)
    v_mfma_f32_16x16x32_bf16 v[76:79], v[204:207], v[156:159], v[76:79]
    v_max3_f32 v245, v245, v68, v69
    v_max3_f32 v245, v245, v70, v71
    ds_read_b128 v[200:203], v226 offset:24576
    s_waitcnt lgkmcnt(10)
    v_mfma_f32_16x16x32_bf16 v[80:83], v[208:211], v[144:147], 0
    ds_read_b128 v[204:207], v227 offset:24576
    s_waitcnt lgkmcnt(10)
    v_mfma_f32_16x16x32_bf16 v[80:83], v[212:215], v[148:151], v[80:83]
    ds_read_b128 v[208:211], v224 offset:28672
    s_waitcnt lgkmcnt(10)
    v_mfma_f32_16x16x32_bf16 v[80:83], v[216:219], v[152:155], v[80:83]
    ds_read_b128 v[212:215], v225 offset:28672
    s_waitcnt lgkmcnt(10)
    v_mfma_f32_16x16x32_bf16 v[80:83], v[220:223], v[156:159], v[80:83]
    v_max3_f32 v244, v244, v72, v73
    v_max3_f32 v244, v244, v74, v75
    ds_read_b128 v[216:219], v226 offset:28672
    s_waitcnt lgkmcnt(10)
    v_mfma_f32_16x16x32_bf16 v[84:87], v[176:179], v[144:147], 0
    ds_read_b128 v[220:223], v227 offset:28672
    s_waitcnt lgkmcnt(10)
    v_mfma_f32_16x16x32_bf16 v[84:87], v[180:183], v[148:151], v[84:87]
    s_barrier
    ds_read_b128 v[176:179], v224 offset:32768
    s_waitcnt lgkmcnt(10)
    v_mfma_f32_16x16x32_bf16 v[84:87], v[184:187], v[152:155], v[84:87]
    ds_read_b128 v[180:183], v225 offset:32768
    s_waitcnt lgkmcnt(10)
    v_mfma_f32_16x16x32_bf16 v[84:87], v[188:191], v[156:159], v[84:87]
    v_max3_f32 v245, v245, v76, v77
    v_max3_f32 v245, v245, v78, v79
    ds_read_b128 v[184:187], v226 offset:32768
    s_waitcnt lgkmcnt(10)
    v_mfma_f32_16x16x32_bf16 v[88:91], v[192:195], v[144:147], 0
    ds_read_b128 v[188:191], v227 offset:32768
    s_waitcnt lgkmcnt(10)
    v_mfma_f32_16x16x32_bf16 v[88:91], v[196:199], v[148:151], v[88:91]
    ds_read_b128 v[192:195], v224 offset:36864
    s_waitcnt lgkmcnt(10)
    v_mfma_f32_16x16x32_bf16 v[88:91], v[200:203], v[152:155], v[88:91]
    ds_read_b128 v[196:199], v225 offset:36864
    s_waitcnt lgkmcnt(10)
    v_mfma_f32_16x16x32_bf16 v[88:91], v[204:207], v[156:159], v[88:91]
    v_max3_f32 v244, v244, v80, v81
    v_max3_f32 v244, v244, v82, v83
    ds_read_b128 v[200:203], v226 offset:36864
    s_waitcnt lgkmcnt(10)
    v_mfma_f32_16x16x32_bf16 v[92:95], v[208:211], v[144:147], 0
    ds_read_b128 v[204:207], v227 offset:36864
    s_waitcnt lgkmcnt(10)
    v_mfma_f32_16x16x32_bf16 v[92:95], v[212:215], v[148:151], v[92:95]
    ds_read_b128 v[208:211], v224 offset:40960
    s_waitcnt lgkmcnt(10)
    v_mfma_f32_16x16x32_bf16 v[92:95], v[216:219], v[152:155], v[92:95]
    ds_read_b128 v[212:215], v225 offset:40960
    s_waitcnt lgkmcnt(10)
    v_mfma_f32_16x16x32_bf16 v[92:95], v[220:223], v[156:159], v[92:95]
    v_max3_f32 v245, v245, v84, v85
    v_max3_f32 v245, v245, v86, v87
    ds_read_b128 v[216:219], v226 offset:40960
    s_waitcnt lgkmcnt(10)
    v_mfma_f32_16x16x32_bf16 v[96:99], v[176:179], v[144:147], 0
    ds_read_b128 v[220:223], v227 offset:40960
    s_waitcnt lgkmcnt(10)
    v_mfma_f32_16x16x32_bf16 v[96:99], v[180:183], v[148:151], v[96:99]
    ds_read_b128 v[176:179], v224 offset:45056
    s_waitcnt lgkmcnt(10)
    v_mfma_f32_16x16x32_bf16 v[96:99], v[184:187], v[152:155], v[96:99]
    ds_read_b128 v[180:183], v225 offset:45056
    s_waitcnt lgkmcnt(10)
    v_mfma_f32_16x16x32_bf16 v[96:99], v[188:191], v[156:159], v[96:99]
    v_max3_f32 v244, v244, v88, v89
    v_max3_f32 v244, v244, v90, v91
    ds_read_b128 v[184:187], v226 offset:45056
    s_waitcnt lgkmcnt(10)
    v_mfma_f32_16x16x32_bf16 v[100:103], v[192:195], v[144:147], 0
    ds_read_b128 v[188:191], v227 offset:45056
    s_waitcnt lgkmcnt(10)
    v_mfma_f32_16x16x32_bf16 v[100:103], v[196:199], v[148:151], v[100:103]
    s_barrier
    ds_read_b128 v[192:195], v224 offset:49152
    s_waitcnt lgkmcnt(10)
    v_mfma_f32_16x16x32_bf16 v[100:103], v[200:203], v[152:155], v[100:103]
    ds_read_b128 v[196:199], v225 offset:49152
    s_waitcnt lgkmcnt(10)
    v_mfma_f32_16x16x32_bf16 v[100:103], v[204:207], v[156:159], v[100:103]
    v_max3_f32 v245, v245, v92, v93
    v_max3_f32 v245, v245, v94, v95
    ds_read_b128 v[200:203], v226 offset:49152
    s_waitcnt lgkmcnt(10)
    v_mfma_f32_16x16x32_bf16 v[104:107], v[208:211], v[144:147], 0
    ds_read_b128 v[204:207], v227 offset:49152
    s_waitcnt lgkmcnt(10)
    v_mfma_f32_16x16x32_bf16 v[104:107], v[212:215], v[148:151], v[104:107]
    ds_read_b128 v[208:211], v224 offset:53248
    s_waitcnt lgkmcnt(10)
    v_mfma_f32_16x16x32_bf16 v[104:107], v[216:219], v[152:155], v[104:107]
    ds_read_b128 v[212:215], v225 offset:53248
    s_waitcnt lgkmcnt(10)
    v_mfma_f32_16x16x32_bf16 v[104:107], v[220:223], v[156:159], v[104:107]
    v_max3_f32 v244, v244, v96, v97
    v_max3_f32 v244, v244, v98, v99
    ds_read_b128 v[216:219], v226 offset:53248
    s_waitcnt lgkmcnt(10)
    v_mfma_f32_16x16x32_bf16 v[108:111], v[176:179], v[144:147], 0
    ds_read_b128 v[220:223], v227 offset:53248
    s_waitcnt lgkmcnt(10)
    v_mfma_f32_16x16x32_bf16 v[108:111], v[180:183], v[148:151], v[108:111]
    ds_read_b128 v[176:179], v224 offset:57344
    s_waitcnt lgkmcnt(10)
    v_mfma_f32_16x16x32_bf16 v[108:111], v[184:187], v[152:155], v[108:111]
    ds_read_b128 v[180:183], v225 offset:57344
    s_waitcnt lgkmcnt(10)
    v_mfma_f32_16x16x32_bf16 v[108:111], v[188:191], v[156:159], v[108:111]
    v_max3_f32 v245, v245, v100, v101
    v_max3_f32 v245, v245, v102, v103
    ds_read_b128 v[184:187], v226 offset:57344
    s_waitcnt lgkmcnt(10)
    v_mfma_f32_16x16x32_bf16 v[112:115], v[192:195], v[144:147], 0
    ds_read_b128 v[188:191], v227 offset:57344
    s_waitcnt lgkmcnt(10)
    v_mfma_f32_16x16x32_bf16 v[112:115], v[196:199], v[148:151], v[112:115]
    ds_read_b128 v[192:195], v224 offset:61440
    s_waitcnt lgkmcnt(10)
    v_mfma_f32_16x16x32_bf16 v[112:115], v[200:203], v[152:155], v[112:115]
    ds_read_b128 v[196:199], v225 offset:61440
    s_waitcnt lgkmcnt(10)
    v_mfma_f32_16x16x32_bf16 v[112:115], v[204:207], v[156:159], v[112:115]
    v_max3_f32 v244, v244, v104, v105
    v_max3_f32 v244, v244, v106, v107
    ds_read_b128 v[200:203], v226 offset:61440
    s_waitcnt lgkmcnt(10)
    v_mfma_f32_16x16x32_bf16 v[116:119], v[208:211], v[144:147], 0
    ds_read_b128 v[204:207], v227 offset:61440
    s_waitcnt lgkmcnt(10)
    v_mfma_f32_16x16x32_bf16 v[116:119], v[212:215], v[148:151], v[116:119]
    s_waitcnt lgkmcnt(9)
    v_mfma_f32_16x16x32_bf16 v[116:119], v[216:219], v[152:155], v[116:119]
    s_waitcnt lgkmcnt(8)
    v_mfma_f32_16x16x32_bf16 v[116:119], v[220:223], v[156:159], v[116:119]
    v_max3_f32 v245, v245, v108, v109
    v_max3_f32 v245, v245, v110, v111
    s_waitcnt lgkmcnt(7)
    v_mfma_f32_16x16x32_bf16 v[120:123], v[176:179], v[144:147], 0
    s_waitcnt lgkmcnt(6)
    v_mfma_f32_16x16x32_bf16 v[120:123], v[180:183], v[148:151], v[120:123]
    s_waitcnt lgkmcnt(5)
    v_mfma_f32_16x16x32_bf16 v[120:123], v[184:187], v[152:155], v[120:123]
    s_waitcnt lgkmcnt(4)
    v_mfma_f32_16x16x32_bf16 v[120:123], v[188:191], v[156:159], v[120:123]
    v_max3_f32 v244, v244, v112, v113
    v_max3_f32 v244, v244, v114, v115
    s_waitcnt lgkmcnt(3)
    v_mfma_f32_16x16x32_bf16 v[124:127], v[192:195], v[144:147], 0
    s_waitcnt lgkmcnt(2)
    v_mfma_f32_16x16x32_bf16 v[124:127], v[196:199], v[148:151], v[124:127]
    s_waitcnt lgkmcnt(1)
    v_mfma_f32_16x16x32_bf16 v[124:127], v[200:203], v[152:155], v[124:127]
    s_waitcnt lgkmcnt(0)
    v_mfma_f32_16x16x32_bf16 v[124:127], v[204:207], v[156:159], v[124:127]
    v_max3_f32 v245, v245, v116, v117
    v_max3_f32 v245, v245, v118, v119
    s_nop 1
    v_max3_f32 v244, v244, v120, v121
    v_max3_f32 v244, v244, v122, v123
    s_nop 3
    v_max3_f32 v245, v245, v124, v125
    v_max3_f32 v245, v245, v126, v127
    v_max_f32 v244, v244, v245
    v_mov_b32 v245, v244
    s_nop 1
    v_permlane32_swap_b32 v244, v245
    v_max_f32 v244, v244, v245
    v_mov_b32 v245, v244
    s_nop 1
    v_permlane16_swap_b32 v244, v245
    v_max_f32 v244, v244, v245
    v_mul_f32 v247, s41, v244
    v_fma_f32 v0, v0, s41, -v247
    v_fma_f32 v1, v1, s41, -v247
    v_fma_f32 v2, v2, s41, -v247
    v_fma_f32 v3, v3, s41, -v247
    v_fma_f32 v4, v4, s41, -v247
    v_fma_f32 v5, v5, s41, -v247
    v_fma_f32 v6, v6, s41, -v247
    v_fma_f32 v7, v7, s41, -v247
    v_exp_f32 v0, v0
    v_exp_f32 v1, v1
    v_exp_f32 v2, v2
    v_exp_f32 v3, v3
    v_exp_f32 v4, v4
    v_exp_f32 v5, v5
    v_exp_f32 v6, v6
    v_exp_f32 v7, v7
    v_fma_f32 v8, v8, s41, -v247
    v_fma_f32 v9, v9, s41, -v247
    v_fma_f32 v10, v10, s41, -v247
    v_fma_f32 v11, v11, s41, -v247
    s_barrier
    ds_read_b64_tr_b16 v[208:209], v228 offset:0
    ds_read_b64_tr_b16 v[210:211], v228 offset:4096
    ds_read_b64_tr_b16 v[212:213], v229 offset:0
    ds_read_b64_tr_b16 v[214:215], v229 offset:4096
    ds_read_b64_tr_b16 v[216:217], v230 offset:0
    ds_read_b64_tr_b16 v[218:219], v230 offset:4096
    ds_read_b64_tr_b16 v[220:221], v231 offset:0
    ds_read_b64_tr_b16 v[222:223], v231 offset:4096
    ds_read_b64_tr_b16 v[176:177], v232 offset:0
    ds_read_b64_tr_b16 v[178:179], v232 offset:4096
    ds_read_b64_tr_b16 v[180:181], v233 offset:0
    ds_read_b64_tr_b16 v[182:183], v233 offset:4096
    ds_read_b64_tr_b16 v[184:185], v234 offset:0
    ds_read_b64_tr_b16 v[186:187], v234 offset:4096
    v_fma_f32 v12, v12, s41, -v247
    v_fma_f32 v13, v13, s41, -v247
    v_fma_f32 v14, v14, s41, -v247
    v_fma_f32 v15, v15, s41, -v247
    v_cvt_pk_bf16_f32 v0, v0, v1
    v_cvt_pk_bf16_f32 v1, v2, v3
    v_cvt_pk_bf16_f32 v2, v4, v5
    v_cvt_pk_bf16_f32 v3, v6, v7
    v_exp_f32 v8, v8
    v_exp_f32 v9, v9
    v_exp_f32 v10, v10
    v_exp_f32 v11, v11
    v_exp_f32 v12, v12
    v_exp_f32 v13, v13
    v_exp_f32 v14, v14
    v_exp_f32 v15, v15
    v_mfma_f32_16x16x32_bf16 v[236:239], v[240:243], v[0:3], 0
    v_cvt_pk_bf16_f32 v8, v8, v9
    v_cvt_pk_bf16_f32 v9, v10, v11
    v_cvt_pk_bf16_f32 v10, v12, v13
    v_cvt_pk_bf16_f32 v11, v14, v15
    s_nop 1
    s_waitcnt lgkmcnt(12)
    v_mfma_f32_16x16x32_bf16 v[144:147], v[208:211], v[0:3], 0
    v_fma_f32 v16, v16, s41, -v247
    v_fma_f32 v17, v17, s41, -v247
    v_mfma_f32_16x16x32_bf16 v[236:239], v[240:243], v[8:11], v[236:239]
    ds_read_b64_tr_b16 v[188:189], v235 offset:0
    ds_read_b64_tr_b16 v[190:191], v235 offset:4096
    s_waitcnt lgkmcnt(12)
    v_mfma_f32_16x16x32_bf16 v[148:151], v[212:215], v[0:3], 0
    v_fma_f32 v18, v18, s41, -v247
    v_fma_f32 v19, v19, s41, -v247
    v_fma_f32 v20, v20, s41, -v247
    ds_read_b64_tr_b16 v[192:193], v228 offset:8192
    ds_read_b64_tr_b16 v[194:195], v228 offset:12288
    s_waitcnt lgkmcnt(12)
    v_mfma_f32_16x16x32_bf16 v[152:155], v[216:219], v[0:3], 0
    v_fma_f32 v21, v21, s41, -v247
    v_fma_f32 v22, v22, s41, -v247
    ds_read_b64_tr_b16 v[196:197], v229 offset:8192
    ds_read_b64_tr_b16 v[198:199], v229 offset:12288
    s_waitcnt lgkmcnt(12)
    v_mfma_f32_16x16x32_bf16 v[156:159], v[220:223], v[0:3], 0
    v_fma_f32 v23, v23, s41, -v247
    v_exp_f32 v16, v16
    v_exp_f32 v17, v17
    ds_read_b64_tr_b16 v[200:201], v230 offset:8192
    ds_read_b64_tr_b16 v[202:203], v230 offset:12288
    s_waitcnt lgkmcnt(12)
    v_mfma_f32_16x16x32_bf16 v[160:163], v[176:179], v[0:3], 0
    v_exp_f32 v18, v18
    v_exp_f32 v19, v19
    v_exp_f32 v20, v20
    ds_read_b64_tr_b16 v[204:205], v231 offset:8192
    ds_read_b64_tr_b16 v[206:207], v231 offset:12288
    s_waitcnt lgkmcnt(12)
    v_mfma_f32_16x16x32_bf16 v[164:167], v[180:183], v[0:3], 0
    v_exp_f32 v21, v21
    v_exp_f32 v22, v22
    ds_read_b64_tr_b16 v[208:209], v232 offset:8192
    ds_read_b64_tr_b16 v[210:211], v232 offset:12288
    s_waitcnt lgkmcnt(12)
    v_mfma_f32_16x16x32_bf16 v[168:171], v[184:187], v[0:3], 0
    v_exp_f32 v23, v23
    v_fma_f32 v24, v24, s41, -v247
    v_fma_f32 v25, v25, s41, -v247
    ds_read_b64_tr_b16 v[212:213], v233 offset:8192
    ds_read_b64_tr_b16 v[214:215], v233 offset:12288
    s_waitcnt lgkmcnt(12)
    v_mfma_f32_16x16x32_bf16 v[172:175], v[188:191], v[0:3], 0
    v_fma_f32 v26, v26, s41, -v247
    v_fma_f32 v27, v27, s41, -v247
    ds_read_b64_tr_b16 v[216:217], v234 offset:8192
    ds_read_b64_tr_b16 v[218:219], v234 offset:12288
    s_waitcnt lgkmcnt(12)
    v_mfma_f32_16x16x32_bf16 v[144:147], v[192:195], v[8:11], v[144:147]
    v_fma_f32 v28, v28, s41, -v247
    v_fma_f32 v29, v29, s41, -v247
    v_fma_f32 v30, v30, s41, -v247
    ds_read_b64_tr_b16 v[220:221], v235 offset:8192
    ds_read_b64_tr_b16 v[222:223], v235 offset:12288
    s_waitcnt lgkmcnt(12)
    v_mfma_f32_16x16x32_bf16 v[148:151], v[196:199], v[8:11], v[148:151]
    v_fma_f32 v31, v31, s41, -v247
    v_cvt_pk_bf16_f32 v16, v16, v17
    v_cvt_pk_bf16_f32 v17, v18, v19
    s_barrier
    ds_read_b64_tr_b16 v[176:177], v228 offset:16384
    ds_read_b64_tr_b16 v[178:179], v228 offset:20480
    s_waitcnt lgkmcnt(12)
    v_mfma_f32_16x16x32_bf16 v[152:155], v[200:203], v[8:11], v[152:155]
    v_cvt_pk_bf16_f32 v18, v20, v21
    v_cvt_pk_bf16_f32 v19, v22, v23
    ds_read_b64_tr_b16 v[180:181], v229 offset:16384
    ds_read_b64_tr_b16 v[182:183], v229 offset:20480
    s_waitcnt lgkmcnt(12)
    v_mfma_f32_16x16x32_bf16 v[156:159], v[204:207], v[8:11], v[156:159]
    v_exp_f32 v24, v24
    v_exp_f32 v25, v25
    v_exp_f32 v26, v26
    ds_read_b64_tr_b16 v[184:185], v230 offset:16384
    ds_read_b64_tr_b16 v[186:187], v230 offset:20480
    s_waitcnt lgkmcnt(12)
    v_mfma_f32_16x16x32_bf16 v[160:163], v[208:211], v[8:11], v[160:163]
    v_exp_f32 v27, v27
    v_exp_f32 v28, v28
    v_exp_f32 v29, v29
    ds_read_b64_tr_b16 v[188:189], v231 offset:16384
    ds_read_b64_tr_b16 v[190:191], v231 offset:20480
    s_waitcnt lgkmcnt(12)
    v_mfma_f32_16x16x32_bf16 v[164:167], v[212:215], v[8:11], v[164:167]
    v_exp_f32 v30, v30
    v_exp_f32 v31, v31
    ds_read_b64_tr_b16 v[192:193], v232 offset:16384
    ds_read_b64_tr_b16 v[194:195], v232 offset:20480
    s_waitcnt lgkmcnt(12)
    v_mfma_f32_16x16x32_bf16 v[168:171], v[216:219], v[8:11], v[168:171]
    v_mfma_f32_16x16x32_bf16 v[236:239], v[240:243], v[16:19], v[236:239]
    v_cvt_pk_bf16_f32 v24, v24, v25
    v_cvt_pk_bf16_f32 v25, v26, v27
    ds_read_b64_tr_b16 v[196:197], v233 offset:16384
    ds_read_b64_tr_b16 v[198:199], v233 offset:20480
    s_waitcnt lgkmcnt(12)
    v_mfma_f32_16x16x32_bf16 v[172:175], v[220:223], v[8:11], v[172:175]
    v_cvt_pk_bf16_f32 v26, v28, v29
    v_cvt_pk_bf16_f32 v27, v30, v31
    ds_read_b64_tr_b16 v[200:201], v234 offset:16384
    ds_read_b64_tr_b16 v[202:203], v234 offset:20480
    s_waitcnt lgkmcnt(12)
    v_mfma_f32_16x16x32_bf16 v[144:147], v[176:179], v[16:19], v[144:147]
    v_fma_f32 v32, v32, s41, -v247
    v_fma_f32 v33, v33, s41, -v247
    v_mfma_f32_16x16x32_bf16 v[236:239], v[240:243], v[24:27], v[236:239]
    ds_read_b64_tr_b16 v[204:205], v235 offset:16384
    ds_read_b64_tr_b16 v[206:207], v235 offset:20480
    s_waitcnt lgkmcnt(12)
    v_mfma_f32_16x16x32_bf16 v[148:151], v[180:183], v[16:19], v[148:151]
    v_fma_f32 v34, v34, s41, -v247
    v_fma_f32 v35, v35, s41, -v247
    v_fma_f32 v36, v36, s41, -v247
    ds_read_b64_tr_b16 v[208:209], v228 offset:24576
    ds_read_b64_tr_b16 v[210:211], v228 offset:28672
    s_waitcnt lgkmcnt(12)
    v_mfma_f32_16x16x32_bf16 v[152:155], v[184:187], v[16:19], v[152:155]
    v_fma_f32 v37, v37, s41, -v247
    v_fma_f32 v38, v38, s41, -v247
    ds_read_b64_tr_b16 v[212:213], v229 offset:24576
    ds_read_b64_tr_b16 v[214:215], v229 offset:28672
    s_waitcnt lgkmcnt(12)
    v_mfma_f32_16x16x32_bf16 v[156:159], v[188:191], v[16:19], v[156:159]
    v_fma_f32 v39, v39, s41, -v247
    v_exp_f32 v32, v32
    v_exp_f32 v33, v33
    ds_read_b64_tr_b16 v[216:217], v230 offset:24576
    ds_read_b64_tr_b16 v[218:219], v230 offset:28672
    s_waitcnt lgkmcnt(12)
    v_mfma_f32_16x16x32_bf16 v[160:163], v[192:195], v[16:19], v[160:163]
    v_exp_f32 v34, v34
    v_exp_f32 v35, v35
    v_exp_f32 v36, v36
    ds_read_b64_tr_b16 v[220:221], v231 offset:24576
    ds_read_b64_tr_b16 v[222:223], v231 offset:28672
    s_waitcnt lgkmcnt(12)
    v_mfma_f32_16x16x32_bf16 v[164:167], v[196:199], v[16:19], v[164:167]
    v_exp_f32 v37, v37
    v_exp_f32 v38, v38
    ds_read_b64_tr_b16 v[176:177], v232 offset:24576
    ds_read_b64_tr_b16 v[178:179], v232 offset:28672
    s_waitcnt lgkmcnt(12)
    v_mfma_f32_16x16x32_bf16 v[168:171], v[200:203], v[16:19], v[168:171]
    v_exp_f32 v39, v39
    v_fma_f32 v40, v40, s41, -v247
    v_fma_f32 v41, v41, s41, -v247
    ds_read_b64_tr_b16 v[180:181], v233 offset:24576
    ds_read_b64_tr_b16 v[182:183], v233 offset:28672
    s_waitcnt lgkmcnt(12)
    v_mfma_f32_16x16x32_bf16 v[172:175], v[204:207], v[16:19], v[172:175]
    v_fma_f32 v42, v42, s41, -v247
    v_fma_f32 v43, v43, s41, -v247
    ds_read_b64_tr_b16 v[184:185], v234 offset:24576
    ds_read_b64_tr_b16 v[186:187], v234 offset:28672
    s_waitcnt lgkmcnt(12)
    v_mfma_f32_16x16x32_bf16 v[144:147], v[208:211], v[24:27], v[144:147]
    v_fma_f32 v44, v44, s41, -v247
    v_fma_f32 v45, v45, s41, -v247
    v_fma_f32 v46, v46, s41, -v247
    ds_read_b64_tr_b16 v[188:189], v235 offset:24576
    ds_read_b64_tr_b16 v[190:191], v235 offset:28672
    s_waitcnt lgkmcnt(12)
    v_mfma_f32_16x16x32_bf16 v[148:151], v[212:215], v[24:27], v[148:151]
    v_fma_f32 v47, v47, s41, -v247
    v_cvt_pk_bf16_f32 v32, v32, v33
    v_cvt_pk_bf16_f32 v33, v34, v35
    v_xor_b32 v228, 0x10000, v228
    v_xor_b32 v229, 0x10000, v229
    v_xor_b32 v230, 0x10000, v230
    v_xor_b32 v231, 0x10000, v231
    v_xor_b32 v232, 0x10000, v232
    v_xor_b32 v233, 0x10000, v233
    v_xor_b32 v234, 0x10000, v234
    v_xor_b32 v235, 0x10000, v235
    s_barrier
    ds_read_b64_tr_b16 v[192:193], v228 offset:0
    ds_read_b64_tr_b16 v[194:195], v228 offset:4096
    s_waitcnt lgkmcnt(12)
    v_mfma_f32_16x16x32_bf16 v[152:155], v[216:219], v[24:27], v[152:155]
    v_cvt_pk_bf16_f32 v34, v36, v37
    v_cvt_pk_bf16_f32 v35, v38, v39
    ds_read_b64_tr_b16 v[196:197], v229 offset:0
    ds_read_b64_tr_b16 v[198:199], v229 offset:4096
    s_waitcnt lgkmcnt(12)
    v_mfma_f32_16x16x32_bf16 v[156:159], v[220:223], v[24:27], v[156:159]
    v_exp_f32 v40, v40
    v_exp_f32 v41, v41
    v_exp_f32 v42, v42
    ds_read_b64_tr_b16 v[200:201], v230 offset:0
    ds_read_b64_tr_b16 v[202:203], v230 offset:4096
    s_waitcnt lgkmcnt(12)
    v_mfma_f32_16x16x32_bf16 v[160:163], v[176:179], v[24:27], v[160:163]
    v_exp_f32 v43, v43
    v_exp_f32 v44, v44
    v_exp_f32 v45, v45
    ds_read_b64_tr_b16 v[204:205], v231 offset:0
    ds_read_b64_tr_b16 v[206:207], v231 offset:4096
    s_waitcnt lgkmcnt(12)
    v_mfma_f32_16x16x32_bf16 v[164:167], v[180:183], v[24:27], v[164:167]
    v_exp_f32 v46, v46
    v_exp_f32 v47, v47
    ds_read_b64_tr_b16 v[208:209], v232 offset:0
    ds_read_b64_tr_b16 v[210:211], v232 offset:4096
    s_waitcnt lgkmcnt(12)
    v_mfma_f32_16x16x32_bf16 v[168:171], v[184:187], v[24:27], v[168:171]
    v_mfma_f32_16x16x32_bf16 v[236:239], v[240:243], v[32:35], v[236:239]
    v_cvt_pk_bf16_f32 v40, v40, v41
    v_cvt_pk_bf16_f32 v41, v42, v43
    ds_read_b64_tr_b16 v[212:213], v233 offset:0
    ds_read_b64_tr_b16 v[214:215], v233 offset:4096
    s_waitcnt lgkmcnt(12)
    v_mfma_f32_16x16x32_bf16 v[172:175], v[188:191], v[24:27], v[172:175]
    v_cvt_pk_bf16_f32 v42, v44, v45
    v_cvt_pk_bf16_f32 v43, v46, v47
    ds_read_b64_tr_b16 v[216:217], v234 offset:0
    ds_read_b64_tr_b16 v[218:219], v234 offset:4096
    s_waitcnt lgkmcnt(12)
    v_mfma_f32_16x16x32_bf16 v[144:147], v[192:195], v[32:35], v[144:147]
    v_fma_f32 v48, v48, s41, -v247
    v_fma_f32 v49, v49, s41, -v247
    v_mfma_f32_16x16x32_bf16 v[236:239], v[240:243], v[40:43], v[236:239]
    ds_read_b64_tr_b16 v[220:221], v235 offset:0
    ds_read_b64_tr_b16 v[222:223], v235 offset:4096
    s_waitcnt lgkmcnt(12)
    v_mfma_f32_16x16x32_bf16 v[148:151], v[196:199], v[32:35], v[148:151]
    v_fma_f32 v50, v50, s41, -v247
    v_fma_f32 v51, v51, s41, -v247
    v_fma_f32 v52, v52, s41, -v247
    ds_read_b64_tr_b16 v[176:177], v228 offset:8192
    ds_read_b64_tr_b16 v[178:179], v228 offset:12288
    s_waitcnt lgkmcnt(12)
    v_mfma_f32_16x16x32_bf16 v[152:155], v[200:203], v[32:35], v[152:155]
    v_fma_f32 v53, v53, s41, -v247
    v_fma_f32 v54, v54, s41, -v247
    ds_read_b64_tr_b16 v[180:181], v229 offset:8192
    ds_read_b64_tr_b16 v[182:183], v229 offset:12288
    s_waitcnt lgkmcnt(12)
    v_mfma_f32_16x16x32_bf16 v[156:159], v[204:207], v[32:35], v[156:159]
    v_fma_f32 v55, v55, s41, -v247
    v_exp_f32 v48, v48
    v_exp_f32 v49, v49
    ds_read_b64_tr_b16 v[184:185], v230 offset:8192
    ds_read_b64_tr_b16 v[186:187], v230 offset:12288
    s_waitcnt lgkmcnt(12)
    v_mfma_f32_16x16x32_bf16 v[160:163], v[208:211], v[32:35], v[160:163]
    v_exp_f32 v50, v50
    v_exp_f32 v51, v51
    v_exp_f32 v52, v52
    ds_read_b64_tr_b16 v[188:189], v231 offset:8192
    ds_read_b64_tr_b16 v[190:191], v231 offset:12288
    s_waitcnt lgkmcnt(12)
    v_mfma_f32_16x16x32_bf16 v[164:167], v[212:215], v[32:35], v[164:167]
    v_exp_f32 v53, v53
    v_exp_f32 v54, v54
    ds_read_b64_tr_b16 v[192:193], v232 offset:8192
    ds_read_b64_tr_b16 v[194:195], v232 offset:12288
    s_waitcnt lgkmcnt(12)
    v_mfma_f32_16x16x32_bf16 v[168:171], v[216:219], v[32:35], v[168:171]
    v_exp_f32 v55, v55
    v_fma_f32 v56, v56, s41, -v247
    v_fma_f32 v57, v57, s41, -v247
    ds_read_b64_tr_b16 v[196:197], v233 offset:8192
    ds_read_b64_tr_b16 v[198:199], v233 offset:12288
    s_waitcnt lgkmcnt(12)
    v_mfma_f32_16x16x32_bf16 v[172:175], v[220:223], v[32:35], v[172:175]
    v_fma_f32 v58, v58, s41, -v247
    v_fma_f32 v59, v59, s41, -v247
    ds_read_b64_tr_b16 v[200:201], v234 offset:8192
    ds_read_b64_tr_b16 v[202:203], v234 offset:12288
    s_waitcnt lgkmcnt(12)
    v_mfma_f32_16x16x32_bf16 v[144:147], v[176:179], v[40:43], v[144:147]
    v_fma_f32 v60, v60, s41, -v247
    v_fma_f32 v61, v61, s41, -v247
    v_fma_f32 v62, v62, s41, -v247
    ds_read_b64_tr_b16 v[204:205], v235 offset:8192
    ds_read_b64_tr_b16 v[206:207], v235 offset:12288
    s_waitcnt lgkmcnt(12)
    v_mfma_f32_16x16x32_bf16 v[148:151], v[180:183], v[40:43], v[148:151]
    v_fma_f32 v63, v63, s41, -v247
    v_cvt_pk_bf16_f32 v48, v48, v49
    v_cvt_pk_bf16_f32 v49, v50, v51
    s_barrier
    ds_read_b64_tr_b16 v[208:209], v228 offset:16384
    ds_read_b64_tr_b16 v[210:211], v228 offset:20480
    s_waitcnt lgkmcnt(12)
    v_mfma_f32_16x16x32_bf16 v[152:155], v[184:187], v[40:43], v[152:155]
    v_cvt_pk_bf16_f32 v50, v52, v53
    v_cvt_pk_bf16_f32 v51, v54, v55
    ds_read_b64_tr_b16 v[212:213], v229 offset:16384
    ds_read_b64_tr_b16 v[214:215], v229 offset:20480
    s_waitcnt lgkmcnt(12)
    v_mfma_f32_16x16x32_bf16 v[156:159], v[188:191], v[40:43], v[156:159]
    v_exp_f32 v56, v56
    v_exp_f32 v57, v57
    v_exp_f32 v58, v58
    ds_read_b64_tr_b16 v[216:217], v230 offset:16384
    ds_read_b64_tr_b16 v[218:219], v230 offset:20480
    s_waitcnt lgkmcnt(12)
    v_mfma_f32_16x16x32_bf16 v[160:163], v[192:195], v[40:43], v[160:163]
    v_exp_f32 v59, v59
    v_exp_f32 v60, v60
    v_exp_f32 v61, v61
    ds_read_b64_tr_b16 v[220:221], v231 offset:16384
    ds_read_b64_tr_b16 v[222:223], v231 offset:20480
    s_waitcnt lgkmcnt(12)
    v_mfma_f32_16x16x32_bf16 v[164:167], v[196:199], v[40:43], v[164:167]
    v_exp_f32 v62, v62
    v_exp_f32 v63, v63
    ds_read_b64_tr_b16 v[176:177], v232 offset:16384
    ds_read_b64_tr_b16 v[178:179], v232 offset:20480
    s_waitcnt lgkmcnt(12)
    v_mfma_f32_16x16x32_bf16 v[168:171], v[200:203], v[40:43], v[168:171]
    v_mfma_f32_16x16x32_bf16 v[236:239], v[240:243], v[48:51], v[236:239]
    v_cvt_pk_bf16_f32 v56, v56, v57
    v_cvt_pk_bf16_f32 v57, v58, v59
    ds_read_b64_tr_b16 v[180:181], v233 offset:16384
    ds_read_b64_tr_b16 v[182:183], v233 offset:20480
    s_waitcnt lgkmcnt(12)
    v_mfma_f32_16x16x32_bf16 v[172:175], v[204:207], v[40:43], v[172:175]
    v_cvt_pk_bf16_f32 v58, v60, v61
    v_cvt_pk_bf16_f32 v59, v62, v63
    ds_read_b64_tr_b16 v[184:185], v234 offset:16384
    ds_read_b64_tr_b16 v[186:187], v234 offset:20480
    s_waitcnt lgkmcnt(12)
    v_mfma_f32_16x16x32_bf16 v[144:147], v[208:211], v[48:51], v[144:147]
    v_fma_f32 v64, v64, s41, -v247
    v_fma_f32 v65, v65, s41, -v247
    v_mfma_f32_16x16x32_bf16 v[236:239], v[240:243], v[56:59], v[236:239]
    ds_read_b64_tr_b16 v[188:189], v235 offset:16384
    ds_read_b64_tr_b16 v[190:191], v235 offset:20480
    s_waitcnt lgkmcnt(12)
    v_mfma_f32_16x16x32_bf16 v[148:151], v[212:215], v[48:51], v[148:151]
    v_fma_f32 v66, v66, s41, -v247
    v_fma_f32 v67, v67, s41, -v247
    v_fma_f32 v68, v68, s41, -v247
    ds_read_b64_tr_b16 v[192:193], v228 offset:24576
    ds_read_b64_tr_b16 v[194:195], v228 offset:28672
    s_waitcnt lgkmcnt(12)
    v_mfma_f32_16x16x32_bf16 v[152:155], v[216:219], v[48:51], v[152:155]
    v_fma_f32 v69, v69, s41, -v247
    v_fma_f32 v70, v70, s41, -v247
    ds_read_b64_tr_b16 v[196:197], v229 offset:24576
    ds_read_b64_tr_b16 v[198:199], v229 offset:28672
    s_waitcnt lgkmcnt(12)
    v_mfma_f32_16x16x32_bf16 v[156:159], v[220:223], v[48:51], v[156:159]
    v_fma_f32 v71, v71, s41, -v247
    v_exp_f32 v64, v64
    v_exp_f32 v65, v65
    ds_read_b64_tr_b16 v[200:201], v230 offset:24576
    ds_read_b64_tr_b16 v[202:203], v230 offset:28672
    s_waitcnt lgkmcnt(12)
    v_mfma_f32_16x16x32_bf16 v[160:163], v[176:179], v[48:51], v[160:163]
    v_exp_f32 v66, v66
    v_exp_f32 v67, v67
    v_exp_f32 v68, v68
    ds_read_b64_tr_b16 v[204:205], v231 offset:24576
    ds_read_b64_tr_b16 v[206:207], v231 offset:28672
    s_waitcnt lgkmcnt(12)
    v_mfma_f32_16x16x32_bf16 v[164:167], v[180:183], v[48:51], v[164:167]
    v_exp_f32 v69, v69
    v_exp_f32 v70, v70
    ds_read_b64_tr_b16 v[208:209], v232 offset:24576
    ds_read_b64_tr_b16 v[210:211], v232 offset:28672
    s_waitcnt lgkmcnt(12)
    v_mfma_f32_16x16x32_bf16 v[168:171], v[184:187], v[48:51], v[168:171]
    v_exp_f32 v71, v71
    v_fma_f32 v72, v72, s41, -v247
    v_fma_f32 v73, v73, s41, -v247
    ds_read_b64_tr_b16 v[212:213], v233 offset:24576
    ds_read_b64_tr_b16 v[214:215], v233 offset:28672
    s_waitcnt lgkmcnt(12)
    v_mfma_f32_16x16x32_bf16 v[172:175], v[188:191], v[48:51], v[172:175]
    v_fma_f32 v74, v74, s41, -v247
    v_fma_f32 v75, v75, s41, -v247
    ds_read_b64_tr_b16 v[216:217], v234 offset:24576
    ds_read_b64_tr_b16 v[218:219], v234 offset:28672
    s_waitcnt lgkmcnt(12)
    v_mfma_f32_16x16x32_bf16 v[144:147], v[192:195], v[56:59], v[144:147]
    v_fma_f32 v76, v76, s41, -v247
    v_fma_f32 v77, v77, s41, -v247
    v_fma_f32 v78, v78, s41, -v247
    ds_read_b64_tr_b16 v[220:221], v235 offset:24576
    ds_read_b64_tr_b16 v[222:223], v235 offset:28672
    s_waitcnt lgkmcnt(12)
    v_mfma_f32_16x16x32_bf16 v[148:151], v[196:199], v[56:59], v[148:151]
    v_fma_f32 v79, v79, s41, -v247
    v_cvt_pk_bf16_f32 v64, v64, v65
    v_cvt_pk_bf16_f32 v65, v66, v67
    s_barrier
    ds_read_b64_tr_b16 v[176:177], v228 offset:32768
    ds_read_b64_tr_b16 v[178:179], v228 offset:36864
    s_waitcnt lgkmcnt(12)
    v_mfma_f32_16x16x32_bf16 v[152:155], v[200:203], v[56:59], v[152:155]
    v_cvt_pk_bf16_f32 v66, v68, v69
    v_cvt_pk_bf16_f32 v67, v70, v71
    ds_read_b64_tr_b16 v[180:181], v229 offset:32768
    ds_read_b64_tr_b16 v[182:183], v229 offset:36864
    s_waitcnt lgkmcnt(12)
    v_mfma_f32_16x16x32_bf16 v[156:159], v[204:207], v[56:59], v[156:159]
    v_exp_f32 v72, v72
    v_exp_f32 v73, v73
    v_exp_f32 v74, v74
    ds_read_b64_tr_b16 v[184:185], v230 offset:32768
    ds_read_b64_tr_b16 v[186:187], v230 offset:36864
    s_waitcnt lgkmcnt(12)
    v_mfma_f32_16x16x32_bf16 v[160:163], v[208:211], v[56:59], v[160:163]
    v_exp_f32 v75, v75
    v_exp_f32 v76, v76
    v_exp_f32 v77, v77
    ds_read_b64_tr_b16 v[188:189], v231 offset:32768
    ds_read_b64_tr_b16 v[190:191], v231 offset:36864
    s_waitcnt lgkmcnt(12)
    v_mfma_f32_16x16x32_bf16 v[164:167], v[212:215], v[56:59], v[164:167]
    v_exp_f32 v78, v78
    v_exp_f32 v79, v79
    ds_read_b64_tr_b16 v[192:193], v232 offset:32768
    ds_read_b64_tr_b16 v[194:195], v232 offset:36864
    s_waitcnt lgkmcnt(12)
    v_mfma_f32_16x16x32_bf16 v[168:171], v[216:219], v[56:59], v[168:171]
    v_mfma_f32_16x16x32_bf16 v[236:239], v[240:243], v[64:67], v[236:239]
    v_cvt_pk_bf16_f32 v72, v72, v73
    v_cvt_pk_bf16_f32 v73, v74, v75
    ds_read_b64_tr_b16 v[196:197], v233 offset:32768
    ds_read_b64_tr_b16 v[198:199], v233 offset:36864
    s_waitcnt lgkmcnt(12)
    v_mfma_f32_16x16x32_bf16 v[172:175], v[220:223], v[56:59], v[172:175]
    v_cvt_pk_bf16_f32 v74, v76, v77
    v_cvt_pk_bf16_f32 v75, v78, v79
    ds_read_b64_tr_b16 v[200:201], v234 offset:32768
    ds_read_b64_tr_b16 v[202:203], v234 offset:36864
    s_waitcnt lgkmcnt(12)
    v_mfma_f32_16x16x32_bf16 v[144:147], v[176:179], v[64:67], v[144:147]
    v_fma_f32 v80, v80, s41, -v247
    v_fma_f32 v81, v81, s41, -v247
    v_mfma_f32_16x16x32_bf16 v[236:239], v[240:243], v[72:75], v[236:239]
    ds_read_b64_tr_b16 v[204:205], v235 offset:32768
    ds_read_b64_tr_b16 v[206:207], v235 offset:36864
    s_waitcnt lgkmcnt(12)
    v_mfma_f32_16x16x32_bf16 v[148:151], v[180:183], v[64:67], v[148:151]
    v_fma_f32 v82, v82, s41, -v247
    v_fma_f32 v83, v83, s41, -v247
    v_fma_f32 v84, v84, s41, -v247
    ds_read_b64_tr_b16 v[208:209], v228 offset:40960
    ds_read_b64_tr_b16 v[210:211], v228 offset:45056
    s_waitcnt lgkmcnt(12)
    v_mfma_f32_16x16x32_bf16 v[152:155], v[184:187], v[64:67], v[152:155]
    v_fma_f32 v85, v85, s41, -v247
    v_fma_f32 v86, v86, s41, -v247
    ds_read_b64_tr_b16 v[212:213], v229 offset:40960
    ds_read_b64_tr_b16 v[214:215], v229 offset:45056
    s_waitcnt lgkmcnt(12)
    v_mfma_f32_16x16x32_bf16 v[156:159], v[188:191], v[64:67], v[156:159]
    v_fma_f32 v87, v87, s41, -v247
    v_exp_f32 v80, v80
    v_exp_f32 v81, v81
    ds_read_b64_tr_b16 v[216:217], v230 offset:40960
    ds_read_b64_tr_b16 v[218:219], v230 offset:45056
    s_waitcnt lgkmcnt(12)
    v_mfma_f32_16x16x32_bf16 v[160:163], v[192:195], v[64:67], v[160:163]
    v_exp_f32 v82, v82
    v_exp_f32 v83, v83
    v_exp_f32 v84, v84
    ds_read_b64_tr_b16 v[220:221], v231 offset:40960
    ds_read_b64_tr_b16 v[222:223], v231 offset:45056
    s_waitcnt lgkmcnt(12)
    v_mfma_f32_16x16x32_bf16 v[164:167], v[196:199], v[64:67], v[164:167]
    v_exp_f32 v85, v85
    v_exp_f32 v86, v86
    ds_read_b64_tr_b16 v[176:177], v232 offset:40960
    ds_read_b64_tr_b16 v[178:179], v232 offset:45056
    s_waitcnt lgkmcnt(12)
    v_mfma_f32_16x16x32_bf16 v[168:171], v[200:203], v[64:67], v[168:171]
    v_exp_f32 v87, v87
    v_fma_f32 v88, v88, s41, -v247
    v_fma_f32 v89, v89, s41, -v247
    ds_read_b64_tr_b16 v[180:181], v233 offset:40960
    ds_read_b64_tr_b16 v[182:183], v233 offset:45056
    s_waitcnt lgkmcnt(12)
    v_mfma_f32_16x16x32_bf16 v[172:175], v[204:207], v[64:67], v[172:175]
    v_fma_f32 v90, v90, s41, -v247
    v_fma_f32 v91, v91, s41, -v247
    ds_read_b64_tr_b16 v[184:185], v234 offset:40960
    ds_read_b64_tr_b16 v[186:187], v234 offset:45056
    s_waitcnt lgkmcnt(12)
    v_mfma_f32_16x16x32_bf16 v[144:147], v[208:211], v[72:75], v[144:147]
    v_fma_f32 v92, v92, s41, -v247
    v_fma_f32 v93, v93, s41, -v247
    v_fma_f32 v94, v94, s41, -v247
    ds_read_b64_tr_b16 v[188:189], v235 offset:40960
    ds_read_b64_tr_b16 v[190:191], v235 offset:45056
    s_waitcnt lgkmcnt(12)
    v_mfma_f32_16x16x32_bf16 v[148:151], v[212:215], v[72:75], v[148:151]
    v_fma_f32 v95, v95, s41, -v247
    v_cvt_pk_bf16_f32 v80, v80, v81
    v_cvt_pk_bf16_f32 v81, v82, v83
    s_barrier
    ds_read_b64_tr_b16 v[192:193], v228 offset:49152
    ds_read_b64_tr_b16 v[194:195], v228 offset:53248
    s_waitcnt lgkmcnt(12)
    v_mfma_f32_16x16x32_bf16 v[152:155], v[216:219], v[72:75], v[152:155]
    v_cvt_pk_bf16_f32 v82, v84, v85
    v_cvt_pk_bf16_f32 v83, v86, v87
    ds_read_b64_tr_b16 v[196:197], v229 offset:49152
    ds_read_b64_tr_b16 v[198:199], v229 offset:53248
    s_waitcnt lgkmcnt(12)
    v_mfma_f32_16x16x32_bf16 v[156:159], v[220:223], v[72:75], v[156:159]
    v_exp_f32 v88, v88
    v_exp_f32 v89, v89
    v_exp_f32 v90, v90
    ds_read_b64_tr_b16 v[200:201], v230 offset:49152
    ds_read_b64_tr_b16 v[202:203], v230 offset:53248
    s_waitcnt lgkmcnt(12)
    v_mfma_f32_16x16x32_bf16 v[160:163], v[176:179], v[72:75], v[160:163]
    v_exp_f32 v91, v91
    v_exp_f32 v92, v92
    v_exp_f32 v93, v93
    ds_read_b64_tr_b16 v[204:205], v231 offset:49152
    ds_read_b64_tr_b16 v[206:207], v231 offset:53248
    s_waitcnt lgkmcnt(12)
    v_mfma_f32_16x16x32_bf16 v[164:167], v[180:183], v[72:75], v[164:167]
    v_exp_f32 v94, v94
    v_exp_f32 v95, v95
    ds_read_b64_tr_b16 v[208:209], v232 offset:49152
    ds_read_b64_tr_b16 v[210:211], v232 offset:53248
    s_waitcnt lgkmcnt(12)
    v_mfma_f32_16x16x32_bf16 v[168:171], v[184:187], v[72:75], v[168:171]
    v_mfma_f32_16x16x32_bf16 v[236:239], v[240:243], v[80:83], v[236:239]
    v_cvt_pk_bf16_f32 v88, v88, v89
    v_cvt_pk_bf16_f32 v89, v90, v91
    ds_read_b64_tr_b16 v[212:213], v233 offset:49152
    ds_read_b64_tr_b16 v[214:215], v233 offset:53248
    s_waitcnt lgkmcnt(12)
    v_mfma_f32_16x16x32_bf16 v[172:175], v[188:191], v[72:75], v[172:175]
    v_cvt_pk_bf16_f32 v90, v92, v93
    v_cvt_pk_bf16_f32 v91, v94, v95
    ds_read_b64_tr_b16 v[216:217], v234 offset:49152
    ds_read_b64_tr_b16 v[218:219], v234 offset:53248
    s_waitcnt lgkmcnt(12)
    v_mfma_f32_16x16x32_bf16 v[144:147], v[192:195], v[80:83], v[144:147]
    v_fma_f32 v96, v96, s41, -v247
    v_fma_f32 v97, v97, s41, -v247
    v_mfma_f32_16x16x32_bf16 v[236:239], v[240:243], v[88:91], v[236:239]
    ds_read_b64_tr_b16 v[220:221], v235 offset:49152
    ds_read_b64_tr_b16 v[222:223], v235 offset:53248
    s_waitcnt lgkmcnt(12)
    v_mfma_f32_16x16x32_bf16 v[148:151], v[196:199], v[80:83], v[148:151]
    v_fma_f32 v98, v98, s41, -v247
    v_fma_f32 v99, v99, s41, -v247
    v_fma_f32 v100, v100, s41, -v247
    ds_read_b64_tr_b16 v[176:177], v228 offset:57344
    ds_read_b64_tr_b16 v[178:179], v228 offset:61440
    s_waitcnt lgkmcnt(12)
    v_mfma_f32_16x16x32_bf16 v[152:155], v[200:203], v[80:83], v[152:155]
    v_fma_f32 v101, v101, s41, -v247
    v_fma_f32 v102, v102, s41, -v247
    ds_read_b64_tr_b16 v[180:181], v229 offset:57344
    ds_read_b64_tr_b16 v[182:183], v229 offset:61440
    s_waitcnt lgkmcnt(12)
    v_mfma_f32_16x16x32_bf16 v[156:159], v[204:207], v[80:83], v[156:159]
    v_fma_f32 v103, v103, s41, -v247
    v_exp_f32 v96, v96
    v_exp_f32 v97, v97
    ds_read_b64_tr_b16 v[184:185], v230 offset:57344
    ds_read_b64_tr_b16 v[186:187], v230 offset:61440
    s_waitcnt lgkmcnt(12)
    v_mfma_f32_16x16x32_bf16 v[160:163], v[208:211], v[80:83], v[160:163]
    v_exp_f32 v98, v98
    v_exp_f32 v99, v99
    v_exp_f32 v100, v100
    ds_read_b64_tr_b16 v[188:189], v231 offset:57344
    ds_read_b64_tr_b16 v[190:191], v231 offset:61440
    s_waitcnt lgkmcnt(12)
    v_mfma_f32_16x16x32_bf16 v[164:167], v[212:215], v[80:83], v[164:167]
    v_exp_f32 v101, v101
    v_exp_f32 v102, v102
    ds_read_b64_tr_b16 v[192:193], v232 offset:57344
    ds_read_b64_tr_b16 v[194:195], v232 offset:61440
    s_waitcnt lgkmcnt(12)
    v_mfma_f32_16x16x32_bf16 v[168:171], v[216:219], v[80:83], v[168:171]
    v_exp_f32 v103, v103
    v_fma_f32 v104, v104, s41, -v247
    v_fma_f32 v105, v105, s41, -v247
    ds_read_b64_tr_b16 v[196:197], v233 offset:57344
    ds_read_b64_tr_b16 v[198:199], v233 offset:61440
    s_waitcnt lgkmcnt(12)
    v_mfma_f32_16x16x32_bf16 v[172:175], v[220:223], v[80:83], v[172:175]
    v_fma_f32 v106, v106, s41, -v247
    v_fma_f32 v107, v107, s41, -v247
    ds_read_b64_tr_b16 v[200:201], v234 offset:57344
    ds_read_b64_tr_b16 v[202:203], v234 offset:61440
    s_waitcnt lgkmcnt(12)
    v_mfma_f32_16x16x32_bf16 v[144:147], v[176:179], v[88:91], v[144:147]
    v_fma_f32 v108, v108, s41, -v247
    v_fma_f32 v109, v109, s41, -v247
    v_fma_f32 v110, v110, s41, -v247
    ds_read_b64_tr_b16 v[204:205], v235 offset:57344
    ds_read_b64_tr_b16 v[206:207], v235 offset:61440
    s_waitcnt lgkmcnt(12)
    v_mfma_f32_16x16x32_bf16 v[148:151], v[180:183], v[88:91], v[148:151]
    v_fma_f32 v111, v111, s41, -v247
    v_cvt_pk_bf16_f32 v96, v96, v97
    v_cvt_pk_bf16_f32 v97, v98, v99
    v_xor_b32 v228, 0x30000, v228
    v_xor_b32 v229, 0x30000, v229
    v_xor_b32 v230, 0x30000, v230
    v_xor_b32 v231, 0x30000, v231
    v_xor_b32 v232, 0x30000, v232
    v_xor_b32 v233, 0x30000, v233
    v_xor_b32 v234, 0x30000, v234
    v_xor_b32 v235, 0x30000, v235
    s_barrier
    ds_read_b64_tr_b16 v[208:209], v228 offset:0
    ds_read_b64_tr_b16 v[210:211], v228 offset:4096
    s_waitcnt lgkmcnt(12)
    v_mfma_f32_16x16x32_bf16 v[152:155], v[184:187], v[88:91], v[152:155]
    v_cvt_pk_bf16_f32 v98, v100, v101
    v_cvt_pk_bf16_f32 v99, v102, v103
    ds_read_b64_tr_b16 v[212:213], v229 offset:0
    ds_read_b64_tr_b16 v[214:215], v229 offset:4096
    s_waitcnt lgkmcnt(12)
    v_mfma_f32_16x16x32_bf16 v[156:159], v[188:191], v[88:91], v[156:159]
    v_exp_f32 v104, v104
    v_exp_f32 v105, v105
    v_exp_f32 v106, v106
    ds_read_b64_tr_b16 v[216:217], v230 offset:0
    ds_read_b64_tr_b16 v[218:219], v230 offset:4096
    s_waitcnt lgkmcnt(12)
    v_mfma_f32_16x16x32_bf16 v[160:163], v[192:195], v[88:91], v[160:163]
    v_exp_f32 v107, v107
    v_exp_f32 v108, v108
    v_exp_f32 v109, v109
    ds_read_b64_tr_b16 v[220:221], v231 offset:0
    ds_read_b64_tr_b16 v[222:223], v231 offset:4096
    s_waitcnt lgkmcnt(12)
    v_mfma_f32_16x16x32_bf16 v[164:167], v[196:199], v[88:91], v[164:167]
    v_exp_f32 v110, v110
    v_exp_f32 v111, v111
    ds_read_b64_tr_b16 v[176:177], v232 offset:0
    ds_read_b64_tr_b16 v[178:179], v232 offset:4096
    s_waitcnt lgkmcnt(12)
    v_mfma_f32_16x16x32_bf16 v[168:171], v[200:203], v[88:91], v[168:171]
    v_mfma_f32_16x16x32_bf16 v[236:239], v[240:243], v[96:99], v[236:239]
    v_cvt_pk_bf16_f32 v104, v104, v105
    v_cvt_pk_bf16_f32 v105, v106, v107
    ds_read_b64_tr_b16 v[180:181], v233 offset:0
    ds_read_b64_tr_b16 v[182:183], v233 offset:4096
    s_waitcnt lgkmcnt(12)
    v_mfma_f32_16x16x32_bf16 v[172:175], v[204:207], v[88:91], v[172:175]
    v_cvt_pk_bf16_f32 v106, v108, v109
    v_cvt_pk_bf16_f32 v107, v110, v111
    ds_read_b64_tr_b16 v[184:185], v234 offset:0
    ds_read_b64_tr_b16 v[186:187], v234 offset:4096
    s_waitcnt lgkmcnt(12)
    v_mfma_f32_16x16x32_bf16 v[144:147], v[208:211], v[96:99], v[144:147]
    v_fma_f32 v112, v112, s41, -v247
    v_fma_f32 v113, v113, s41, -v247
    v_mfma_f32_16x16x32_bf16 v[236:239], v[240:243], v[104:107], v[236:239]
    ds_read_b64_tr_b16 v[188:189], v235 offset:0
    ds_read_b64_tr_b16 v[190:191], v235 offset:4096
    s_waitcnt lgkmcnt(12)
    v_mfma_f32_16x16x32_bf16 v[148:151], v[212:215], v[96:99], v[148:151]
    v_fma_f32 v114, v114, s41, -v247
    v_fma_f32 v115, v115, s41, -v247
    v_fma_f32 v116, v116, s41, -v247
    ds_read_b64_tr_b16 v[192:193], v228 offset:8192
    ds_read_b64_tr_b16 v[194:195], v228 offset:12288
    s_waitcnt lgkmcnt(12)
    v_mfma_f32_16x16x32_bf16 v[152:155], v[216:219], v[96:99], v[152:155]
    v_fma_f32 v117, v117, s41, -v247
    v_fma_f32 v118, v118, s41, -v247
    ds_read_b64_tr_b16 v[196:197], v229 offset:8192
    ds_read_b64_tr_b16 v[198:199], v229 offset:12288
    s_waitcnt lgkmcnt(12)
    v_mfma_f32_16x16x32_bf16 v[156:159], v[220:223], v[96:99], v[156:159]
    v_fma_f32 v119, v119, s41, -v247
    v_exp_f32 v112, v112
    v_exp_f32 v113, v113
    ds_read_b64_tr_b16 v[200:201], v230 offset:8192
    ds_read_b64_tr_b16 v[202:203], v230 offset:12288
    s_waitcnt lgkmcnt(12)
    v_mfma_f32_16x16x32_bf16 v[160:163], v[176:179], v[96:99], v[160:163]
    v_exp_f32 v114, v114
    v_exp_f32 v115, v115
    v_exp_f32 v116, v116
    ds_read_b64_tr_b16 v[204:205], v231 offset:8192
    ds_read_b64_tr_b16 v[206:207], v231 offset:12288
    s_waitcnt lgkmcnt(12)
    v_mfma_f32_16x16x32_bf16 v[164:167], v[180:183], v[96:99], v[164:167]
    v_exp_f32 v117, v117
    v_exp_f32 v118, v118
    ds_read_b64_tr_b16 v[208:209], v232 offset:8192
    ds_read_b64_tr_b16 v[210:211], v232 offset:12288
    s_waitcnt lgkmcnt(12)
    v_mfma_f32_16x16x32_bf16 v[168:171], v[184:187], v[96:99], v[168:171]
    v_exp_f32 v119, v119
    v_fma_f32 v120, v120, s41, -v247
    v_fma_f32 v121, v121, s41, -v247
    ds_read_b64_tr_b16 v[212:213], v233 offset:8192
    ds_read_b64_tr_b16 v[214:215], v233 offset:12288
    s_waitcnt lgkmcnt(12)
    v_mfma_f32_16x16x32_bf16 v[172:175], v[188:191], v[96:99], v[172:175]
    v_fma_f32 v122, v122, s41, -v247
    v_fma_f32 v123, v123, s41, -v247
    ds_read_b64_tr_b16 v[216:217], v234 offset:8192
    ds_read_b64_tr_b16 v[218:219], v234 offset:12288
    s_waitcnt lgkmcnt(12)
    v_mfma_f32_16x16x32_bf16 v[144:147], v[192:195], v[104:107], v[144:147]
    v_fma_f32 v124, v124, s41, -v247
    v_fma_f32 v125, v125, s41, -v247
    v_fma_f32 v126, v126, s41, -v247
    ds_read_b64_tr_b16 v[220:221], v235 offset:8192
    ds_read_b64_tr_b16 v[222:223], v235 offset:12288
    s_waitcnt lgkmcnt(12)
    v_mfma_f32_16x16x32_bf16 v[148:151], v[196:199], v[104:107], v[148:151]
    v_fma_f32 v127, v127, s41, -v247
    v_cvt_pk_bf16_f32 v112, v112, v113
    v_cvt_pk_bf16_f32 v113, v114, v115
    s_barrier
    ds_read_b64_tr_b16 v[176:177], v228 offset:16384
    ds_read_b64_tr_b16 v[178:179], v228 offset:20480
    s_waitcnt lgkmcnt(12)
    v_mfma_f32_16x16x32_bf16 v[152:155], v[200:203], v[104:107], v[152:155]
    v_cvt_pk_bf16_f32 v114, v116, v117
    v_cvt_pk_bf16_f32 v115, v118, v119
    ds_read_b64_tr_b16 v[180:181], v229 offset:16384
    ds_read_b64_tr_b16 v[182:183], v229 offset:20480
    s_waitcnt lgkmcnt(12)
    v_mfma_f32_16x16x32_bf16 v[156:159], v[204:207], v[104:107], v[156:159]
    v_exp_f32 v120, v120
    v_exp_f32 v121, v121
    v_exp_f32 v122, v122
    ds_read_b64_tr_b16 v[184:185], v230 offset:16384
    ds_read_b64_tr_b16 v[186:187], v230 offset:20480
    s_waitcnt lgkmcnt(12)
    v_mfma_f32_16x16x32_bf16 v[160:163], v[208:211], v[104:107], v[160:163]
    v_exp_f32 v123, v123
    v_exp_f32 v124, v124
    v_exp_f32 v125, v125
    ds_read_b64_tr_b16 v[188:189], v231 offset:16384
    ds_read_b64_tr_b16 v[190:191], v231 offset:20480
    s_waitcnt lgkmcnt(12)
    v_mfma_f32_16x16x32_bf16 v[164:167], v[212:215], v[104:107], v[164:167]
    v_exp_f32 v126, v126
    v_exp_f32 v127, v127
    ds_read_b64_tr_b16 v[192:193], v232 offset:16384
    ds_read_b64_tr_b16 v[194:195], v232 offset:20480
    s_waitcnt lgkmcnt(12)
    v_mfma_f32_16x16x32_bf16 v[168:171], v[216:219], v[104:107], v[168:171]
    v_mfma_f32_16x16x32_bf16 v[236:239], v[240:243], v[112:115], v[236:239]
    v_cvt_pk_bf16_f32 v120, v120, v121
    v_cvt_pk_bf16_f32 v121, v122, v123
    ds_read_b64_tr_b16 v[196:197], v233 offset:16384
    ds_read_b64_tr_b16 v[198:199], v233 offset:20480
    s_waitcnt lgkmcnt(12)
    v_mfma_f32_16x16x32_bf16 v[172:175], v[220:223], v[104:107], v[172:175]
    v_cvt_pk_bf16_f32 v122, v124, v125
    v_cvt_pk_bf16_f32 v123, v126, v127
    ds_read_b64_tr_b16 v[200:201], v234 offset:16384
    ds_read_b64_tr_b16 v[202:203], v234 offset:20480
    s_waitcnt lgkmcnt(12)
    v_mfma_f32_16x16x32_bf16 v[144:147], v[176:179], v[112:115], v[144:147]
    s_nop 0
    s_nop 0
    v_mfma_f32_16x16x32_bf16 v[236:239], v[240:243], v[120:123], v[236:239]
    ds_read_b64_tr_b16 v[204:205], v235 offset:16384
    ds_read_b64_tr_b16 v[206:207], v235 offset:20480
    s_waitcnt lgkmcnt(12)
    v_mfma_f32_16x16x32_bf16 v[148:151], v[180:183], v[112:115], v[148:151]
    ds_read_b64_tr_b16 v[208:209], v228 offset:24576
    ds_read_b64_tr_b16 v[210:211], v228 offset:28672
    s_waitcnt lgkmcnt(12)
    v_mfma_f32_16x16x32_bf16 v[152:155], v[184:187], v[112:115], v[152:155]
    ds_read_b64_tr_b16 v[212:213], v229 offset:24576
    ds_read_b64_tr_b16 v[214:215], v229 offset:28672
    s_waitcnt lgkmcnt(12)
    v_mfma_f32_16x16x32_bf16 v[156:159], v[188:191], v[112:115], v[156:159]
    ds_read_b64_tr_b16 v[216:217], v230 offset:24576
    ds_read_b64_tr_b16 v[218:219], v230 offset:28672
    s_waitcnt lgkmcnt(12)
    v_mfma_f32_16x16x32_bf16 v[160:163], v[192:195], v[112:115], v[160:163]
    ds_read_b64_tr_b16 v[220:221], v231 offset:24576
    ds_read_b64_tr_b16 v[222:223], v231 offset:28672
    s_waitcnt lgkmcnt(12)
    v_mfma_f32_16x16x32_bf16 v[164:167], v[196:199], v[112:115], v[164:167]
    ds_read_b64_tr_b16 v[176:177], v232 offset:24576
    ds_read_b64_tr_b16 v[178:179], v232 offset:28672
    s_waitcnt lgkmcnt(12)
    v_mfma_f32_16x16x32_bf16 v[168:171], v[200:203], v[112:115], v[168:171]
    ds_read_b64_tr_b16 v[180:181], v233 offset:24576
    ds_read_b64_tr_b16 v[182:183], v233 offset:28672
    s_waitcnt lgkmcnt(12)
    v_mfma_f32_16x16x32_bf16 v[172:175], v[204:207], v[112:115], v[172:175]
    ds_read_b64_tr_b16 v[184:185], v234 offset:24576
    ds_read_b64_tr_b16 v[186:187], v234 offset:28672
    s_waitcnt lgkmcnt(12)
    v_mfma_f32_16x16x32_bf16 v[144:147], v[208:211], v[120:123], v[144:147]
    ds_read_b64_tr_b16 v[188:189], v235 offset:24576
    ds_read_b64_tr_b16 v[190:191], v235 offset:28672
    v_xor_b32 v224, 0x10000, v224
    v_xor_b32 v225, 0x10000, v225
    v_xor_b32 v226, 0x10000, v226
    v_xor_b32 v227, 0x10000, v227
    s_barrier
    ds_read_b128 v[192:195], v224 offset:32768
    s_waitcnt lgkmcnt(13)
    v_mfma_f32_16x16x32_bf16 v[148:151], v[212:215], v[120:123], v[148:151]
    ds_read_b128 v[196:199], v225 offset:32768
    ds_read_b128 v[200:203], v226 offset:32768
    s_waitcnt lgkmcnt(13)
    v_mfma_f32_16x16x32_bf16 v[152:155], v[216:219], v[120:123], v[152:155]
    v_rcp_f32 v246, v236
    ds_read_b128 v[204:207], v227 offset:32768
    ds_read_b128 v[208:211], v224 offset:36864
    s_waitcnt lgkmcnt(13)
    v_mfma_f32_16x16x32_bf16 v[156:159], v[220:223], v[120:123], v[156:159]
    ds_read_b128 v[212:215], v225 offset:36864
    ds_read_b128 v[216:219], v226 offset:36864
    s_waitcnt lgkmcnt(13)
    v_mfma_f32_16x16x32_bf16 v[160:163], v[176:179], v[120:123], v[160:163]
    ds_read_b128 v[220:223], v227 offset:36864
    s_waitcnt lgkmcnt(12)
    v_mfma_f32_16x16x32_bf16 v[164:167], v[180:183], v[120:123], v[164:167]
    ds_read_b128 v[176:179], v224 offset:40960
    s_waitcnt lgkmcnt(11)
    v_mfma_f32_16x16x32_bf16 v[168:171], v[184:187], v[120:123], v[168:171]
    ds_read_b128 v[180:183], v225 offset:40960
    s_waitcnt lgkmcnt(10)
    v_mfma_f32_16x16x32_bf16 v[172:175], v[188:191], v[120:123], v[172:175]
    ds_read_b128 v[184:187], v226 offset:40960
    s_waitcnt lgkmcnt(10)
    v_mfma_f32_16x16x32_bf16 v[0:3], v[192:195], v[128:131], 0
    ds_read_b128 v[188:191], v227 offset:40960
    s_waitcnt lgkmcnt(10)
    v_mfma_f32_16x16x32_bf16 v[0:3], v[196:199], v[132:135], v[0:3]
    ds_read_b128 v[192:195], v224 offset:45056
    s_waitcnt lgkmcnt(10)
    v_mfma_f32_16x16x32_bf16 v[0:3], v[200:203], v[136:139], v[0:3]
    s_nop 0
    s_nop 0
    s_nop 0
    ds_read_b128 v[196:199], v225 offset:45056
    s_waitcnt lgkmcnt(10)
    v_mfma_f32_16x16x32_bf16 v[0:3], v[204:207], v[140:143], v[0:3]
    v_mul_f32 v144, v246, v144
    v_mul_f32 v145, v246, v145
    v_mul_f32 v146, v246, v146
    ds_read_b128 v[200:203], v226 offset:45056
    s_waitcnt lgkmcnt(10)
    v_mfma_f32_16x16x32_bf16 v[4:7], v[208:211], v[128:131], 0
    v_mul_f32 v147, v246, v147
    v_mul_f32 v148, v246, v148
    v_mul_f32 v149, v246, v149
    ds_read_b128 v[204:207], v227 offset:45056
    s_waitcnt lgkmcnt(10)
    v_mfma_f32_16x16x32_bf16 v[4:7], v[212:215], v[132:135], v[4:7]
    v_mul_f32 v150, v246, v150
    v_mul_f32 v151, v246, v151
    v_cvt_pk_bf16_f32 v144, v144, v145
    s_barrier
    ds_read_b128 v[208:211], v224 offset:49152
    s_waitcnt lgkmcnt(10)
    v_mfma_f32_16x16x32_bf16 v[4:7], v[216:219], v[136:139], v[4:7]
    v_cvt_pk_bf16_f32 v145, v146, v147
    v_cvt_pk_bf16_f32 v146, v148, v149
    v_cvt_pk_bf16_f32 v147, v150, v151
    ds_read_b128 v[212:215], v225 offset:49152
    s_waitcnt lgkmcnt(10)
    v_mfma_f32_16x16x32_bf16 v[4:7], v[220:223], v[140:143], v[4:7]
    v_mul_f32 v152, v246, v152
    v_mul_f32 v153, v246, v153
    v_mul_f32 v154, v246, v154
    ds_read_b128 v[216:219], v226 offset:49152
    s_waitcnt lgkmcnt(10)
    v_mfma_f32_16x16x32_bf16 v[8:11], v[176:179], v[128:131], 0
    v_mul_f32 v155, v246, v155
    v_mul_f32 v156, v246, v156
    v_mul_f32 v157, v246, v157
    ds_read_b128 v[220:223], v227 offset:49152
    s_waitcnt lgkmcnt(10)
    v_mfma_f32_16x16x32_bf16 v[8:11], v[180:183], v[132:135], v[8:11]
    v_mul_f32 v158, v246, v158
    v_mul_f32 v159, v246, v159
    v_cvt_pk_bf16_f32 v152, v152, v153
    ds_read_b128 v[176:179], v224 offset:53248
    s_waitcnt lgkmcnt(10)
    v_mfma_f32_16x16x32_bf16 v[8:11], v[184:187], v[136:139], v[8:11]
    v_cvt_pk_bf16_f32 v153, v154, v155
    v_cvt_pk_bf16_f32 v154, v156, v157
    v_cvt_pk_bf16_f32 v155, v158, v159
    ds_read_b128 v[180:183], v225 offset:53248
    s_waitcnt lgkmcnt(10)
    v_mfma_f32_16x16x32_bf16 v[8:11], v[188:191], v[140:143], v[8:11]
    v_max3_f32 v244, v0, v1, v2
    v_max_f32 v244, v244, v3
    v_mul_f32 v160, v246, v160
    v_mul_f32 v161, v246, v161
    v_mul_f32 v162, v246, v162
    ds_read_b128 v[184:187], v226 offset:53248
    s_waitcnt lgkmcnt(10)
    v_mfma_f32_16x16x32_bf16 v[12:15], v[192:195], v[128:131], 0
    v_mul_f32 v163, v246, v163
    v_mul_f32 v164, v246, v164
    v_mul_f32 v165, v246, v165
    ds_read_b128 v[188:191], v227 offset:53248
    s_waitcnt lgkmcnt(10)
    v_mfma_f32_16x16x32_bf16 v[12:15], v[196:199], v[132:135], v[12:15]
    v_mul_f32 v166, v246, v166
    v_mul_f32 v167, v246, v167
    v_cvt_pk_bf16_f32 v160, v160, v161
    ds_read_b128 v[192:195], v224 offset:57344
    s_waitcnt lgkmcnt(10)
    v_mfma_f32_16x16x32_bf16 v[12:15], v[200:203], v[136:139], v[12:15]
    v_cvt_pk_bf16_f32 v161, v162, v163
    v_cvt_pk_bf16_f32 v162, v164, v165
    v_cvt_pk_bf16_f32 v163, v166, v167
    ds_read_b128 v[196:199], v225 offset:57344
    s_waitcnt lgkmcnt(10)
    v_mfma_f32_16x16x32_bf16 v[12:15], v[204:207], v[140:143], v[12:15]
    v_max3_f32 v245, v4, v5, v6
    v_max_f32 v245, v245, v7
    v_mul_f32 v168, v246, v168
    v_mul_f32 v169, v246, v169
    v_mul_f32 v170, v246, v170
    ds_read_b128 v[200:203], v226 offset:57344
    s_waitcnt lgkmcnt(10)
    v_mfma_f32_16x16x32_bf16 v[16:19], v[208:211], v[128:131], 0
    v_mul_f32 v171, v246, v171
    v_mul_f32 v172, v246, v172
    v_mul_f32 v173, v246, v173
    ds_read_b128 v[204:207], v227 offset:57344
    s_waitcnt lgkmcnt(10)
    v_mfma_f32_16x16x32_bf16 v[16:19], v[212:215], v[132:135], v[16:19]
    v_mul_f32 v174, v246, v174
    v_mul_f32 v175, v246, v175
    v_cvt_pk_bf16_f32 v168, v168, v169
    ds_read_b128 v[208:211], v224 offset:61440
    s_waitcnt lgkmcnt(10)
    v_mfma_f32_16x16x32_bf16 v[16:19], v[216:219], v[136:139], v[16:19]
    v_cvt_pk_bf16_f32 v169, v170, v171
    v_cvt_pk_bf16_f32 v170, v172, v173
    v_cvt_pk_bf16_f32 v171, v174, v175
    ds_read_b128 v[212:215], v225 offset:61440
    s_waitcnt lgkmcnt(10)
    v_mfma_f32_16x16x32_bf16 v[16:19], v[220:223], v[140:143], v[16:19]
    v_max3_f32 v244, v244, v8, v9
    v_max3_f32 v244, v244, v10, v11
    ds_read_b128 v[216:219], v226 offset:61440
    s_waitcnt lgkmcnt(10)
    v_mfma_f32_16x16x32_bf16 v[20:23], v[176:179], v[128:131], 0
    ds_read_b128 v[220:223], v227 offset:61440
    s_waitcnt lgkmcnt(10)
    v_mfma_f32_16x16x32_bf16 v[20:23], v[180:183], v[132:135], v[20:23]
    v_xor_b32 v224, 0x30000, v224
    v_xor_b32 v225, 0x30000, v225
    v_xor_b32 v226, 0x30000, v226
    v_xor_b32 v227, 0x30000, v227
    s_barrier
    ds_read_b128 v[176:179], v224 offset:0
    s_waitcnt lgkmcnt(10)
    v_mfma_f32_16x16x32_bf16 v[20:23], v[184:187], v[136:139], v[20:23]
    ds_read_b128 v[180:183], v225 offset:0
    s_waitcnt lgkmcnt(10)
    v_mfma_f32_16x16x32_bf16 v[20:23], v[188:191], v[140:143], v[20:23]
    v_max3_f32 v245, v245, v12, v13
    v_max3_f32 v245, v245, v14, v15
    ds_read_b128 v[184:187], v226 offset:0
    s_waitcnt lgkmcnt(10)
    v_mfma_f32_16x16x32_bf16 v[24:27], v[192:195], v[128:131], 0
    s_add_u32 s40, s50, 0
    buffer_store_dwordx4 v[144:147], v248, s[24:27], s40 offen offset:0 sc1
    ds_read_b128 v[188:191], v227 offset:0
    s_waitcnt lgkmcnt(10)
    v_mfma_f32_16x16x32_bf16 v[24:27], v[196:199], v[132:135], v[24:27]
    ds_read_b128 v[192:195], v224 offset:4096
    s_waitcnt lgkmcnt(10)
    v_mfma_f32_16x16x32_bf16 v[24:27], v[200:203], v[136:139], v[24:27]
    ds_read_b128 v[196:199], v225 offset:4096
    s_waitcnt lgkmcnt(10)
    v_mfma_f32_16x16x32_bf16 v[24:27], v[204:207], v[140:143], v[24:27]
    v_max3_f32 v244, v244, v16, v17
    v_max3_f32 v244, v244, v18, v19
    ds_read_b128 v[200:203], v226 offset:4096
    s_waitcnt lgkmcnt(10)
    v_mfma_f32_16x16x32_bf16 v[28:31], v[208:211], v[128:131], 0
    ds_read_b128 v[204:207], v227 offset:4096
    s_waitcnt lgkmcnt(10)
    v_mfma_f32_16x16x32_bf16 v[28:31], v[212:215], v[132:135], v[28:31]
    ds_read_b128 v[208:211], v224 offset:8192
    s_waitcnt lgkmcnt(10)
    v_mfma_f32_16x16x32_bf16 v[28:31], v[216:219], v[136:139], v[28:31]
    ds_read_b128 v[212:215], v225 offset:8192
    s_waitcnt lgkmcnt(10)
    v_mfma_f32_16x16x32_bf16 v[28:31], v[220:223], v[140:143], v[28:31]
    v_max3_f32 v245, v245, v20, v21
    v_max3_f32 v245, v245, v22, v23
    ds_read_b128 v[216:219], v226 offset:8192
    s_waitcnt lgkmcnt(10)
    v_mfma_f32_16x16x32_bf16 v[32:35], v[176:179], v[128:131], 0
    ds_read_b128 v[220:223], v227 offset:8192
    s_waitcnt lgkmcnt(10)
    v_mfma_f32_16x16x32_bf16 v[32:35], v[180:183], v[132:135], v[32:35]
    ds_read_b128 v[176:179], v224 offset:12288
    s_waitcnt lgkmcnt(10)
    v_mfma_f32_16x16x32_bf16 v[32:35], v[184:187], v[136:139], v[32:35]
    ds_read_b128 v[180:183], v225 offset:12288
    s_waitcnt lgkmcnt(10)
    v_mfma_f32_16x16x32_bf16 v[32:35], v[188:191], v[140:143], v[32:35]
    v_max3_f32 v244, v244, v24, v25
    v_max3_f32 v244, v244, v26, v27
    ds_read_b128 v[184:187], v226 offset:12288
    s_waitcnt lgkmcnt(10)
    v_mfma_f32_16x16x32_bf16 v[36:39], v[192:195], v[128:131], 0
    ds_read_b128 v[188:191], v227 offset:12288
    s_waitcnt lgkmcnt(10)
    v_mfma_f32_16x16x32_bf16 v[36:39], v[196:199], v[132:135], v[36:39]
    s_barrier
    ds_read_b128 v[192:195], v224 offset:16384
    s_waitcnt lgkmcnt(10)
    v_mfma_f32_16x16x32_bf16 v[36:39], v[200:203], v[136:139], v[36:39]
    ds_read_b128 v[196:199], v225 offset:16384
    s_waitcnt lgkmcnt(10)
    v_mfma_f32_16x16x32_bf16 v[36:39], v[204:207], v[140:143], v[36:39]
    v_max3_f32 v245, v245, v28, v29
    v_max3_f32 v245, v245, v30, v31
    ds_read_b128 v[200:203], v226 offset:16384
    s_waitcnt lgkmcnt(10)
    v_mfma_f32_16x16x32_bf16 v[40:43], v[208:211], v[128:131], 0
    buffer_store_dwordx4 v[152:155], v248, s[24:27], s40 offen offset:1024 sc1
    ds_read_b128 v[204:207], v227 offset:16384
    s_waitcnt lgkmcnt(10)
    v_mfma_f32_16x16x32_bf16 v[40:43], v[212:215], v[132:135], v[40:43]
    ds_read_b128 v[208:211], v224 offset:20480
    s_waitcnt lgkmcnt(10)
    v_mfma_f32_16x16x32_bf16 v[40:43], v[216:219], v[136:139], v[40:43]
    ds_read_b128 v[212:215], v225 offset:20480
    s_waitcnt lgkmcnt(10)
    v_mfma_f32_16x16x32_bf16 v[40:43], v[220:223], v[140:143], v[40:43]
    v_max3_f32 v244, v244, v32, v33
    v_max3_f32 v244, v244, v34, v35
    ds_read_b128 v[216:219], v226 offset:20480
    s_waitcnt lgkmcnt(10)
    v_mfma_f32_16x16x32_bf16 v[44:47], v[176:179], v[128:131], 0
    ds_read_b128 v[220:223], v227 offset:20480
    s_waitcnt lgkmcnt(10)
    v_mfma_f32_16x16x32_bf16 v[44:47], v[180:183], v[132:135], v[44:47]
    ds_read_b128 v[176:179], v224 offset:24576
    s_waitcnt lgkmcnt(10)
    v_mfma_f32_16x16x32_bf16 v[44:47], v[184:187], v[136:139], v[44:47]
    ds_read_b128 v[180:183], v225 offset:24576
    s_waitcnt lgkmcnt(10)
    v_mfma_f32_16x16x32_bf16 v[44:47], v[188:191], v[140:143], v[44:47]
    v_max3_f32 v245, v245, v36, v37
    v_max3_f32 v245, v245, v38, v39
    ds_read_b128 v[184:187], v226 offset:24576
    s_waitcnt lgkmcnt(10)
    v_mfma_f32_16x16x32_bf16 v[48:51], v[192:195], v[128:131], 0
    ds_read_b128 v[188:191], v227 offset:24576
    s_waitcnt lgkmcnt(10)
    v_mfma_f32_16x16x32_bf16 v[48:51], v[196:199], v[132:135], v[48:51]
    ds_read_b128 v[192:195], v224 offset:28672
    s_waitcnt lgkmcnt(10)
    v_mfma_f32_16x16x32_bf16 v[48:51], v[200:203], v[136:139], v[48:51]
    ds_read_b128 v[196:199], v225 offset:28672
    s_waitcnt lgkmcnt(10)
    v_mfma_f32_16x16x32_bf16 v[48:51], v[204:207], v[140:143], v[48:51]
    v_max3_f32 v244, v244, v40, v41
    v_max3_f32 v244, v244, v42, v43
    ds_read_b128 v[200:203], v226 offset:28672
    s_waitcnt lgkmcnt(10)
    v_mfma_f32_16x16x32_bf16 v[52:55], v[208:211], v[128:131], 0
    ds_read_b128 v[204:207], v227 offset:28672
    s_waitcnt lgkmcnt(10)
    v_mfma_f32_16x16x32_bf16 v[52:55], v[212:215], v[132:135], v[52:55]
    v_xor_b32 v224, 0x30000, v224
    v_xor_b32 v225, 0x30000, v225
    v_xor_b32 v226, 0x30000, v226
    v_xor_b32 v227, 0x30000, v227
    s_barrier
    ds_read_b128 v[208:211], v224 offset:32768
    s_waitcnt lgkmcnt(10)
    v_mfma_f32_16x16x32_bf16 v[52:55], v[216:219], v[136:139], v[52:55]
    ds_read_b128 v[212:215], v225 offset:32768
    s_waitcnt lgkmcnt(10)
    v_mfma_f32_16x16x32_bf16 v[52:55], v[220:223], v[140:143], v[52:55]
    v_max3_f32 v245, v245, v44, v45
    v_max3_f32 v245, v245, v46, v47
    ds_read_b128 v[216:219], v226 offset:32768
    s_waitcnt lgkmcnt(10)
    v_mfma_f32_16x16x32_bf16 v[56:59], v[176:179], v[128:131], 0
    ds_read_b128 v[220:223], v227 offset:32768
    s_waitcnt lgkmcnt(10)
    v_mfma_f32_16x16x32_bf16 v[56:59], v[180:183], v[132:135], v[56:59]
    ds_read_b128 v[176:179], v224 offset:36864
    s_waitcnt lgkmcnt(10)
    v_mfma_f32_16x16x32_bf16 v[56:59], v[184:187], v[136:139], v[56:59]
    ds_read_b128 v[180:183], v225 offset:36864
    s_waitcnt lgkmcnt(10)
    v_mfma_f32_16x16x32_bf16 v[56:59], v[188:191], v[140:143], v[56:59]
    v_max3_f32 v244, v244, v48, v49
    v_max3_f32 v244, v244, v50, v51
    ds_read_b128 v[184:187], v226 offset:36864
    s_waitcnt lgkmcnt(10)
    v_mfma_f32_16x16x32_bf16 v[60:63], v[192:195], v[128:131], 0
    ds_read_b128 v[188:191], v227 offset:36864
    s_waitcnt lgkmcnt(10)
    v_mfma_f32_16x16x32_bf16 v[60:63], v[196:199], v[132:135], v[60:63]
    ds_read_b128 v[192:195], v224 offset:40960
    s_waitcnt lgkmcnt(10)
    v_mfma_f32_16x16x32_bf16 v[60:63], v[200:203], v[136:139], v[60:63]
    ds_read_b128 v[196:199], v225 offset:40960
    s_waitcnt lgkmcnt(10)
    v_mfma_f32_16x16x32_bf16 v[60:63], v[204:207], v[140:143], v[60:63]
    v_max3_f32 v245, v245, v52, v53
    v_max3_f32 v245, v245, v54, v55
    ds_read_b128 v[200:203], v226 offset:40960
    s_waitcnt lgkmcnt(10)
    v_mfma_f32_16x16x32_bf16 v[64:67], v[208:211], v[128:131], 0
    ds_read_b128 v[204:207], v227 offset:40960
    s_waitcnt lgkmcnt(10)
    v_mfma_f32_16x16x32_bf16 v[64:67], v[212:215], v[132:135], v[64:67]
    ds_read_b128 v[208:211], v224 offset:45056
    s_waitcnt lgkmcnt(10)
    v_mfma_f32_16x16x32_bf16 v[64:67], v[216:219], v[136:139], v[64:67]
    ds_read_b128 v[212:215], v225 offset:45056
    s_waitcnt lgkmcnt(10)
    v_mfma_f32_16x16x32_bf16 v[64:67], v[220:223], v[140:143], v[64:67]
    v_max3_f32 v244, v244, v56, v57
    v_max3_f32 v244, v244, v58, v59
    ds_read_b128 v[216:219], v226 offset:45056
    s_waitcnt lgkmcnt(10)
    v_mfma_f32_16x16x32_bf16 v[68:71], v[176:179], v[128:131], 0
    ds_read_b128 v[220:223], v227 offset:45056
    s_waitcnt lgkmcnt(10)
    v_mfma_f32_16x16x32_bf16 v[68:71], v[180:183], v[132:135], v[68:71]
    s_barrier
    ds_read_b128 v[176:179], v224 offset:49152
    s_waitcnt lgkmcnt(10)
    v_mfma_f32_16x16x32_bf16 v[68:71], v[184:187], v[136:139], v[68:71]
    ds_read_b128 v[180:183], v225 offset:49152
    s_waitcnt lgkmcnt(10)
    v_mfma_f32_16x16x32_bf16 v[68:71], v[188:191], v[140:143], v[68:71]
    v_max3_f32 v245, v245, v60, v61
    v_max3_f32 v245, v245, v62, v63
    ds_read_b128 v[184:187], v226 offset:49152
    s_waitcnt lgkmcnt(10)
    v_mfma_f32_16x16x32_bf16 v[72:75], v[192:195], v[128:131], 0
    buffer_store_dwordx4 v[160:163], v248, s[24:27], s40 offen offset:2048 sc1
    ds_read_b128 v[188:191], v227 offset:49152
    s_waitcnt lgkmcnt(10)
    v_mfma_f32_16x16x32_bf16 v[72:75], v[196:199], v[132:135], v[72:75]
    ds_read_b128 v[192:195], v224 offset:53248
    s_waitcnt lgkmcnt(10)
    v_mfma_f32_16x16x32_bf16 v[72:75], v[200:203], v[136:139], v[72:75]
    ds_read_b128 v[196:199], v225 offset:53248
    s_waitcnt lgkmcnt(10)
    v_mfma_f32_16x16x32_bf16 v[72:75], v[204:207], v[140:143], v[72:75]
    v_max3_f32 v244, v244, v64, v65
    v_max3_f32 v244, v244, v66, v67
    ds_read_b128 v[200:203], v226 offset:53248
    s_waitcnt lgkmcnt(10)
    v_mfma_f32_16x16x32_bf16 v[76:79], v[208:211], v[128:131], 0
    ds_read_b128 v[204:207], v227 offset:53248
    s_waitcnt lgkmcnt(10)
    v_mfma_f32_16x16x32_bf16 v[76:79], v[212:215], v[132:135], v[76:79]
    ds_read_b128 v[208:211], v224 offset:57344
    s_waitcnt lgkmcnt(10)
    v_mfma_f32_16x16x32_bf16 v[76:79], v[216:219], v[136:139], v[76:79]
    ds_read_b128 v[212:215], v225 offset:57344
    s_waitcnt lgkmcnt(10)
    v_mfma_f32_16x16x32_bf16 v[76:79], v[220:223], v[140:143], v[76:79]
    v_max3_f32 v245, v245, v68, v69
    v_max3_f32 v245, v245, v70, v71
    ds_read_b128 v[216:219], v226 offset:57344
    s_waitcnt lgkmcnt(10)
    v_mfma_f32_16x16x32_bf16 v[80:83], v[176:179], v[128:131], 0
    ds_read_b128 v[220:223], v227 offset:57344
    s_waitcnt lgkmcnt(10)
    v_mfma_f32_16x16x32_bf16 v[80:83], v[180:183], v[132:135], v[80:83]
    ds_read_b128 v[176:179], v224 offset:61440
    s_waitcnt lgkmcnt(10)
    v_mfma_f32_16x16x32_bf16 v[80:83], v[184:187], v[136:139], v[80:83]
    ds_read_b128 v[180:183], v225 offset:61440
    s_waitcnt lgkmcnt(10)
    v_mfma_f32_16x16x32_bf16 v[80:83], v[188:191], v[140:143], v[80:83]
    v_max3_f32 v244, v244, v72, v73
    v_max3_f32 v244, v244, v74, v75
    ds_read_b128 v[184:187], v226 offset:61440
    s_waitcnt lgkmcnt(10)
    v_mfma_f32_16x16x32_bf16 v[84:87], v[192:195], v[128:131], 0
    ds_read_b128 v[188:191], v227 offset:61440
    s_waitcnt lgkmcnt(10)
    v_mfma_f32_16x16x32_bf16 v[84:87], v[196:199], v[132:135], v[84:87]
    v_xor_b32 v224, 0x10000, v224
    v_xor_b32 v225, 0x10000, v225
    v_xor_b32 v226, 0x10000, v226
    v_xor_b32 v227, 0x10000, v227
    s_barrier
    ds_read_b128 v[192:195], v224 offset:32768
    s_waitcnt lgkmcnt(10)
    v_mfma_f32_16x16x32_bf16 v[84:87], v[200:203], v[136:139], v[84:87]
    ds_read_b128 v[196:199], v225 offset:32768
    s_waitcnt lgkmcnt(10)
    v_mfma_f32_16x16x32_bf16 v[84:87], v[204:207], v[140:143], v[84:87]
    v_max3_f32 v245, v245, v76, v77
    v_max3_f32 v245, v245, v78, v79
    ds_read_b128 v[200:203], v226 offset:32768
    s_waitcnt lgkmcnt(10)
    v_mfma_f32_16x16x32_bf16 v[88:91], v[208:211], v[128:131], 0
    buffer_store_dwordx4 v[168:171], v248, s[24:27], s40 offen offset:3072 sc1
    ds_read_b128 v[204:207], v227 offset:32768
    s_waitcnt lgkmcnt(10)
    v_mfma_f32_16x16x32_bf16 v[88:91], v[212:215], v[132:135], v[88:91]
    ds_read_b128 v[208:211], v224 offset:36864
    s_waitcnt lgkmcnt(10)
    v_mfma_f32_16x16x32_bf16 v[88:91], v[216:219], v[136:139], v[88:91]
    ds_read_b128 v[212:215], v225 offset:36864
    s_waitcnt lgkmcnt(10)
    v_mfma_f32_16x16x32_bf16 v[88:91], v[220:223], v[140:143], v[88:91]
    v_max3_f32 v244, v244, v80, v81
    v_max3_f32 v244, v244, v82, v83
    ds_read_b128 v[216:219], v226 offset:36864
    s_waitcnt lgkmcnt(10)
    v_mfma_f32_16x16x32_bf16 v[92:95], v[176:179], v[128:131], 0
    ds_read_b128 v[220:223], v227 offset:36864
    s_waitcnt lgkmcnt(10)
    v_mfma_f32_16x16x32_bf16 v[92:95], v[180:183], v[132:135], v[92:95]
    ds_read_b128 v[176:179], v224 offset:40960
    s_waitcnt lgkmcnt(10)
    v_mfma_f32_16x16x32_bf16 v[92:95], v[184:187], v[136:139], v[92:95]
    ds_read_b128 v[180:183], v225 offset:40960
    s_waitcnt lgkmcnt(10)
    v_mfma_f32_16x16x32_bf16 v[92:95], v[188:191], v[140:143], v[92:95]
    v_max3_f32 v245, v245, v84, v85
    v_max3_f32 v245, v245, v86, v87
    ds_read_b128 v[184:187], v226 offset:40960
    s_waitcnt lgkmcnt(10)
    v_mfma_f32_16x16x32_bf16 v[96:99], v[192:195], v[128:131], 0
    ds_read_b128 v[188:191], v227 offset:40960
    s_waitcnt lgkmcnt(10)
    v_mfma_f32_16x16x32_bf16 v[96:99], v[196:199], v[132:135], v[96:99]
    ds_read_b128 v[192:195], v224 offset:45056
    s_waitcnt lgkmcnt(10)
    v_mfma_f32_16x16x32_bf16 v[96:99], v[200:203], v[136:139], v[96:99]
    ds_read_b128 v[196:199], v225 offset:45056
    s_waitcnt lgkmcnt(10)
    v_mfma_f32_16x16x32_bf16 v[96:99], v[204:207], v[140:143], v[96:99]
    v_max3_f32 v244, v244, v88, v89
    v_max3_f32 v244, v244, v90, v91
    ds_read_b128 v[200:203], v226 offset:45056
    s_waitcnt lgkmcnt(10)
    v_mfma_f32_16x16x32_bf16 v[100:103], v[208:211], v[128:131], 0
    ds_read_b128 v[204:207], v227 offset:45056
    s_waitcnt lgkmcnt(10)
    v_mfma_f32_16x16x32_bf16 v[100:103], v[212:215], v[132:135], v[100:103]
    s_barrier
    ds_read_b128 v[208:211], v224 offset:49152
    s_waitcnt lgkmcnt(10)
    v_mfma_f32_16x16x32_bf16 v[100:103], v[216:219], v[136:139], v[100:103]
    ds_read_b128 v[212:215], v225 offset:49152
    s_waitcnt lgkmcnt(10)
    v_mfma_f32_16x16x32_bf16 v[100:103], v[220:223], v[140:143], v[100:103]
    v_max3_f32 v245, v245, v92, v93
    v_max3_f32 v245, v245, v94, v95
    ds_read_b128 v[216:219], v226 offset:49152
    s_waitcnt lgkmcnt(10)
    v_mfma_f32_16x16x32_bf16 v[104:107], v[176:179], v[128:131], 0
    ds_read_b128 v[220:223], v227 offset:49152
    s_waitcnt lgkmcnt(10)
    v_mfma_f32_16x16x32_bf16 v[104:107], v[180:183], v[132:135], v[104:107]
    ds_read_b128 v[176:179], v224 offset:53248
    s_waitcnt lgkmcnt(10)
    v_mfma_f32_16x16x32_bf16 v[104:107], v[184:187], v[136:139], v[104:107]
    ds_read_b128 v[180:183], v225 offset:53248
    s_waitcnt lgkmcnt(10)
    v_mfma_f32_16x16x32_bf16 v[104:107], v[188:191], v[140:143], v[104:107]
    v_max3_f32 v244, v244, v96, v97
    v_max3_f32 v244, v244, v98, v99
    ds_read_b128 v[184:187], v226 offset:53248
    s_waitcnt lgkmcnt(10)
    v_mfma_f32_16x16x32_bf16 v[108:111], v[192:195], v[128:131], 0
    ds_read_b128 v[188:191], v227 offset:53248
    s_waitcnt lgkmcnt(10)
    v_mfma_f32_16x16x32_bf16 v[108:111], v[196:199], v[132:135], v[108:111]
    ds_read_b128 v[192:195], v224 offset:57344
    s_waitcnt lgkmcnt(10)
    v_mfma_f32_16x16x32_bf16 v[108:111], v[200:203], v[136:139], v[108:111]
    ds_read_b128 v[196:199], v225 offset:57344
    s_waitcnt lgkmcnt(10)
    v_mfma_f32_16x16x32_bf16 v[108:111], v[204:207], v[140:143], v[108:111]
    v_max3_f32 v245, v245, v100, v101
    v_max3_f32 v245, v245, v102, v103
    ds_read_b128 v[200:203], v226 offset:57344
    s_waitcnt lgkmcnt(10)
    v_mfma_f32_16x16x32_bf16 v[112:115], v[208:211], v[128:131], 0
    ds_read_b128 v[204:207], v227 offset:57344
    s_waitcnt lgkmcnt(10)
    v_mfma_f32_16x16x32_bf16 v[112:115], v[212:215], v[132:135], v[112:115]
    ds_read_b128 v[208:211], v224 offset:61440
    s_waitcnt lgkmcnt(10)
    v_mfma_f32_16x16x32_bf16 v[112:115], v[216:219], v[136:139], v[112:115]
    ds_read_b128 v[212:215], v225 offset:61440
    s_waitcnt lgkmcnt(10)
    v_mfma_f32_16x16x32_bf16 v[112:115], v[220:223], v[140:143], v[112:115]
    v_max3_f32 v244, v244, v104, v105
    v_max3_f32 v244, v244, v106, v107
    ds_read_b128 v[216:219], v226 offset:61440
    s_waitcnt lgkmcnt(10)
    v_mfma_f32_16x16x32_bf16 v[116:119], v[176:179], v[128:131], 0
    ds_read_b128 v[220:223], v227 offset:61440
    s_waitcnt lgkmcnt(10)
    v_mfma_f32_16x16x32_bf16 v[116:119], v[180:183], v[132:135], v[116:119]
    s_waitcnt lgkmcnt(9)
    v_mfma_f32_16x16x32_bf16 v[116:119], v[184:187], v[136:139], v[116:119]
    s_waitcnt lgkmcnt(8)
    v_mfma_f32_16x16x32_bf16 v[116:119], v[188:191], v[140:143], v[116:119]
    v_max3_f32 v245, v245, v108, v109
    v_max3_f32 v245, v245, v110, v111
    s_waitcnt lgkmcnt(7)
    v_mfma_f32_16x16x32_bf16 v[120:123], v[192:195], v[128:131], 0
    s_waitcnt lgkmcnt(6)
    v_mfma_f32_16x16x32_bf16 v[120:123], v[196:199], v[132:135], v[120:123]
    s_waitcnt lgkmcnt(5)
    v_mfma_f32_16x16x32_bf16 v[120:123], v[200:203], v[136:139], v[120:123]
    s_waitcnt lgkmcnt(4)
    v_mfma_f32_16x16x32_bf16 v[120:123], v[204:207], v[140:143], v[120:123]
    v_max3_f32 v244, v244, v112, v113
    v_max3_f32 v244, v244, v114, v115
    s_waitcnt lgkmcnt(3)
    v_mfma_f32_16x16x32_bf16 v[124:127], v[208:211], v[128:131], 0
    s_waitcnt lgkmcnt(2)
    v_mfma_f32_16x16x32_bf16 v[124:127], v[212:215], v[132:135], v[124:127]
    s_waitcnt lgkmcnt(1)
    v_mfma_f32_16x16x32_bf16 v[124:127], v[216:219], v[136:139], v[124:127]
    s_waitcnt lgkmcnt(0)
    v_mfma_f32_16x16x32_bf16 v[124:127], v[220:223], v[140:143], v[124:127]
    v_max3_f32 v245, v245, v116, v117
    v_max3_f32 v245, v245, v118, v119
    s_nop 1
    v_max3_f32 v244, v244, v120, v121
    v_max3_f32 v244, v244, v122, v123
    v_mov_b32 v128, v144
    v_mov_b32 v129, v145
    v_mov_b32 v130, v146
    v_mov_b32 v131, v147
    v_max3_f32 v245, v245, v124, v125
    v_max3_f32 v245, v245, v126, v127
    v_max_f32 v244, v244, v245
    v_mov_b32 v245, v244
    v_mov_b32 v132, v152
    v_mov_b32 v133, v153
    v_mov_b32 v134, v154
    v_mov_b32 v135, v155
    v_mov_b32 v136, v160
    v_mov_b32 v137, v161
    v_permlane32_swap_b32 v244, v245
    v_max_f32 v244, v244, v245
    v_mov_b32 v245, v244
    v_mov_b32 v138, v162
    v_mov_b32 v139, v163
    v_mov_b32 v140, v168
    v_mov_b32 v141, v169
    v_mov_b32 v142, v170
    v_mov_b32 v143, v171
    v_permlane16_swap_b32 v244, v245
    v_max_f32 v244, v244, v245
    v_mul_f32 v247, s41, v244
    v_fma_f32 v0, v0, s41, -v247
    v_fma_f32 v1, v1, s41, -v247
    v_fma_f32 v2, v2, s41, -v247
    v_fma_f32 v3, v3, s41, -v247
    v_fma_f32 v4, v4, s41, -v247
    v_fma_f32 v5, v5, s41, -v247
    v_fma_f32 v6, v6, s41, -v247
    v_fma_f32 v7, v7, s41, -v247
    v_exp_f32 v0, v0
    v_exp_f32 v1, v1
    v_exp_f32 v2, v2
    v_exp_f32 v3, v3
    v_exp_f32 v4, v4
    v_exp_f32 v5, v5
    v_exp_f32 v6, v6
    v_exp_f32 v7, v7
    v_fma_f32 v8, v8, s41, -v247
    v_fma_f32 v9, v9, s41, -v247
    v_fma_f32 v10, v10, s41, -v247
    v_fma_f32 v11, v11, s41, -v247
    v_xor_b32 v228, 0x20000, v228
    v_xor_b32 v229, 0x20000, v229
    v_xor_b32 v230, 0x20000, v230
    v_xor_b32 v231, 0x20000, v231
    v_xor_b32 v232, 0x20000, v232
    v_xor_b32 v233, 0x20000, v233
    v_xor_b32 v234, 0x20000, v234
    v_xor_b32 v235, 0x20000, v235
    s_barrier
    ds_read_b64_tr_b16 v[176:177], v228 offset:0
    ds_read_b64_tr_b16 v[178:179], v228 offset:4096
    ds_read_b64_tr_b16 v[180:181], v229 offset:0
    ds_read_b64_tr_b16 v[182:183], v229 offset:4096
    ds_read_b64_tr_b16 v[184:185], v230 offset:0
    ds_read_b64_tr_b16 v[186:187], v230 offset:4096
    ds_read_b64_tr_b16 v[188:189], v231 offset:0
    ds_read_b64_tr_b16 v[190:191], v231 offset:4096
    ds_read_b64_tr_b16 v[192:193], v232 offset:0
    ds_read_b64_tr_b16 v[194:195], v232 offset:4096
    ds_read_b64_tr_b16 v[196:197], v233 offset:0
    ds_read_b64_tr_b16 v[198:199], v233 offset:4096
    ds_read_b64_tr_b16 v[200:201], v234 offset:0
    ds_read_b64_tr_b16 v[202:203], v234 offset:4096
    v_fma_f32 v12, v12, s41, -v247
    v_fma_f32 v13, v13, s41, -v247
    v_fma_f32 v14, v14, s41, -v247
    v_fma_f32 v15, v15, s41, -v247
    v_cvt_pk_bf16_f32 v0, v0, v1
    v_cvt_pk_bf16_f32 v1, v2, v3
    v_cvt_pk_bf16_f32 v2, v4, v5
    v_cvt_pk_bf16_f32 v3, v6, v7
    v_exp_f32 v8, v8
    v_exp_f32 v9, v9
    v_exp_f32 v10, v10
    v_exp_f32 v11, v11
    v_exp_f32 v12, v12
    v_exp_f32 v13, v13
    v_exp_f32 v14, v14
    v_exp_f32 v15, v15
    v_mfma_f32_16x16x32_bf16 v[236:239], v[240:243], v[0:3], 0
    v_cvt_pk_bf16_f32 v8, v8, v9
    v_cvt_pk_bf16_f32 v9, v10, v11
    v_cvt_pk_bf16_f32 v10, v12, v13
    v_cvt_pk_bf16_f32 v11, v14, v15
    s_nop 1
    s_waitcnt lgkmcnt(12)
    v_mfma_f32_16x16x32_bf16 v[144:147], v[176:179], v[0:3], 0
    v_fma_f32 v16, v16, s41, -v247
    v_fma_f32 v17, v17, s41, -v247
    v_mfma_f32_16x16x32_bf16 v[236:239], v[240:243], v[8:11], v[236:239]
    ds_read_b64_tr_b16 v[204:205], v235 offset:0
    ds_read_b64_tr_b16 v[206:207], v235 offset:4096
    s_waitcnt lgkmcnt(12)
    v_mfma_f32_16x16x32_bf16 v[148:151], v[180:183], v[0:3], 0
    v_fma_f32 v18, v18, s41, -v247
    v_fma_f32 v19, v19, s41, -v247
    v_fma_f32 v20, v20, s41, -v247
    ds_read_b64_tr_b16 v[208:209], v228 offset:8192
    ds_read_b64_tr_b16 v[210:211], v228 offset:12288
    s_waitcnt lgkmcnt(12)
    v_mfma_f32_16x16x32_bf16 v[152:155], v[184:187], v[0:3], 0
    v_fma_f32 v21, v21, s41, -v247
    v_fma_f32 v22, v22, s41, -v247
    ds_read_b64_tr_b16 v[212:213], v229 offset:8192
    ds_read_b64_tr_b16 v[214:215], v229 offset:12288
    s_waitcnt lgkmcnt(12)
    v_mfma_f32_16x16x32_bf16 v[156:159], v[188:191], v[0:3], 0
    v_fma_f32 v23, v23, s41, -v247
    v_exp_f32 v16, v16
    v_exp_f32 v17, v17
    ds_read_b64_tr_b16 v[216:217], v230 offset:8192
    ds_read_b64_tr_b16 v[218:219], v230 offset:12288
    s_waitcnt lgkmcnt(12)
    v_mfma_f32_16x16x32_bf16 v[160:163], v[192:195], v[0:3], 0
    v_exp_f32 v18, v18
    v_exp_f32 v19, v19
    v_exp_f32 v20, v20
    ds_read_b64_tr_b16 v[220:221], v231 offset:8192
    ds_read_b64_tr_b16 v[222:223], v231 offset:12288
    s_waitcnt lgkmcnt(12)
    v_mfma_f32_16x16x32_bf16 v[164:167], v[196:199], v[0:3], 0
    v_exp_f32 v21, v21
    v_exp_f32 v22, v22
    ds_read_b64_tr_b16 v[176:177], v232 offset:8192
    ds_read_b64_tr_b16 v[178:179], v232 offset:12288
    s_waitcnt lgkmcnt(12)
    v_mfma_f32_16x16x32_bf16 v[168:171], v[200:203], v[0:3], 0
    v_exp_f32 v23, v23
    v_fma_f32 v24, v24, s41, -v247
    v_fma_f32 v25, v25, s41, -v247
    ds_read_b64_tr_b16 v[180:181], v233 offset:8192
    ds_read_b64_tr_b16 v[182:183], v233 offset:12288
    s_waitcnt lgkmcnt(12)
    v_mfma_f32_16x16x32_bf16 v[172:175], v[204:207], v[0:3], 0
    v_fma_f32 v26, v26, s41, -v247
    v_fma_f32 v27, v27, s41, -v247
    ds_read_b64_tr_b16 v[184:185], v234 offset:8192
    ds_read_b64_tr_b16 v[186:187], v234 offset:12288
    s_waitcnt lgkmcnt(12)
    v_mfma_f32_16x16x32_bf16 v[144:147], v[208:211], v[8:11], v[144:147]
    v_fma_f32 v28, v28, s41, -v247
    v_fma_f32 v29, v29, s41, -v247
    v_fma_f32 v30, v30, s41, -v247
    ds_read_b64_tr_b16 v[188:189], v235 offset:8192
    ds_read_b64_tr_b16 v[190:191], v235 offset:12288
    s_waitcnt lgkmcnt(12)
    v_mfma_f32_16x16x32_bf16 v[148:151], v[212:215], v[8:11], v[148:151]
    v_fma_f32 v31, v31, s41, -v247
    v_cvt_pk_bf16_f32 v16, v16, v17
    v_cvt_pk_bf16_f32 v17, v18, v19
    s_barrier
    ds_read_b64_tr_b16 v[192:193], v228 offset:16384
    ds_read_b64_tr_b16 v[194:195], v228 offset:20480
    s_waitcnt lgkmcnt(12)
    v_mfma_f32_16x16x32_bf16 v[152:155], v[216:219], v[8:11], v[152:155]
    v_cvt_pk_bf16_f32 v18, v20, v21
    v_cvt_pk_bf16_f32 v19, v22, v23
    ds_read_b64_tr_b16 v[196:197], v229 offset:16384
    ds_read_b64_tr_b16 v[198:199], v229 offset:20480
    s_waitcnt lgkmcnt(12)
    v_mfma_f32_16x16x32_bf16 v[156:159], v[220:223], v[8:11], v[156:159]
    v_exp_f32 v24, v24
    v_exp_f32 v25, v25
    v_exp_f32 v26, v26
    ds_read_b64_tr_b16 v[200:201], v230 offset:16384
    ds_read_b64_tr_b16 v[202:203], v230 offset:20480
    s_waitcnt lgkmcnt(12)
    v_mfma_f32_16x16x32_bf16 v[160:163], v[176:179], v[8:11], v[160:163]
    v_exp_f32 v27, v27
    v_exp_f32 v28, v28
    v_exp_f32 v29, v29
    ds_read_b64_tr_b16 v[204:205], v231 offset:16384
    ds_read_b64_tr_b16 v[206:207], v231 offset:20480
    s_waitcnt lgkmcnt(12)
    v_mfma_f32_16x16x32_bf16 v[164:167], v[180:183], v[8:11], v[164:167]
    v_exp_f32 v30, v30
    v_exp_f32 v31, v31
    ds_read_b64_tr_b16 v[208:209], v232 offset:16384
    ds_read_b64_tr_b16 v[210:211], v232 offset:20480
    s_waitcnt lgkmcnt(12)
    v_mfma_f32_16x16x32_bf16 v[168:171], v[184:187], v[8:11], v[168:171]
    v_mfma_f32_16x16x32_bf16 v[236:239], v[240:243], v[16:19], v[236:239]
    v_cvt_pk_bf16_f32 v24, v24, v25
    v_cvt_pk_bf16_f32 v25, v26, v27
    ds_read_b64_tr_b16 v[212:213], v233 offset:16384
    ds_read_b64_tr_b16 v[214:215], v233 offset:20480
    s_waitcnt lgkmcnt(12)
    v_mfma_f32_16x16x32_bf16 v[172:175], v[188:191], v[8:11], v[172:175]
    v_cvt_pk_bf16_f32 v26, v28, v29
    v_cvt_pk_bf16_f32 v27, v30, v31
    ds_read_b64_tr_b16 v[216:217], v234 offset:16384
    ds_read_b64_tr_b16 v[218:219], v234 offset:20480
    s_waitcnt lgkmcnt(12)
    v_mfma_f32_16x16x32_bf16 v[144:147], v[192:195], v[16:19], v[144:147]
    v_fma_f32 v32, v32, s41, -v247
    v_fma_f32 v33, v33, s41, -v247
    v_mfma_f32_16x16x32_bf16 v[236:239], v[240:243], v[24:27], v[236:239]
    ds_read_b64_tr_b16 v[220:221], v235 offset:16384
    ds_read_b64_tr_b16 v[222:223], v235 offset:20480
    s_waitcnt lgkmcnt(12)
    v_mfma_f32_16x16x32_bf16 v[148:151], v[196:199], v[16:19], v[148:151]
    v_fma_f32 v34, v34, s41, -v247
    v_fma_f32 v35, v35, s41, -v247
    v_fma_f32 v36, v36, s41, -v247
    ds_read_b64_tr_b16 v[176:177], v228 offset:24576
    ds_read_b64_tr_b16 v[178:179], v228 offset:28672
    s_waitcnt lgkmcnt(12)
    v_mfma_f32_16x16x32_bf16 v[152:155], v[200:203], v[16:19], v[152:155]
    v_fma_f32 v37, v37, s41, -v247
    v_fma_f32 v38, v38, s41, -v247
    ds_read_b64_tr_b16 v[180:181], v229 offset:24576
    ds_read_b64_tr_b16 v[182:183], v229 offset:28672
    s_waitcnt lgkmcnt(12)
    v_mfma_f32_16x16x32_bf16 v[156:159], v[204:207], v[16:19], v[156:159]
    v_fma_f32 v39, v39, s41, -v247
    v_exp_f32 v32, v32
    v_exp_f32 v33, v33
    ds_read_b64_tr_b16 v[184:185], v230 offset:24576
    ds_read_b64_tr_b16 v[186:187], v230 offset:28672
    s_waitcnt lgkmcnt(12)
    v_mfma_f32_16x16x32_bf16 v[160:163], v[208:211], v[16:19], v[160:163]
    v_exp_f32 v34, v34
    v_exp_f32 v35, v35
    v_exp_f32 v36, v36
    ds_read_b64_tr_b16 v[188:189], v231 offset:24576
    ds_read_b64_tr_b16 v[190:191], v231 offset:28672
    s_waitcnt lgkmcnt(12)
    v_mfma_f32_16x16x32_bf16 v[164:167], v[212:215], v[16:19], v[164:167]
    v_exp_f32 v37, v37
    v_exp_f32 v38, v38
    ds_read_b64_tr_b16 v[192:193], v232 offset:24576
    ds_read_b64_tr_b16 v[194:195], v232 offset:28672
    s_waitcnt lgkmcnt(12)
    v_mfma_f32_16x16x32_bf16 v[168:171], v[216:219], v[16:19], v[168:171]
    v_exp_f32 v39, v39
    v_fma_f32 v40, v40, s41, -v247
    v_fma_f32 v41, v41, s41, -v247
    ds_read_b64_tr_b16 v[196:197], v233 offset:24576
    ds_read_b64_tr_b16 v[198:199], v233 offset:28672
    s_waitcnt lgkmcnt(12)
    v_mfma_f32_16x16x32_bf16 v[172:175], v[220:223], v[16:19], v[172:175]
    v_fma_f32 v42, v42, s41, -v247
    v_fma_f32 v43, v43, s41, -v247
    ds_read_b64_tr_b16 v[200:201], v234 offset:24576
    ds_read_b64_tr_b16 v[202:203], v234 offset:28672
    s_waitcnt lgkmcnt(12)
    v_mfma_f32_16x16x32_bf16 v[144:147], v[176:179], v[24:27], v[144:147]
    v_fma_f32 v44, v44, s41, -v247
    v_fma_f32 v45, v45, s41, -v247
    v_fma_f32 v46, v46, s41, -v247
    ds_read_b64_tr_b16 v[204:205], v235 offset:24576
    ds_read_b64_tr_b16 v[206:207], v235 offset:28672
    s_waitcnt lgkmcnt(12)
    v_mfma_f32_16x16x32_bf16 v[148:151], v[180:183], v[24:27], v[148:151]
    v_fma_f32 v47, v47, s41, -v247
    v_cvt_pk_bf16_f32 v32, v32, v33
    v_cvt_pk_bf16_f32 v33, v34, v35
    v_xor_b32 v228, 0x10000, v228
    v_xor_b32 v229, 0x10000, v229
    v_xor_b32 v230, 0x10000, v230
    v_xor_b32 v231, 0x10000, v231
    v_xor_b32 v232, 0x10000, v232
    v_xor_b32 v233, 0x10000, v233
    v_xor_b32 v234, 0x10000, v234
    v_xor_b32 v235, 0x10000, v235
    s_waitcnt vmcnt(0)
    s_barrier
    ds_read_b64_tr_b16 v[208:209], v228 offset:0
    ds_read_b64_tr_b16 v[210:211], v228 offset:4096
    s_waitcnt lgkmcnt(12)
    v_mfma_f32_16x16x32_bf16 v[152:155], v[184:187], v[24:27], v[152:155]
    v_cvt_pk_bf16_f32 v34, v36, v37
    v_cvt_pk_bf16_f32 v35, v38, v39
    ds_read_b64_tr_b16 v[212:213], v229 offset:0
    ds_read_b64_tr_b16 v[214:215], v229 offset:4096
    s_waitcnt lgkmcnt(12)
    v_mfma_f32_16x16x32_bf16 v[156:159], v[188:191], v[24:27], v[156:159]
    v_exp_f32 v40, v40
    v_exp_f32 v41, v41
    v_exp_f32 v42, v42
    ds_read_b64_tr_b16 v[216:217], v230 offset:0
    ds_read_b64_tr_b16 v[218:219], v230 offset:4096
    s_waitcnt lgkmcnt(12)
    v_mfma_f32_16x16x32_bf16 v[160:163], v[192:195], v[24:27], v[160:163]
    v_exp_f32 v43, v43
    v_exp_f32 v44, v44
    v_exp_f32 v45, v45
    ds_read_b64_tr_b16 v[220:221], v231 offset:0
    ds_read_b64_tr_b16 v[222:223], v231 offset:4096
    s_waitcnt lgkmcnt(12)
    v_mfma_f32_16x16x32_bf16 v[164:167], v[196:199], v[24:27], v[164:167]
    v_exp_f32 v46, v46
    v_exp_f32 v47, v47
    ds_read_b64_tr_b16 v[176:177], v232 offset:0
    ds_read_b64_tr_b16 v[178:179], v232 offset:4096
    s_waitcnt lgkmcnt(12)
    v_mfma_f32_16x16x32_bf16 v[168:171], v[200:203], v[24:27], v[168:171]
    v_mfma_f32_16x16x32_bf16 v[236:239], v[240:243], v[32:35], v[236:239]
    v_cvt_pk_bf16_f32 v40, v40, v41
    v_cvt_pk_bf16_f32 v41, v42, v43
    ds_read_b64_tr_b16 v[180:181], v233 offset:0
    ds_read_b64_tr_b16 v[182:183], v233 offset:4096
    s_waitcnt lgkmcnt(12)
    v_mfma_f32_16x16x32_bf16 v[172:175], v[204:207], v[24:27], v[172:175]
    v_cvt_pk_bf16_f32 v42, v44, v45
    v_cvt_pk_bf16_f32 v43, v46, v47
    ds_read_b64_tr_b16 v[184:185], v234 offset:0
    ds_read_b64_tr_b16 v[186:187], v234 offset:4096
    s_waitcnt lgkmcnt(12)
    v_mfma_f32_16x16x32_bf16 v[144:147], v[208:211], v[32:35], v[144:147]
    v_fma_f32 v48, v48, s41, -v247
    v_fma_f32 v49, v49, s41, -v247
    v_mfma_f32_16x16x32_bf16 v[236:239], v[240:243], v[40:43], v[236:239]
    ds_read_b64_tr_b16 v[188:189], v235 offset:0
    ds_read_b64_tr_b16 v[190:191], v235 offset:4096
    s_waitcnt lgkmcnt(12)
    v_mfma_f32_16x16x32_bf16 v[148:151], v[212:215], v[32:35], v[148:151]
    v_fma_f32 v50, v50, s41, -v247
    v_fma_f32 v51, v51, s41, -v247
    v_fma_f32 v52, v52, s41, -v247
    s_cmp_lg_u32 s3, 5
    s_cbranch_scc1 L_nf_11
    s_lshl_b32 s46, s2, 7
    s_add_u32 s46, s46, 33554432
    s_mov_b64 exec, 1
    v_mov_b32 v254, 0
    v_mov_b32 v252, s92
    v_mov_b32 v253, s93
    buffer_store_dwordx2 v[252:253], v254, s[24:27], s46 offen sc1
    s_mov_b64 exec, -1
L_nf_11:
    ds_read_b64_tr_b16 v[192:193], v228 offset:8192
    ds_read_b64_tr_b16 v[194:195], v228 offset:12288
    s_waitcnt lgkmcnt(12)
    v_mfma_f32_16x16x32_bf16 v[152:155], v[216:219], v[32:35], v[152:155]
    v_fma_f32 v53, v53, s41, -v247
    v_fma_f32 v54, v54, s41, -v247
    ds_read_b64_tr_b16 v[196:197], v229 offset:8192
    ds_read_b64_tr_b16 v[198:199], v229 offset:12288
    s_waitcnt lgkmcnt(12)
    v_mfma_f32_16x16x32_bf16 v[156:159], v[220:223], v[32:35], v[156:159]
    v_fma_f32 v55, v55, s41, -v247
    v_exp_f32 v48, v48
    v_exp_f32 v49, v49
    ds_read_b64_tr_b16 v[200:201], v230 offset:8192
    ds_read_b64_tr_b16 v[202:203], v230 offset:12288
    s_waitcnt lgkmcnt(12)
    v_mfma_f32_16x16x32_bf16 v[160:163], v[176:179], v[32:35], v[160:163]
    v_exp_f32 v50, v50
    v_exp_f32 v51, v51
    v_exp_f32 v52, v52
    ds_read_b64_tr_b16 v[204:205], v231 offset:8192
    ds_read_b64_tr_b16 v[206:207], v231 offset:12288
    s_waitcnt lgkmcnt(12)
    v_mfma_f32_16x16x32_bf16 v[164:167], v[180:183], v[32:35], v[164:167]
    v_exp_f32 v53, v53
    v_exp_f32 v54, v54
    ds_read_b64_tr_b16 v[208:209], v232 offset:8192
    ds_read_b64_tr_b16 v[210:211], v232 offset:12288
    s_waitcnt lgkmcnt(12)
    v_mfma_f32_16x16x32_bf16 v[168:171], v[184:187], v[32:35], v[168:171]
    v_exp_f32 v55, v55
    v_fma_f32 v56, v56, s41, -v247
    v_fma_f32 v57, v57, s41, -v247
    ds_read_b64_tr_b16 v[212:213], v233 offset:8192
    ds_read_b64_tr_b16 v[214:215], v233 offset:12288
    s_waitcnt lgkmcnt(12)
    v_mfma_f32_16x16x32_bf16 v[172:175], v[188:191], v[32:35], v[172:175]
    v_fma_f32 v58, v58, s41, -v247
    v_fma_f32 v59, v59, s41, -v247
    ds_read_b64_tr_b16 v[216:217], v234 offset:8192
    ds_read_b64_tr_b16 v[218:219], v234 offset:12288
    s_waitcnt lgkmcnt(12)
    v_mfma_f32_16x16x32_bf16 v[144:147], v[192:195], v[40:43], v[144:147]
    v_fma_f32 v60, v60, s41, -v247
    v_fma_f32 v61, v61, s41, -v247
    v_fma_f32 v62, v62, s41, -v247
    ds_read_b64_tr_b16 v[220:221], v235 offset:8192
    ds_read_b64_tr_b16 v[222:223], v235 offset:12288
    s_waitcnt lgkmcnt(12)
    v_mfma_f32_16x16x32_bf16 v[148:151], v[196:199], v[40:43], v[148:151]
    v_fma_f32 v63, v63, s41, -v247
    v_cvt_pk_bf16_f32 v48, v48, v49
    v_cvt_pk_bf16_f32 v49, v50, v51
    s_barrier
    ds_read_b64_tr_b16 v[176:177], v228 offset:16384
    ds_read_b64_tr_b16 v[178:179], v228 offset:20480
    s_waitcnt lgkmcnt(12)
    v_mfma_f32_16x16x32_bf16 v[152:155], v[200:203], v[40:43], v[152:155]
    v_cvt_pk_bf16_f32 v50, v52, v53
    v_cvt_pk_bf16_f32 v51, v54, v55
    ds_read_b64_tr_b16 v[180:181], v229 offset:16384
    ds_read_b64_tr_b16 v[182:183], v229 offset:20480
    s_waitcnt lgkmcnt(12)
    v_mfma_f32_16x16x32_bf16 v[156:159], v[204:207], v[40:43], v[156:159]
    v_exp_f32 v56, v56
    v_exp_f32 v57, v57
    v_exp_f32 v58, v58
    ds_read_b64_tr_b16 v[184:185], v230 offset:16384
    ds_read_b64_tr_b16 v[186:187], v230 offset:20480
    s_waitcnt lgkmcnt(12)
    v_mfma_f32_16x16x32_bf16 v[160:163], v[208:211], v[40:43], v[160:163]
    v_exp_f32 v59, v59
    v_exp_f32 v60, v60
    v_exp_f32 v61, v61
    ds_read_b64_tr_b16 v[188:189], v231 offset:16384
    ds_read_b64_tr_b16 v[190:191], v231 offset:20480
    s_waitcnt lgkmcnt(12)
    v_mfma_f32_16x16x32_bf16 v[164:167], v[212:215], v[40:43], v[164:167]
    v_exp_f32 v62, v62
    v_exp_f32 v63, v63
    ds_read_b64_tr_b16 v[192:193], v232 offset:16384
    ds_read_b64_tr_b16 v[194:195], v232 offset:20480
    s_waitcnt lgkmcnt(12)
    v_mfma_f32_16x16x32_bf16 v[168:171], v[216:219], v[40:43], v[168:171]
    v_mfma_f32_16x16x32_bf16 v[236:239], v[240:243], v[48:51], v[236:239]
    v_cvt_pk_bf16_f32 v56, v56, v57
    v_cvt_pk_bf16_f32 v57, v58, v59
    ds_read_b64_tr_b16 v[196:197], v233 offset:16384
    ds_read_b64_tr_b16 v[198:199], v233 offset:20480
    s_waitcnt lgkmcnt(12)
    v_mfma_f32_16x16x32_bf16 v[172:175], v[220:223], v[40:43], v[172:175]
    v_cvt_pk_bf16_f32 v58, v60, v61
    v_cvt_pk_bf16_f32 v59, v62, v63
    ds_read_b64_tr_b16 v[200:201], v234 offset:16384
    ds_read_b64_tr_b16 v[202:203], v234 offset:20480
    s_waitcnt lgkmcnt(12)
    v_mfma_f32_16x16x32_bf16 v[144:147], v[176:179], v[48:51], v[144:147]
    v_fma_f32 v64, v64, s41, -v247
    v_fma_f32 v65, v65, s41, -v247
    v_mfma_f32_16x16x32_bf16 v[236:239], v[240:243], v[56:59], v[236:239]
    ds_read_b64_tr_b16 v[204:205], v235 offset:16384
    ds_read_b64_tr_b16 v[206:207], v235 offset:20480
    s_waitcnt lgkmcnt(12)
    v_mfma_f32_16x16x32_bf16 v[148:151], v[180:183], v[48:51], v[148:151]
    v_fma_f32 v66, v66, s41, -v247
    v_fma_f32 v67, v67, s41, -v247
    v_fma_f32 v68, v68, s41, -v247
    ds_read_b64_tr_b16 v[208:209], v228 offset:24576
    ds_read_b64_tr_b16 v[210:211], v228 offset:28672
    s_waitcnt lgkmcnt(12)
    v_mfma_f32_16x16x32_bf16 v[152:155], v[184:187], v[48:51], v[152:155]
    v_fma_f32 v69, v69, s41, -v247
    v_fma_f32 v70, v70, s41, -v247
    ds_read_b64_tr_b16 v[212:213], v229 offset:24576
    ds_read_b64_tr_b16 v[214:215], v229 offset:28672
    s_waitcnt lgkmcnt(12)
    v_mfma_f32_16x16x32_bf16 v[156:159], v[188:191], v[48:51], v[156:159]
    v_fma_f32 v71, v71, s41, -v247
    v_exp_f32 v64, v64
    v_exp_f32 v65, v65
    v_add_u32 v245, 32768, v255
    ds_write_b128 v245, v[128:131] offset:0
    ds_read_b64_tr_b16 v[216:217], v230 offset:24576
    ds_read_b64_tr_b16 v[218:219], v230 offset:28672
    s_waitcnt lgkmcnt(13)
    v_mfma_f32_16x16x32_bf16 v[160:163], v[192:195], v[48:51], v[160:163]
    v_exp_f32 v66, v66
    v_exp_f32 v67, v67
    v_exp_f32 v68, v68
    ds_read_b64_tr_b16 v[220:221], v231 offset:24576
    ds_read_b64_tr_b16 v[222:223], v231 offset:28672
    s_waitcnt lgkmcnt(13)
    v_mfma_f32_16x16x32_bf16 v[164:167], v[196:199], v[48:51], v[164:167]
    v_exp_f32 v69, v69
    v_exp_f32 v70, v70
    ds_read_b64_tr_b16 v[176:177], v232 offset:24576
    ds_read_b64_tr_b16 v[178:179], v232 offset:28672
    s_waitcnt lgkmcnt(13)
    v_mfma_f32_16x16x32_bf16 v[168:171], v[200:203], v[48:51], v[168:171]
    v_exp_f32 v71, v71
    v_fma_f32 v72, v72, s41, -v247
    v_fma_f32 v73, v73, s41, -v247
    ds_write_b128 v245, v[132:135] offset:1024
    s_waitcnt lgkmcnt(12)
    v_mfma_f32_16x16x32_bf16 v[172:175], v[204:207], v[48:51], v[172:175]
    v_fma_f32 v74, v74, s41, -v247
    v_fma_f32 v75, v75, s41, -v247
    ds_read_b64_tr_b16 v[180:181], v233 offset:24576
    ds_read_b64_tr_b16 v[182:183], v233 offset:28672
    s_waitcnt lgkmcnt(12)
    v_mfma_f32_16x16x32_bf16 v[144:147], v[208:211], v[56:59], v[144:147]
    v_fma_f32 v76, v76, s41, -v247
    v_fma_f32 v77, v77, s41, -v247
    v_fma_f32 v78, v78, s41, -v247
    ds_read_b64_tr_b16 v[184:185], v234 offset:24576
    ds_read_b64_tr_b16 v[186:187], v234 offset:28672
    s_waitcnt lgkmcnt(12)
    v_mfma_f32_16x16x32_bf16 v[148:151], v[212:215], v[56:59], v[148:151]
    v_fma_f32 v79, v79, s41, -v247
    v_cvt_pk_bf16_f32 v64, v64, v65
    v_cvt_pk_bf16_f32 v65, v66, v67
    v_add_u32 v245, 0, v255
    ds_write_b128 v245, v[136:139] offset:0
    ds_read_b64_tr_b16 v[188:189], v235 offset:24576
    ds_read_b64_tr_b16 v[190:191], v235 offset:28672
    s_waitcnt lgkmcnt(12)
    v_mfma_f32_16x16x32_bf16 v[152:155], v[216:219], v[56:59], v[152:155]
    v_cvt_pk_bf16_f32 v66, v68, v69
    v_cvt_pk_bf16_f32 v67, v70, v71
    v_xor_b32 v228, 0x30000, v228
    v_xor_b32 v229, 0x30000, v229
    v_xor_b32 v230, 0x30000, v230
    v_xor_b32 v231, 0x30000, v231
    v_xor_b32 v232, 0x30000, v232
    v_xor_b32 v233, 0x30000, v233
    v_xor_b32 v234, 0x30000, v234
    v_xor_b32 v235, 0x30000, v235
    s_barrier
    ds_read_b64_tr_b16 v[192:193], v228 offset:0
    ds_read_b64_tr_b16 v[194:195], v228 offset:4096
    s_waitcnt lgkmcnt(12)
    v_mfma_f32_16x16x32_bf16 v[156:159], v[220:223], v[56:59], v[156:159]
    v_exp_f32 v72, v72
    v_exp_f32 v73, v73
    v_exp_f32 v74, v74
    ds_read_b64_tr_b16 v[196:197], v229 offset:0
    ds_read_b64_tr_b16 v[198:199], v229 offset:4096
    s_waitcnt lgkmcnt(12)
    v_mfma_f32_16x16x32_bf16 v[160:163], v[176:179], v[56:59], v[160:163]
    v_exp_f32 v75, v75
    v_exp_f32 v76, v76
    v_exp_f32 v77, v77
    ds_write_b128 v245, v[140:143] offset:1024
    ds_read_b64_tr_b16 v[200:201], v230 offset:0
    ds_read_b64_tr_b16 v[202:203], v230 offset:4096
    s_waitcnt lgkmcnt(12)
    v_mfma_f32_16x16x32_bf16 v[164:167], v[180:183], v[56:59], v[164:167]
    v_exp_f32 v78, v78
    v_exp_f32 v79, v79
    ds_read_b64_tr_b16 v[204:205], v231 offset:0
    ds_read_b64_tr_b16 v[206:207], v231 offset:4096
    s_waitcnt lgkmcnt(12)
    v_mfma_f32_16x16x32_bf16 v[168:171], v[184:187], v[56:59], v[168:171]
    v_mfma_f32_16x16x32_bf16 v[236:239], v[240:243], v[64:67], v[236:239]
    v_cvt_pk_bf16_f32 v72, v72, v73
    v_cvt_pk_bf16_f32 v73, v74, v75
    ds_read_b64_tr_b16 v[208:209], v232 offset:0
    ds_read_b64_tr_b16 v[210:211], v232 offset:4096
    s_waitcnt lgkmcnt(11)
    v_mfma_f32_16x16x32_bf16 v[172:175], v[188:191], v[56:59], v[172:175]
    v_cvt_pk_bf16_f32 v74, v76, v77
    v_cvt_pk_bf16_f32 v75, v78, v79
    ds_read_b64_tr_b16 v[212:213], v233 offset:0
    ds_read_b64_tr_b16 v[214:215], v233 offset:4096
    ds_read_b64_tr_b16 v[216:217], v234 offset:0
    ds_read_b64_tr_b16 v[218:219], v234 offset:4096
    s_waitcnt lgkmcnt(13)
    v_mfma_f32_16x16x32_bf16 v[144:147], v[192:195], v[64:67], v[144:147]
    v_fma_f32 v80, v80, s41, -v247
    v_fma_f32 v81, v81, s41, -v247
    v_mfma_f32_16x16x32_bf16 v[236:239], v[240:243], v[72:75], v[236:239]
    ds_read_b64_tr_b16 v[220:221], v235 offset:0
    ds_read_b64_tr_b16 v[222:223], v235 offset:4096
    s_waitcnt lgkmcnt(13)
    v_mfma_f32_16x16x32_bf16 v[148:151], v[196:199], v[64:67], v[148:151]
    v_fma_f32 v82, v82, s41, -v247
    v_fma_f32 v83, v83, s41, -v247
    v_fma_f32 v84, v84, s41, -v247
    ds_read_b64_tr_b16 v[176:177], v228 offset:8192
    ds_read_b64_tr_b16 v[178:179], v228 offset:12288
    s_waitcnt lgkmcnt(12)
    v_mfma_f32_16x16x32_bf16 v[152:155], v[200:203], v[64:67], v[152:155]
    v_fma_f32 v85, v85, s41, -v247
    v_fma_f32 v86, v86, s41, -v247
    ds_read_b64_tr_b16 v[180:181], v229 offset:8192
    ds_read_b64_tr_b16 v[182:183], v229 offset:12288
    s_waitcnt lgkmcnt(12)
    v_mfma_f32_16x16x32_bf16 v[156:159], v[204:207], v[64:67], v[156:159]
    v_fma_f32 v87, v87, s41, -v247
    v_exp_f32 v80, v80
    v_exp_f32 v81, v81
    ds_read_b64_tr_b16 v[184:185], v230 offset:8192
    ds_read_b64_tr_b16 v[186:187], v230 offset:12288
    s_waitcnt lgkmcnt(12)
    v_mfma_f32_16x16x32_bf16 v[160:163], v[208:211], v[64:67], v[160:163]
    v_exp_f32 v82, v82
    v_exp_f32 v83, v83
    v_exp_f32 v84, v84
    ds_read_b64_tr_b16 v[188:189], v231 offset:8192
    ds_read_b64_tr_b16 v[190:191], v231 offset:12288
    s_waitcnt lgkmcnt(12)
    v_mfma_f32_16x16x32_bf16 v[164:167], v[212:215], v[64:67], v[164:167]
    v_exp_f32 v85, v85
    v_exp_f32 v86, v86
    ds_read_b64_tr_b16 v[192:193], v232 offset:8192
    ds_read_b64_tr_b16 v[194:195], v232 offset:12288
    s_waitcnt lgkmcnt(12)
    v_mfma_f32_16x16x32_bf16 v[168:171], v[216:219], v[64:67], v[168:171]
    v_exp_f32 v87, v87
    v_fma_f32 v88, v88, s41, -v247
    v_fma_f32 v89, v89, s41, -v247
    ds_read_b64_tr_b16 v[196:197], v233 offset:8192
    ds_read_b64_tr_b16 v[198:199], v233 offset:12288
    s_waitcnt lgkmcnt(12)
    v_mfma_f32_16x16x32_bf16 v[172:175], v[220:223], v[64:67], v[172:175]
    v_fma_f32 v90, v90, s41, -v247
    v_fma_f32 v91, v91, s41, -v247
    ds_read_b64_tr_b16 v[200:201], v234 offset:8192
    ds_read_b64_tr_b16 v[202:203], v234 offset:12288
    s_waitcnt lgkmcnt(12)
    v_mfma_f32_16x16x32_bf16 v[144:147], v[176:179], v[72:75], v[144:147]
    v_fma_f32 v92, v92, s41, -v247
    v_fma_f32 v93, v93, s41, -v247
    v_fma_f32 v94, v94, s41, -v247
    ds_read_b64_tr_b16 v[204:205], v235 offset:8192
    ds_read_b64_tr_b16 v[206:207], v235 offset:12288
    s_waitcnt lgkmcnt(12)
    v_mfma_f32_16x16x32_bf16 v[148:151], v[180:183], v[72:75], v[148:151]
    v_fma_f32 v95, v95, s41, -v247
    v_cvt_pk_bf16_f32 v80, v80, v81
    v_cvt_pk_bf16_f32 v81, v82, v83
    s_barrier
    ds_read_b64_tr_b16 v[208:209], v228 offset:16384
    ds_read_b64_tr_b16 v[210:211], v228 offset:20480
    s_waitcnt lgkmcnt(12)
    v_mfma_f32_16x16x32_bf16 v[152:155], v[184:187], v[72:75], v[152:155]
    v_cvt_pk_bf16_f32 v82, v84, v85
    v_cvt_pk_bf16_f32 v83, v86, v87
    ds_read_b64_tr_b16 v[212:213], v229 offset:16384
    ds_read_b64_tr_b16 v[214:215], v229 offset:20480
    s_waitcnt lgkmcnt(12)
    v_mfma_f32_16x16x32_bf16 v[156:159], v[188:191], v[72:75], v[156:159]
    v_exp_f32 v88, v88
    v_exp_f32 v89, v89
    v_exp_f32 v90, v90
    ds_read_b64_tr_b16 v[216:217], v230 offset:16384
    ds_read_b64_tr_b16 v[218:219], v230 offset:20480
    s_waitcnt lgkmcnt(12)
    v_mfma_f32_16x16x32_bf16 v[160:163], v[192:195], v[72:75], v[160:163]
    v_exp_f32 v91, v91
    v_exp_f32 v92, v92
    v_exp_f32 v93, v93
    ds_read_b64_tr_b16 v[220:221], v231 offset:16384
    ds_read_b64_tr_b16 v[222:223], v231 offset:20480
    s_waitcnt lgkmcnt(12)
    v_mfma_f32_16x16x32_bf16 v[164:167], v[196:199], v[72:75], v[164:167]
    v_exp_f32 v94, v94
    v_exp_f32 v95, v95
    ds_read_b64_tr_b16 v[176:177], v232 offset:16384
    ds_read_b64_tr_b16 v[178:179], v232 offset:20480
    s_waitcnt lgkmcnt(12)
    v_mfma_f32_16x16x32_bf16 v[168:171], v[200:203], v[72:75], v[168:171]
    v_mfma_f32_16x16x32_bf16 v[236:239], v[240:243], v[80:83], v[236:239]
    v_cvt_pk_bf16_f32 v88, v88, v89
    v_cvt_pk_bf16_f32 v89, v90, v91
    ds_read_b64_tr_b16 v[180:181], v233 offset:16384
    ds_read_b64_tr_b16 v[182:183], v233 offset:20480
    s_waitcnt lgkmcnt(12)
    v_mfma_f32_16x16x32_bf16 v[172:175], v[204:207], v[72:75], v[172:175]
    v_cvt_pk_bf16_f32 v90, v92, v93
    v_cvt_pk_bf16_f32 v91, v94, v95
    ds_read_b64_tr_b16 v[184:185], v234 offset:16384
    ds_read_b64_tr_b16 v[186:187], v234 offset:20480
    s_waitcnt lgkmcnt(12)
    v_mfma_f32_16x16x32_bf16 v[144:147], v[208:211], v[80:83], v[144:147]
    v_fma_f32 v96, v96, s41, -v247
    v_fma_f32 v97, v97, s41, -v247
    v_mfma_f32_16x16x32_bf16 v[236:239], v[240:243], v[88:91], v[236:239]
    ds_read_b64_tr_b16 v[188:189], v235 offset:16384
    ds_read_b64_tr_b16 v[190:191], v235 offset:20480
    s_waitcnt lgkmcnt(12)
    v_mfma_f32_16x16x32_bf16 v[148:151], v[212:215], v[80:83], v[148:151]
    v_fma_f32 v98, v98, s41, -v247
    v_fma_f32 v99, v99, s41, -v247
    v_fma_f32 v100, v100, s41, -v247
    ds_read_b64_tr_b16 v[192:193], v228 offset:24576
    ds_read_b64_tr_b16 v[194:195], v228 offset:28672
    s_waitcnt lgkmcnt(12)
    v_mfma_f32_16x16x32_bf16 v[152:155], v[216:219], v[80:83], v[152:155]
    v_fma_f32 v101, v101, s41, -v247
    v_fma_f32 v102, v102, s41, -v247
    ds_read_b64_tr_b16 v[196:197], v229 offset:24576
    ds_read_b64_tr_b16 v[198:199], v229 offset:28672
    s_waitcnt lgkmcnt(12)
    v_mfma_f32_16x16x32_bf16 v[156:159], v[220:223], v[80:83], v[156:159]
    v_fma_f32 v103, v103, s41, -v247
    v_exp_f32 v96, v96
    v_exp_f32 v97, v97
    ds_read_b64_tr_b16 v[200:201], v230 offset:24576
    ds_read_b64_tr_b16 v[202:203], v230 offset:28672
    s_waitcnt lgkmcnt(12)
    v_mfma_f32_16x16x32_bf16 v[160:163], v[176:179], v[80:83], v[160:163]
    v_exp_f32 v98, v98
    v_exp_f32 v99, v99
    v_exp_f32 v100, v100
    ds_read_b64_tr_b16 v[204:205], v231 offset:24576
    ds_read_b64_tr_b16 v[206:207], v231 offset:28672
    s_waitcnt lgkmcnt(12)
    v_mfma_f32_16x16x32_bf16 v[164:167], v[180:183], v[80:83], v[164:167]
    v_exp_f32 v101, v101
    v_exp_f32 v102, v102
    ds_read_b64_tr_b16 v[208:209], v232 offset:24576
    ds_read_b64_tr_b16 v[210:211], v232 offset:28672
    s_waitcnt lgkmcnt(12)
    v_mfma_f32_16x16x32_bf16 v[168:171], v[184:187], v[80:83], v[168:171]
    v_exp_f32 v103, v103
    v_fma_f32 v104, v104, s41, -v247
    v_fma_f32 v105, v105, s41, -v247
    ds_read_b64_tr_b16 v[212:213], v233 offset:24576
    ds_read_b64_tr_b16 v[214:215], v233 offset:28672
    s_waitcnt lgkmcnt(12)
    v_mfma_f32_16x16x32_bf16 v[172:175], v[188:191], v[80:83], v[172:175]
    v_fma_f32 v106, v106, s41, -v247
    v_fma_f32 v107, v107, s41, -v247
    ds_read_b64_tr_b16 v[216:217], v234 offset:24576
    ds_read_b64_tr_b16 v[218:219], v234 offset:28672
    s_waitcnt lgkmcnt(12)
    v_mfma_f32_16x16x32_bf16 v[144:147], v[192:195], v[88:91], v[144:147]
    v_fma_f32 v108, v108, s41, -v247
    v_fma_f32 v109, v109, s41, -v247
    v_fma_f32 v110, v110, s41, -v247
    ds_read_b64_tr_b16 v[220:221], v235 offset:24576
    ds_read_b64_tr_b16 v[222:223], v235 offset:28672
    s_waitcnt lgkmcnt(12)
    v_mfma_f32_16x16x32_bf16 v[148:151], v[196:199], v[88:91], v[148:151]
    v_fma_f32 v111, v111, s41, -v247
    v_cvt_pk_bf16_f32 v96, v96, v97
    v_cvt_pk_bf16_f32 v97, v98, v99
    v_xor_b32 v228, 0x30000, v228
    v_xor_b32 v229, 0x30000, v229
    v_xor_b32 v230, 0x30000, v230
    v_xor_b32 v231, 0x30000, v231
    v_xor_b32 v232, 0x30000, v232
    v_xor_b32 v233, 0x30000, v233
    v_xor_b32 v234, 0x30000, v234
    v_xor_b32 v235, 0x30000, v235
    s_barrier
    ds_read_b64_tr_b16 v[176:177], v228 offset:32768
    ds_read_b64_tr_b16 v[178:179], v228 offset:36864
    s_waitcnt lgkmcnt(12)
    v_mfma_f32_16x16x32_bf16 v[152:155], v[200:203], v[88:91], v[152:155]
    v_cvt_pk_bf16_f32 v98, v100, v101
    v_cvt_pk_bf16_f32 v99, v102, v103
    ds_read_b64_tr_b16 v[180:181], v229 offset:32768
    ds_read_b64_tr_b16 v[182:183], v229 offset:36864
    s_waitcnt lgkmcnt(12)
    v_mfma_f32_16x16x32_bf16 v[156:159], v[204:207], v[88:91], v[156:159]
    v_exp_f32 v104, v104
    v_exp_f32 v105, v105
    v_exp_f32 v106, v106
    ds_read_b64_tr_b16 v[184:185], v230 offset:32768
    ds_read_b64_tr_b16 v[186:187], v230 offset:36864
    s_waitcnt lgkmcnt(12)
    v_mfma_f32_16x16x32_bf16 v[160:163], v[208:211], v[88:91], v[160:163]
    v_exp_f32 v107, v107
    v_exp_f32 v108, v108
    v_exp_f32 v109, v109
    ds_read_b64_tr_b16 v[188:189], v231 offset:32768
    ds_read_b64_tr_b16 v[190:191], v231 offset:36864
    s_waitcnt lgkmcnt(12)
    v_mfma_f32_16x16x32_bf16 v[164:167], v[212:215], v[88:91], v[164:167]
    v_exp_f32 v110, v110
    v_exp_f32 v111, v111
    ds_read_b64_tr_b16 v[192:193], v232 offset:32768
    ds_read_b64_tr_b16 v[194:195], v232 offset:36864
    s_waitcnt lgkmcnt(12)
    v_mfma_f32_16x16x32_bf16 v[168:171], v[216:219], v[88:91], v[168:171]
    v_mfma_f32_16x16x32_bf16 v[236:239], v[240:243], v[96:99], v[236:239]
    v_cvt_pk_bf16_f32 v104, v104, v105
    v_cvt_pk_bf16_f32 v105, v106, v107
    ds_read_b64_tr_b16 v[196:197], v233 offset:32768
    ds_read_b64_tr_b16 v[198:199], v233 offset:36864
    s_waitcnt lgkmcnt(12)
    v_mfma_f32_16x16x32_bf16 v[172:175], v[220:223], v[88:91], v[172:175]
    v_cvt_pk_bf16_f32 v106, v108, v109
    v_cvt_pk_bf16_f32 v107, v110, v111
    ds_read_b64_tr_b16 v[200:201], v234 offset:32768
    ds_read_b64_tr_b16 v[202:203], v234 offset:36864
    s_waitcnt lgkmcnt(12)
    v_mfma_f32_16x16x32_bf16 v[144:147], v[176:179], v[96:99], v[144:147]
    v_fma_f32 v112, v112, s41, -v247
    v_fma_f32 v113, v113, s41, -v247
    v_mfma_f32_16x16x32_bf16 v[236:239], v[240:243], v[104:107], v[236:239]
    ds_read_b64_tr_b16 v[204:205], v235 offset:32768
    ds_read_b64_tr_b16 v[206:207], v235 offset:36864
    s_waitcnt lgkmcnt(12)
    v_mfma_f32_16x16x32_bf16 v[148:151], v[180:183], v[96:99], v[148:151]
    v_fma_f32 v114, v114, s41, -v247
    v_fma_f32 v115, v115, s41, -v247
    v_fma_f32 v116, v116, s41, -v247
    s_cmp_lg_u32 s3, 5
    s_cbranch_scc1 L_np_12
    s_and_b32 s100, s2, 0x3f
    v_and_b32 v254, 3, v249
    v_lshlrev_b32 v254, 13, v254
    s_lshl_b32 s100, s100, 7
    s_add_u32 s100, s100, 33554432
    s_mov_b64 exec, 15
    buffer_load_dwordx2 v[252:253], v254, s[24:27], s100 offen sc1
    s_mov_b64 exec, -1
L_np_12:
    ds_read_b64_tr_b16 v[208:209], v228 offset:40960
    ds_read_b64_tr_b16 v[210:211], v228 offset:45056
    s_waitcnt lgkmcnt(12)
    v_mfma_f32_16x16x32_bf16 v[152:155], v[184:187], v[96:99], v[152:155]
    v_fma_f32 v117, v117, s41, -v247
    v_fma_f32 v118, v118, s41, -v247
    ds_read_b64_tr_b16 v[212:213], v229 offset:40960
    ds_read_b64_tr_b16 v[214:215], v229 offset:45056
    s_waitcnt lgkmcnt(12)
    v_mfma_f32_16x16x32_bf16 v[156:159], v[188:191], v[96:99], v[156:159]
    v_fma_f32 v119, v119, s41, -v247
    v_exp_f32 v112, v112
    v_exp_f32 v113, v113
    ds_read_b64_tr_b16 v[216:217], v230 offset:40960
    ds_read_b64_tr_b16 v[218:219], v230 offset:45056
    s_waitcnt lgkmcnt(12)
    v_mfma_f32_16x16x32_bf16 v[160:163], v[192:195], v[96:99], v[160:163]
    v_exp_f32 v114, v114
    v_exp_f32 v115, v115
    v_exp_f32 v116, v116
    ds_read_b64_tr_b16 v[220:221], v231 offset:40960
    ds_read_b64_tr_b16 v[222:223], v231 offset:45056
    s_waitcnt lgkmcnt(12)
    v_mfma_f32_16x16x32_bf16 v[164:167], v[196:199], v[96:99], v[164:167]
    v_exp_f32 v117, v117
    v_exp_f32 v118, v118
    ds_read_b64_tr_b16 v[176:177], v232 offset:40960
    ds_read_b64_tr_b16 v[178:179], v232 offset:45056
    s_waitcnt lgkmcnt(12)
    v_mfma_f32_16x16x32_bf16 v[168:171], v[200:203], v[96:99], v[168:171]
    v_exp_f32 v119, v119
    v_fma_f32 v120, v120, s41, -v247
    v_fma_f32 v121, v121, s41, -v247
    ds_read_b64_tr_b16 v[180:181], v233 offset:40960
    ds_read_b64_tr_b16 v[182:183], v233 offset:45056
    s_waitcnt lgkmcnt(12)
    v_mfma_f32_16x16x32_bf16 v[172:175], v[204:207], v[96:99], v[172:175]
    v_fma_f32 v122, v122, s41, -v247
    v_fma_f32 v123, v123, s41, -v247
    ds_read_b64_tr_b16 v[184:185], v234 offset:40960
    ds_read_b64_tr_b16 v[186:187], v234 offset:45056
    s_waitcnt lgkmcnt(12)
    v_mfma_f32_16x16x32_bf16 v[144:147], v[208:211], v[104:107], v[144:147]
    v_fma_f32 v124, v124, s41, -v247
    v_fma_f32 v125, v125, s41, -v247
    v_fma_f32 v126, v126, s41, -v247
    ds_read_b64_tr_b16 v[188:189], v235 offset:40960
    ds_read_b64_tr_b16 v[190:191], v235 offset:45056
    s_waitcnt lgkmcnt(12)
    v_mfma_f32_16x16x32_bf16 v[148:151], v[212:215], v[104:107], v[148:151]
    v_fma_f32 v127, v127, s41, -v247
    v_cvt_pk_bf16_f32 v112, v112, v113
    v_cvt_pk_bf16_f32 v113, v114, v115
    s_barrier
    ds_read_b64_tr_b16 v[192:193], v228 offset:49152
    ds_read_b64_tr_b16 v[194:195], v228 offset:53248
    s_waitcnt lgkmcnt(12)
    v_mfma_f32_16x16x32_bf16 v[152:155], v[216:219], v[104:107], v[152:155]
    v_cvt_pk_bf16_f32 v114, v116, v117
    v_cvt_pk_bf16_f32 v115, v118, v119
    ds_read_b64_tr_b16 v[196:197], v229 offset:49152
    ds_read_b64_tr_b16 v[198:199], v229 offset:53248
    s_waitcnt lgkmcnt(12)
    v_mfma_f32_16x16x32_bf16 v[156:159], v[220:223], v[104:107], v[156:159]
    v_exp_f32 v120, v120
    v_exp_f32 v121, v121
    v_exp_f32 v122, v122
    ds_read_b64_tr_b16 v[200:201], v230 offset:49152
    ds_read_b64_tr_b16 v[202:203], v230 offset:53248
    s_waitcnt lgkmcnt(12)
    v_mfma_f32_16x16x32_bf16 v[160:163], v[176:179], v[104:107], v[160:163]
    v_exp_f32 v123, v123
    v_exp_f32 v124, v124
    v_exp_f32 v125, v125
    ds_read_b64_tr_b16 v[204:205], v231 offset:49152
    ds_read_b64_tr_b16 v[206:207], v231 offset:53248
    s_waitcnt lgkmcnt(12)
    v_mfma_f32_16x16x32_bf16 v[164:167], v[180:183], v[104:107], v[164:167]
    v_exp_f32 v126, v126
    v_exp_f32 v127, v127
    ds_read_b64_tr_b16 v[208:209], v232 offset:49152
    ds_read_b64_tr_b16 v[210:211], v232 offset:53248
    s_waitcnt lgkmcnt(12)
    v_mfma_f32_16x16x32_bf16 v[168:171], v[184:187], v[104:107], v[168:171]
    v_mfma_f32_16x16x32_bf16 v[236:239], v[240:243], v[112:115], v[236:239]
    v_cvt_pk_bf16_f32 v120, v120, v121
    v_cvt_pk_bf16_f32 v121, v122, v123
    ds_read_b64_tr_b16 v[212:213], v233 offset:49152
    ds_read_b64_tr_b16 v[214:215], v233 offset:53248
    s_waitcnt lgkmcnt(12)
    v_mfma_f32_16x16x32_bf16 v[172:175], v[188:191], v[104:107], v[172:175]
    v_cvt_pk_bf16_f32 v122, v124, v125
    v_cvt_pk_bf16_f32 v123, v126, v127
    ds_read_b64_tr_b16 v[216:217], v234 offset:49152
    ds_read_b64_tr_b16 v[218:219], v234 offset:53248
    s_waitcnt lgkmcnt(12)
    v_mfma_f32_16x16x32_bf16 v[144:147], v[192:195], v[112:115], v[144:147]
    s_nop 0
    s_nop 0
    v_mfma_f32_16x16x32_bf16 v[236:239], v[240:243], v[120:123], v[236:239]
    ds_read_b64_tr_b16 v[220:221], v235 offset:49152
    ds_read_b64_tr_b16 v[222:223], v235 offset:53248
    s_waitcnt lgkmcnt(12)
    v_mfma_f32_16x16x32_bf16 v[148:151], v[196:199], v[112:115], v[148:151]
    ds_read_b64_tr_b16 v[176:177], v228 offset:57344
    ds_read_b64_tr_b16 v[178:179], v228 offset:61440
    s_waitcnt lgkmcnt(12)
    v_mfma_f32_16x16x32_bf16 v[152:155], v[200:203], v[112:115], v[152:155]
    ds_read_b64_tr_b16 v[180:181], v229 offset:57344
    ds_read_b64_tr_b16 v[182:183], v229 offset:61440
    s_waitcnt lgkmcnt(12)
    v_mfma_f32_16x16x32_bf16 v[156:159], v[204:207], v[112:115], v[156:159]
    ds_read_b64_tr_b16 v[184:185], v230 offset:57344
    ds_read_b64_tr_b16 v[186:187], v230 offset:61440
    s_waitcnt lgkmcnt(12)
    v_mfma_f32_16x16x32_bf16 v[160:163], v[208:211], v[112:115], v[160:163]
    ds_read_b64_tr_b16 v[188:189], v231 offset:57344
    ds_read_b64_tr_b16 v[190:191], v231 offset:61440
    s_waitcnt lgkmcnt(12)
    v_mfma_f32_16x16x32_bf16 v[164:167], v[212:215], v[112:115], v[164:167]
    ds_read_b64_tr_b16 v[192:193], v232 offset:57344
    ds_read_b64_tr_b16 v[194:195], v232 offset:61440
    s_waitcnt lgkmcnt(12)
    v_mfma_f32_16x16x32_bf16 v[168:171], v[216:219], v[112:115], v[168:171]
    ds_read_b64_tr_b16 v[196:197], v233 offset:57344
    ds_read_b64_tr_b16 v[198:199], v233 offset:61440
    s_waitcnt lgkmcnt(12)
    v_mfma_f32_16x16x32_bf16 v[172:175], v[220:223], v[112:115], v[172:175]
    ds_read_b64_tr_b16 v[200:201], v234 offset:57344
    ds_read_b64_tr_b16 v[202:203], v234 offset:61440
    s_waitcnt lgkmcnt(12)
    v_mfma_f32_16x16x32_bf16 v[144:147], v[176:179], v[120:123], v[144:147]
    ds_read_b64_tr_b16 v[204:205], v235 offset:57344
    ds_read_b64_tr_b16 v[206:207], v235 offset:61440
    s_waitcnt lgkmcnt(12)
    v_mfma_f32_16x16x32_bf16 v[148:151], v[180:183], v[120:123], v[148:151]
    s_waitcnt lgkmcnt(10)
    v_mfma_f32_16x16x32_bf16 v[152:155], v[184:187], v[120:123], v[152:155]
    v_rcp_f32 v246, v236
    s_waitcnt lgkmcnt(8)
    v_mfma_f32_16x16x32_bf16 v[156:159], v[188:191], v[120:123], v[156:159]
    s_waitcnt lgkmcnt(6)
    v_mfma_f32_16x16x32_bf16 v[160:163], v[192:195], v[120:123], v[160:163]
    s_waitcnt lgkmcnt(4)
    v_mfma_f32_16x16x32_bf16 v[164:167], v[196:199], v[120:123], v[164:167]
    s_waitcnt lgkmcnt(2)
    v_mfma_f32_16x16x32_bf16 v[168:171], v[200:203], v[120:123], v[168:171]
    s_waitcnt lgkmcnt(0)
    v_mfma_f32_16x16x32_bf16 v[172:175], v[204:207], v[120:123], v[172:175]
    s_nop 7
    v_mul_f32 v144, v246, v144
    v_mul_f32 v145, v246, v145
    v_mul_f32 v146, v246, v146
    v_mul_f32 v147, v246, v147
    v_mul_f32 v148, v246, v148
    v_mul_f32 v149, v246, v149
    v_mul_f32 v150, v246, v150
    v_mul_f32 v151, v246, v151
    v_cvt_pk_bf16_f32 v144, v144, v145
    v_cvt_pk_bf16_f32 v145, v146, v147
    v_cvt_pk_bf16_f32 v146, v148, v149
    v_cvt_pk_bf16_f32 v147, v150, v151
    s_add_u32 s40, s50, 65536
    buffer_store_dwordx4 v[144:147], v248, s[24:27], s40 offen offset:0 sc1
    v_add_u32 v245, 65536, v255
    ds_write_b128 v245, v[144:147] offset:0
    v_mul_f32 v152, v246, v152
    v_mul_f32 v153, v246, v153
    v_mul_f32 v154, v246, v154
    v_mul_f32 v155, v246, v155
    v_mul_f32 v156, v246, v156
    v_mul_f32 v157, v246, v157
    v_mul_f32 v158, v246, v158
    v_mul_f32 v159, v246, v159
    v_cvt_pk_bf16_f32 v152, v152, v153
    v_cvt_pk_bf16_f32 v153, v154, v155
    v_cvt_pk_bf16_f32 v154, v156, v157
    v_cvt_pk_bf16_f32 v155, v158, v159
    buffer_store_dwordx4 v[152:155], v248, s[24:27], s40 offen offset:1024 sc1
    ds_write_b128 v245, v[152:155] offset:1024
    v_mul_f32 v160, v246, v160
    v_mul_f32 v161, v246, v161
    v_mul_f32 v162, v246, v162
    v_mul_f32 v163, v246, v163
    v_mul_f32 v164, v246, v164
    v_mul_f32 v165, v246, v165
    v_mul_f32 v166, v246, v166
    v_mul_f32 v167, v246, v167
    v_cvt_pk_bf16_f32 v160, v160, v161
    v_cvt_pk_bf16_f32 v161, v162, v163
    v_cvt_pk_bf16_f32 v162, v164, v165
    v_cvt_pk_bf16_f32 v163, v166, v167
    buffer_store_dwordx4 v[160:163], v248, s[24:27], s40 offen offset:2048 sc1
    v_add_u32 v245, 131072, v255
    ds_write_b128 v245, v[160:163] offset:0
    v_mul_f32 v168, v246, v168
    v_mul_f32 v169, v246, v169
    v_mul_f32 v170, v246, v170
    v_mul_f32 v171, v246, v171
    v_mul_f32 v172, v246, v172
    v_mul_f32 v173, v246, v173
    v_mul_f32 v174, v246, v174
    v_mul_f32 v175, v246, v175
    v_cvt_pk_bf16_f32 v168, v168, v169
    v_cvt_pk_bf16_f32 v169, v170, v171
    v_cvt_pk_bf16_f32 v170, v172, v173
    v_cvt_pk_bf16_f32 v171, v174, v175
    buffer_store_dwordx4 v[168:171], v248, s[24:27], s40 offen offset:3072 sc1
    ds_write_b128 v245, v[168:171] offset:1024
    s_cmp_lt_u32 s3, 4
    s_cbranch_scc1 L_gcons
    s_cmp_eq_u32 s3, 5
    s_cbranch_scc1 L_poll
    v_lshlrev_b32 v0, 4, v249
    v_add_u32 v1, 129024, v0
    v_add_u32 v2, 262144, v0
    v_add_u32 v3, 391168, v0
    v_add_u32 v4, 524288, v0
    v_add_u32 v5, 653312, v0
    s_waitcnt lgkmcnt(0)
    s_barrier
    s_add_u32 s53, s95, 1
    s_and_b32 s53, s53, 3
    s_lshl_b32 s54, s94, 2
    s_add_u32 s53, s53, s54
    s_lshl_b32 s98, s53, 12
    s_add_u32 s98, s98, s99
    s_mov_b32 m0, 118784
    s_nop 0
    buffer_load_dwordx4 v0, s[24:27], s98 offen offset:0 sc1 lds
    buffer_load_dwordx4 v0, s[24:27], s98 offen offset:1024 sc1 lds
    buffer_load_dwordx4 v1, s[24:27], s98 offen offset:2048 sc1 lds
    buffer_load_dwordx4 v1, s[24:27], s98 offen offset:3072 sc1 lds
    s_mov_b32 m0, 122880
    s_nop 0
    buffer_load_dwordx4 v2, s[24:27], s98 offen offset:0 sc1 lds
    buffer_load_dwordx4 v2, s[24:27], s98 offen offset:1024 sc1 lds
    buffer_load_dwordx4 v3, s[24:27], s98 offen offset:2048 sc1 lds
    buffer_load_dwordx4 v3, s[24:27], s98 offen offset:3072 sc1 lds
    s_mov_b32 m0, 126976
    s_nop 0
    buffer_load_dwordx4 v4, s[24:27], s98 offen offset:0 sc1 lds
    buffer_load_dwordx4 v4, s[24:27], s98 offen offset:1024 sc1 lds
    buffer_load_dwordx4 v5, s[24:27], s98 offen offset:2048 sc1 lds
    buffer_load_dwordx4 v5, s[24:27], s98 offen offset:3072 sc1 lds
    s_barrier
    s_add_u32 s98, s98, 2048
    s_mov_b32 m0, 53248
    s_nop 0
    buffer_load_dwordx4 v0, s[24:27], s98 offen offset:0 sc1 lds
    buffer_load_dwordx4 v0, s[24:27], s98 offen offset:1024 sc1 lds
    buffer_load_dwordx4 v1, s[24:27], s98 offen offset:2048 sc1 lds
    buffer_load_dwordx4 v1, s[24:27], s98 offen offset:3072 sc1 lds
    s_mov_b32 m0, 57344
    s_nop 0
    buffer_load_dwordx4 v2, s[24:27], s98 offen offset:0 sc1 lds
    buffer_load_dwordx4 v2, s[24:27], s98 offen offset:1024 sc1 lds
    buffer_load_dwordx4 v3, s[24:27], s98 offen offset:2048 sc1 lds
    buffer_load_dwordx4 v3, s[24:27], s98 offen offset:3072 sc1 lds
    s_mov_b32 m0, 61440
    s_nop 0
    buffer_load_dwordx4 v4, s[24:27], s98 offen offset:0 sc1 lds
    buffer_load_dwordx4 v4, s[24:27], s98 offen offset:1024 sc1 lds
    buffer_load_dwordx4 v5, s[24:27], s98 offen offset:2048 sc1 lds
    buffer_load_dwordx4 v5, s[24:27], s98 offen offset:3072 sc1 lds
    s_waitcnt vmcnt(24)
    s_barrier
    s_add_u32 s53, s95, 2
    s_and_b32 s53, s53, 3
    s_lshl_b32 s54, s94, 2
    s_add_u32 s53, s53, s54
    s_lshl_b32 s98, s53, 12
    s_add_u32 s98, s98, s99
    s_mov_b32 m0, 20480
    s_nop 0
    buffer_load_dwordx4 v0, s[24:27], s98 offen offset:0 sc1 lds
    buffer_load_dwordx4 v0, s[24:27], s98 offen offset:1024 sc1 lds
    buffer_load_dwordx4 v1, s[24:27], s98 offen offset:2048 sc1 lds
    buffer_load_dwordx4 v1, s[24:27], s98 offen offset:3072 sc1 lds
    s_mov_b32 m0, 24576
    s_nop 0
    buffer_load_dwordx4 v2, s[24:27], s98 offen offset:0 sc1 lds
    buffer_load_dwordx4 v2, s[24:27], s98 offen offset:1024 sc1 lds
    buffer_load_dwordx4 v3, s[24:27], s98 offen offset:2048 sc1 lds
    buffer_load_dwordx4 v3, s[24:27], s98 offen offset:3072 sc1 lds
    s_mov_b32 m0, 28672
    s_nop 0
    buffer_load_dwordx4 v4, s[24:27], s98 offen offset:0 sc1 lds
    buffer_load_dwordx4 v4, s[24:27], s98 offen offset:1024 sc1 lds
    buffer_load_dwordx4 v5, s[24:27], s98 offen offset:2048 sc1 lds
    buffer_load_dwordx4 v5, s[24:27], s98 offen offset:3072 sc1 lds
    s_barrier
    s_add_u32 s98, s98, 2048
    s_mov_b32 m0, 86016
    s_nop 0
    buffer_load_dwordx4 v0, s[24:27], s98 offen offset:0 sc1 lds
    buffer_load_dwordx4 v0, s[24:27], s98 offen offset:1024 sc1 lds
    buffer_load_dwordx4 v1, s[24:27], s98 offen offset:2048 sc1 lds
    buffer_load_dwordx4 v1, s[24:27], s98 offen offset:3072 sc1 lds
    s_mov_b32 m0, 90112
    s_nop 0
    buffer_load_dwordx4 v2, s[24:27], s98 offen offset:0 sc1 lds
    buffer_load_dwordx4 v2, s[24:27], s98 offen offset:1024 sc1 lds
    buffer_load_dwordx4 v3, s[24:27], s98 offen offset:2048 sc1 lds
    buffer_load_dwordx4 v3, s[24:27], s98 offen offset:3072 sc1 lds
    s_mov_b32 m0, 94208
    s_nop 0
    buffer_load_dwordx4 v4, s[24:27], s98 offen offset:0 sc1 lds
    buffer_load_dwordx4 v4, s[24:27], s98 offen offset:1024 sc1 lds
    buffer_load_dwordx4 v5, s[24:27], s98 offen offset:2048 sc1 lds
    buffer_load_dwordx4 v5, s[24:27], s98 offen offset:3072 sc1 lds
    s_waitcnt vmcnt(36)
    s_barrier
    s_add_u32 s53, s95, 3
    s_and_b32 s53, s53, 3
    s_lshl_b32 s54, s94, 2
    s_add_u32 s53, s53, s54
    s_lshl_b32 s98, s53, 12
    s_add_u32 s98, s98, s99
    s_mov_b32 m0, 151552
    s_nop 0
    buffer_load_dwordx4 v0, s[24:27], s98 offen offset:0 sc1 lds
    buffer_load_dwordx4 v0, s[24:27], s98 offen offset:1024 sc1 lds
    buffer_load_dwordx4 v1, s[24:27], s98 offen offset:2048 sc1 lds
    buffer_load_dwordx4 v1, s[24:27], s98 offen offset:3072 sc1 lds
    s_mov_b32 m0, 155648
    s_nop 0
    buffer_load_dwordx4 v2, s[24:27], s98 offen offset:0 sc1 lds
    buffer_load_dwordx4 v2, s[24:27], s98 offen offset:1024 sc1 lds
    buffer_load_dwordx4 v3, s[24:27], s98 offen offset:2048 sc1 lds
    buffer_load_dwordx4 v3, s[24:27], s98 offen offset:3072 sc1 lds
    s_mov_b32 m0, 159744
    s_nop 0
    buffer_load_dwordx4 v4, s[24:27], s98 offen offset:0 sc1 lds
    buffer_load_dwordx4 v4, s[24:27], s98 offen offset:1024 sc1 lds
    buffer_load_dwordx4 v5, s[24:27], s98 offen offset:2048 sc1 lds
    buffer_load_dwordx4 v5, s[24:27], s98 offen offset:3072 sc1 lds
    s_waitcnt vmcnt(36)
    s_barrier
    s_add_u32 s98, s98, 2048
    s_mov_b32 m0, 118784
    s_nop 0
    buffer_load_dwordx4 v0, s[24:27], s98 offen offset:0 sc1 lds
    buffer_load_dwordx4 v0, s[24:27], s98 offen offset:1024 sc1 lds
    buffer_load_dwordx4 v1, s[24:27], s98 offen offset:2048 sc1 lds
    buffer_load_dwordx4 v1, s[24:27], s98 offen offset:3072 sc1 lds
    s_mov_b32 m0, 122880
    s_nop 0
    buffer_load_dwordx4 v2, s[24:27], s98 offen offset:0 sc1 lds
    buffer_load_dwordx4 v2, s[24:27], s98 offen offset:1024 sc1 lds
    buffer_load_dwordx4 v3, s[24:27], s98 offen offset:2048 sc1 lds
    buffer_load_dwordx4 v3, s[24:27], s98 offen offset:3072 sc1 lds
    s_mov_b32 m0, 126976
    s_nop 0
    buffer_load_dwordx4 v4, s[24:27], s98 offen offset:0 sc1 lds
    buffer_load_dwordx4 v4, s[24:27], s98 offen offset:1024 sc1 lds
    buffer_load_dwordx4 v5, s[24:27], s98 offen offset:2048 sc1 lds
    buffer_load_dwordx4 v5, s[24:27], s98 offen offset:3072 sc1 lds
    s_waitcnt vmcnt(36)
    s_barrier
    s_add_u32 s53, s95, 1
    s_and_b32 s53, s53, 3
    s_lshl_b32 s54, s94, 2
    s_add_u32 s53, s53, s54
    s_add_u32 s53, s53, 16
    s_lshl_b32 s98, s53, 12
    s_add_u32 s98, s98, s99
    s_mov_b32 m0, 53248
    s_nop 0
    buffer_load_dwordx4 v0, s[24:27], s98 offen offset:0 sc1 lds
    buffer_load_dwordx4 v0, s[24:27], s98 offen offset:1024 sc1 lds
    buffer_load_dwordx4 v1, s[24:27], s98 offen offset:2048 sc1 lds
    buffer_load_dwordx4 v1, s[24:27], s98 offen offset:3072 sc1 lds
    s_mov_b32 m0, 57344
    s_nop 0
    buffer_load_dwordx4 v2, s[24:27], s98 offen offset:0 sc1 lds
    buffer_load_dwordx4 v2, s[24:27], s98 offen offset:1024 sc1 lds
    buffer_load_dwordx4 v3, s[24:27], s98 offen offset:2048 sc1 lds
    buffer_load_dwordx4 v3, s[24:27], s98 offen offset:3072 sc1 lds
    s_mov_b32 m0, 61440
    s_nop 0
    buffer_load_dwordx4 v4, s[24:27], s98 offen offset:0 sc1 lds
    buffer_load_dwordx4 v4, s[24:27], s98 offen offset:1024 sc1 lds
    buffer_load_dwordx4 v5, s[24:27], s98 offen offset:2048 sc1 lds
    buffer_load_dwordx4 v5, s[24:27], s98 offen offset:3072 sc1 lds
    s_waitcnt vmcnt(36)
    s_barrier
    s_add_u32 s98, s98, 2048
    s_mov_b32 m0, 20480
    s_nop 0
    buffer_load_dwordx4 v0, s[24:27], s98 offen offset:0 sc1 lds
    buffer_load_dwordx4 v0, s[24:27], s98 offen offset:1024 sc1 lds
    buffer_load_dwordx4 v1, s[24:27], s98 offen offset:2048 sc1 lds
    buffer_load_dwordx4 v1, s[24:27], s98 offen offset:3072 sc1 lds
    s_mov_b32 m0, 24576
    s_nop 0
    buffer_load_dwordx4 v2, s[24:27], s98 offen offset:0 sc1 lds
    buffer_load_dwordx4 v2, s[24:27], s98 offen offset:1024 sc1 lds
    buffer_load_dwordx4 v3, s[24:27], s98 offen offset:2048 sc1 lds
    buffer_load_dwordx4 v3, s[24:27], s98 offen offset:3072 sc1 lds
    s_mov_b32 m0, 28672
    s_nop 0
    buffer_load_dwordx4 v4, s[24:27], s98 offen offset:0 sc1 lds
    buffer_load_dwordx4 v4, s[24:27], s98 offen offset:1024 sc1 lds
    buffer_load_dwordx4 v5, s[24:27], s98 offen offset:2048 sc1 lds
    buffer_load_dwordx4 v5, s[24:27], s98 offen offset:3072 sc1 lds
    s_waitcnt vmcnt(36)
    s_barrier
    s_add_u32 s53, s95, 2
    s_and_b32 s53, s53, 3
    s_lshl_b32 s54, s94, 2
    s_add_u32 s53, s53, s54
    s_add_u32 s53, s53, 16
    s_lshl_b32 s98, s53, 12
    s_add_u32 s98, s98, s99
    s_mov_b32 m0, 86016
    s_nop 0
    buffer_load_dwordx4 v0, s[24:27], s98 offen offset:0 sc1 lds
    buffer_load_dwordx4 v0, s[24:27], s98 offen offset:1024 sc1 lds
    buffer_load_dwordx4 v1, s[24:27], s98 offen offset:2048 sc1 lds
    buffer_load_dwordx4 v1, s[24:27], s98 offen offset:3072 sc1 lds
    s_mov_b32 m0, 90112
    s_nop 0
    buffer_load_dwordx4 v2, s[24:27], s98 offen offset:0 sc1 lds
    buffer_load_dwordx4 v2, s[24:27], s98 offen offset:1024 sc1 lds
    buffer_load_dwordx4 v3, s[24:27], s98 offen offset:2048 sc1 lds
    buffer_load_dwordx4 v3, s[24:27], s98 offen offset:3072 sc1 lds
    s_mov_b32 m0, 94208
    s_nop 0
    buffer_load_dwordx4 v4, s[24:27], s98 offen offset:0 sc1 lds
    buffer_load_dwordx4 v4, s[24:27], s98 offen offset:1024 sc1 lds
    buffer_load_dwordx4 v5, s[24:27], s98 offen offset:2048 sc1 lds
    buffer_load_dwordx4 v5, s[24:27], s98 offen offset:3072 sc1 lds
    s_waitcnt vmcnt(36)
    s_barrier
    s_add_u32 s98, s98, 2048
    s_mov_b32 m0, 151552
    s_nop 0
    buffer_load_dwordx4 v0, s[24:27], s98 offen offset:0 sc1 lds
    buffer_load_dwordx4 v0, s[24:27], s98 offen offset:1024 sc1 lds
    buffer_load_dwordx4 v1, s[24:27], s98 offen offset:2048 sc1 lds
    buffer_load_dwordx4 v1, s[24:27], s98 offen offset:3072 sc1 lds
    s_mov_b32 m0, 155648
    s_nop 0
    buffer_load_dwordx4 v2, s[24:27], s98 offen offset:0 sc1 lds
    buffer_load_dwordx4 v2, s[24:27], s98 offen offset:1024 sc1 lds
    buffer_load_dwordx4 v3, s[24:27], s98 offen offset:2048 sc1 lds
    buffer_load_dwordx4 v3, s[24:27], s98 offen offset:3072 sc1 lds
    s_mov_b32 m0, 159744
    s_nop 0
    buffer_load_dwordx4 v4, s[24:27], s98 offen offset:0 sc1 lds
    buffer_load_dwordx4 v4, s[24:27], s98 offen offset:1024 sc1 lds
    buffer_load_dwordx4 v5, s[24:27], s98 offen offset:2048 sc1 lds
    buffer_load_dwordx4 v5, s[24:27], s98 offen offset:3072 sc1 lds
    s_waitcnt vmcnt(36)
    s_barrier
    s_add_u32 s53, s95, 3
    s_and_b32 s53, s53, 3
    s_lshl_b32 s54, s94, 2
    s_add_u32 s53, s53, s54
    s_add_u32 s53, s53, 16
    s_lshl_b32 s98, s53, 12
    s_add_u32 s98, s98, s99
    s_mov_b32 m0, 118784
    s_nop 0
    buffer_load_dwordx4 v0, s[24:27], s98 offen offset:0 sc1 lds
    buffer_load_dwordx4 v0, s[24:27], s98 offen offset:1024 sc1 lds
    buffer_load_dwordx4 v1, s[24:27], s98 offen offset:2048 sc1 lds
    buffer_load_dwordx4 v1, s[24:27], s98 offen offset:3072 sc1 lds
    s_mov_b32 m0, 122880
    s_nop 0
    buffer_load_dwordx4 v2, s[24:27], s98 offen offset:0 sc1 lds
    buffer_load_dwordx4 v2, s[24:27], s98 offen offset:1024 sc1 lds
    buffer_load_dwordx4 v3, s[24:27], s98 offen offset:2048 sc1 lds
    buffer_load_dwordx4 v3, s[24:27], s98 offen offset:3072 sc1 lds
    s_mov_b32 m0, 126976
    s_nop 0
    buffer_load_dwordx4 v4, s[24:27], s98 offen offset:0 sc1 lds
    buffer_load_dwordx4 v4, s[24:27], s98 offen offset:1024 sc1 lds
    buffer_load_dwordx4 v5, s[24:27], s98 offen offset:2048 sc1 lds
    buffer_load_dwordx4 v5, s[24:27], s98 offen offset:3072 sc1 lds
    s_waitcnt vmcnt(36)
    s_barrier
    s_add_u32 s98, s98, 2048
    s_mov_b32 m0, 53248
    s_nop 0
    buffer_load_dwordx4 v0, s[24:27], s98 offen offset:0 sc1 lds
    buffer_load_dwordx4 v0, s[24:27], s98 offen offset:1024 sc1 lds
    buffer_load_dwordx4 v1, s[24:27], s98 offen offset:2048 sc1 lds
    buffer_load_dwordx4 v1, s[24:27], s98 offen offset:3072 sc1 lds
    s_mov_b32 m0, 57344
    s_nop 0
    buffer_load_dwordx4 v2, s[24:27], s98 offen offset:0 sc1 lds
    buffer_load_dwordx4 v2, s[24:27], s98 offen offset:1024 sc1 lds
    buffer_load_dwordx4 v3, s[24:27], s98 offen offset:2048 sc1 lds
    buffer_load_dwordx4 v3, s[24:27], s98 offen offset:3072 sc1 lds
    s_mov_b32 m0, 61440
    s_nop 0
    buffer_load_dwordx4 v4, s[24:27], s98 offen offset:0 sc1 lds
    buffer_load_dwordx4 v4, s[24:27], s98 offen offset:1024 sc1 lds
    buffer_load_dwordx4 v5, s[24:27], s98 offen offset:2048 sc1 lds
    buffer_load_dwordx4 v5, s[24:27], s98 offen offset:3072 sc1 lds
    s_waitcnt vmcnt(36)
    s_barrier
    s_waitcnt vmcnt(24)
    s_barrier
    s_waitcnt vmcnt(12)
    s_barrier
    s_waitcnt vmcnt(0)
    s_barrier
    s_branch L_gpub
L_poll:
    s_mov_b32 s48, 1
    s_lshl_b32 s48, s48, s95
    s_xor_b32 s48, s48, 15
    s_waitcnt vmcnt(4) lgkmcnt(0)
    s_mov_b32 s47, 0x8000
L_sp_13:
    v_cmp_eq_u64 vcc, s[92:93], v[252:253]
    s_and_b32 s46, vcc_lo, s48
    s_cmp_eq_u32 s46, s48
    s_cbranch_scc1 L_ok_14
    s_sub_u32 s47, s47, 1
    s_cbranch_scc1 L_ok_14
    s_mov_b64 exec, 15
    buffer_load_dwordx2 v[252:253], v254, s[24:27], s100 offen sc1
    s_mov_b64 exec, -1
    s_waitcnt vmcnt(0)
    s_branch L_sp_13
L_ok_14:
    s_and_b32 s100, s2, 0x3f
    v_and_b32 v4, 3, v249
    v_lshlrev_b32 v4, 13, v4
    s_lshl_b32 s100, s100, 7
    s_add_u32 s100, s100, 33587200
    s_barrier
    s_barrier
    s_waitcnt vmcnt(0)
    s_barrier
    s_lshl_b32 s46, s2, 7
    s_add_u32 s46, s46, 33587200
    s_mov_b64 exec, 1
    v_mov_b32 v5, 0
    v_mov_b32 v6, s92
    v_mov_b32 v7, s93
    buffer_store_dwordx2 v[6:7], v5, s[24:27], s46 offen sc1
    s_mov_b64 exec, -1
    s_barrier
    s_barrier
    s_mov_b64 exec, 15
    buffer_load_dwordx2 v[8:9], v4, s[24:27], s100 offen sc1
    s_mov_b64 exec, -1
    s_barrier
    s_mov_b64 exec, 15
    buffer_load_dwordx2 v[10:11], v4, s[24:27], s100 offen sc1
    s_mov_b64 exec, -1
    s_add_u32 s48, s95, 1
    s_and_b32 s48, s48, 3
    s_lshl_b32 s48, 1, s48
    s_waitcnt vmcnt(1)
    s_mov_b32 s47, 0x8000
L_sp_15:
    v_cmp_eq_u64 vcc, s[92:93], v[8:9]
    s_and_b32 s46, vcc_lo, s48
    s_cmp_eq_u32 s46, s48
    s_cbranch_scc1 L_ok_16
    s_sub_u32 s47, s47, 1
    s_cbranch_scc1 L_ok_16
    s_mov_b64 exec, 15
    buffer_load_dwordx2 v[8:9], v4, s[24:27], s100 offen sc1
    s_mov_b64 exec, -1
    s_waitcnt vmcnt(0)
    s_branch L_sp_15
L_ok_16:
    s_barrier
    s_mov_b64 exec, 15
    buffer_load_dwordx2 v[8:9], v4, s[24:27], s100 offen sc1
    s_mov_b64 exec, -1
    s_barrier
    s_mov_b64 exec, 15
    buffer_load_dwordx2 v[10:11], v4, s[24:27], s100 offen sc1
    s_mov_b64 exec, -1
    s_add_u32 s48, s95, 2
    s_and_b32 s48, s48, 3
    s_lshl_b32 s48, 1, s48
    s_waitcnt vmcnt(1)
    s_mov_b32 s47, 0x8000
L_sp_17:
    v_cmp_eq_u64 vcc, s[92:93], v[8:9]
    s_and_b32 s46, vcc_lo, s48
    s_cmp_eq_u32 s46, s48
    s_cbranch_scc1 L_ok_18
    s_sub_u32 s47, s47, 1
    s_cbranch_scc1 L_ok_18
    s_mov_b64 exec, 15
    buffer_load_dwordx2 v[8:9], v4, s[24:27], s100 offen sc1
    s_mov_b64 exec, -1
    s_waitcnt vmcnt(0)
    s_branch L_sp_17
L_ok_18:
    s_barrier
    s_mov_b64 exec, 15
    buffer_load_dwordx2 v[8:9], v4, s[24:27], s100 offen sc1
    s_mov_b64 exec, -1
    s_barrier
    s_mov_b64 exec, 15
    buffer_load_dwordx2 v[10:11], v4, s[24:27], s100 offen sc1
    s_mov_b64 exec, -1
    s_add_u32 s48, s95, 3
    s_and_b32 s48, s48, 3
    s_lshl_b32 s48, 1, s48
    s_waitcnt vmcnt(1)
    s_mov_b32 s47, 0x8000
L_sp_19:
    v_cmp_eq_u64 vcc, s[92:93], v[8:9]
    s_and_b32 s46, vcc_lo, s48
    s_cmp_eq_u32 s46, s48
    s_cbranch_scc1 L_ok_20
    s_sub_u32 s47, s47, 1
    s_cbranch_scc1 L_ok_20
    s_mov_b64 exec, 15
    buffer_load_dwordx2 v[8:9], v4, s[24:27], s100 offen sc1
    s_mov_b64 exec, -1
    s_waitcnt vmcnt(0)
    s_branch L_sp_19
L_ok_20:
    s_barrier
    s_barrier
    s_barrier
    s_barrier
    s_barrier
    s_barrier
    s_waitcnt vmcnt(0)
    s_and_b32 s100, s2, 0xfc
    v_and_b32 v4, 3, v249
    v_lshlrev_b32 v4, 7, v4
    s_lshl_b32 s100, s100, 7
    s_add_u32 s100, s100, 33619968
    s_branch L_gpub
L_gcons:
    v_bfe_u32 v252, v249, 2, 2
    v_lshl_add_u32 v252, v250, 2, v252
    v_mul_u32_u24 v252, 320, v252
    v_and_b32 v253, 3, v249
    v_lshl_add_u32 v252, v253, 3, v252
    v_and_b32 v253, 1, v250
    s_and_b32 s53, s3, 1
    s_mul_i32 s53, s53, 5
    s_add_u32 s54, s53, 1
    v_xor_b32 v254, s53, v253
    v_lshl_add_u32 v192, v254, 5, v252
    v_xor_b32 v254, s54, v253
    v_lshl_add_u32 v193, v254, 5, v252
    v_subrev_u32 v193, 32, v193
    s_lshr_b32 s53, s3, 1
    s_mul_i32 s53, s53, 6144
    s_add_u32 s53, s53, 20480
    v_lshlrev_b32 v252, 4, v249
    v_add_u32 v198, s53, v252
    v_add_u32 v194, 65536, v192
    v_add_u32 v195, 65536, v193
    v_add_u32 v199, 65536, v198
    v_add_u32 v196, 131072, v192
    v_add_u32 v197, 131072, v193
    v_add_u32 v200, 131072, v198
    s_waitcnt lgkmcnt(0)
    s_barrier
    ds_read_b128 v[104:107], v198 offset:32768
    ds_read_b128 v[108:111], v198 offset:34816
    ds_read_b128 v[112:115], v198 offset:36864
    ds_read_b64_tr_b16 v[64:65], v192 offset:32768
    ds_read_b64_tr_b16 v[66:67], v192 offset:37888
    ds_read_b64_tr_b16 v[68:69], v193 offset:32800
    ds_read_b64_tr_b16 v[70:71], v193 offset:37920
    ds_read_b64_tr_b16 v[72:73], v192 offset:32832
    ds_read_b64_tr_b16 v[74:75], v192 offset:37952
    ds_read_b64_tr_b16 v[76:77], v193 offset:32864
    ds_read_b64_tr_b16 v[78:79], v193 offset:37984
    ds_read_b64_tr_b16 v[80:81], v192 offset:32896
    ds_read_b64_tr_b16 v[82:83], v192 offset:38016
    ds_read_b128 v[116:119], v198 offset:33792
    ds_read_b128 v[120:123], v198 offset:35840
    ds_read_b128 v[124:127], v198 offset:37888
    ds_read_b64_tr_b16 v[84:85], v192 offset:43008
    ds_read_b64_tr_b16 v[86:87], v192 offset:48128
    ds_read_b64_tr_b16 v[88:89], v193 offset:43040
    ds_read_b64_tr_b16 v[90:91], v193 offset:48160
    ds_read_b64_tr_b16 v[92:93], v192 offset:43072
    ds_read_b64_tr_b16 v[94:95], v192 offset:48192
    ds_read_b64_tr_b16 v[96:97], v193 offset:43104
    ds_read_b64_tr_b16 v[98:99], v193 offset:48224
    ds_read_b64_tr_b16 v[100:101], v192 offset:43136
    ds_read_b64_tr_b16 v[102:103], v192 offset:48256
    s_waitcnt lgkmcnt(0)
    s_barrier
    v_mfma_f32_16x16x32_bf16 v[0:3], v[64:67], v[104:107], 0
    ds_read_b128 v[168:171], v198 offset:0
    v_mfma_f32_16x16x32_bf16 v[20:23], v[64:67], v[108:111], 0
    ds_read_b128 v[172:175], v198 offset:2048
    v_mfma_f32_16x16x32_bf16 v[40:43], v[64:67], v[112:115], 0
    ds_read_b128 v[176:179], v198 offset:4096
    v_mfma_f32_16x16x32_bf16 v[4:7], v[68:71], v[104:107], 0
    ds_read_b64_tr_b16 v[128:129], v192 offset:0
    v_mfma_f32_16x16x32_bf16 v[24:27], v[68:71], v[108:111], 0
    ds_read_b64_tr_b16 v[130:131], v192 offset:5120
    v_mfma_f32_16x16x32_bf16 v[44:47], v[68:71], v[112:115], 0
    ds_read_b64_tr_b16 v[132:133], v193 offset:32
    v_mfma_f32_16x16x32_bf16 v[8:11], v[72:75], v[104:107], 0
    ds_read_b64_tr_b16 v[134:135], v193 offset:5152
    v_mfma_f32_16x16x32_bf16 v[28:31], v[72:75], v[108:111], 0
    ds_read_b64_tr_b16 v[136:137], v192 offset:64
    v_mfma_f32_16x16x32_bf16 v[48:51], v[72:75], v[112:115], 0
    ds_read_b64_tr_b16 v[138:139], v192 offset:5184
    v_mfma_f32_16x16x32_bf16 v[12:15], v[76:79], v[104:107], 0
    ds_read_b64_tr_b16 v[140:141], v193 offset:96
    v_mfma_f32_16x16x32_bf16 v[32:35], v[76:79], v[108:111], 0
    ds_read_b64_tr_b16 v[142:143], v193 offset:5216
    v_mfma_f32_16x16x32_bf16 v[52:55], v[76:79], v[112:115], 0
    ds_read_b64_tr_b16 v[144:145], v192 offset:128
    v_mfma_f32_16x16x32_bf16 v[16:19], v[80:83], v[104:107], 0
    ds_read_b64_tr_b16 v[146:147], v192 offset:5248
    v_mfma_f32_16x16x32_bf16 v[36:39], v[80:83], v[108:111], 0
    ds_read_b128 v[180:183], v198 offset:1024
    v_mfma_f32_16x16x32_bf16 v[56:59], v[80:83], v[112:115], 0
    ds_read_b128 v[184:187], v198 offset:3072
    v_mfma_f32_16x16x32_bf16 v[0:3], v[84:87], v[116:119], v[0:3]
    ds_read_b128 v[188:191], v198 offset:5120
    v_mfma_f32_16x16x32_bf16 v[20:23], v[84:87], v[120:123], v[20:23]
    ds_read_b64_tr_b16 v[148:149], v192 offset:10240
    v_mfma_f32_16x16x32_bf16 v[40:43], v[84:87], v[124:127], v[40:43]
    ds_read_b64_tr_b16 v[150:151], v192 offset:15360
    v_mfma_f32_16x16x32_bf16 v[4:7], v[88:91], v[116:119], v[4:7]
    ds_read_b64_tr_b16 v[152:153], v193 offset:10272
    v_mfma_f32_16x16x32_bf16 v[24:27], v[88:91], v[120:123], v[24:27]
    ds_read_b64_tr_b16 v[154:155], v193 offset:15392
    v_mfma_f32_16x16x32_bf16 v[44:47], v[88:91], v[124:127], v[44:47]
    ds_read_b64_tr_b16 v[156:157], v192 offset:10304
    v_mfma_f32_16x16x32_bf16 v[8:11], v[92:95], v[116:119], v[8:11]
    ds_read_b64_tr_b16 v[158:159], v192 offset:15424
    v_mfma_f32_16x16x32_bf16 v[28:31], v[92:95], v[120:123], v[28:31]
    ds_read_b64_tr_b16 v[160:161], v193 offset:10336
    v_mfma_f32_16x16x32_bf16 v[48:51], v[92:95], v[124:127], v[48:51]
    ds_read_b64_tr_b16 v[162:163], v193 offset:15456
    v_mfma_f32_16x16x32_bf16 v[12:15], v[96:99], v[116:119], v[12:15]
    ds_read_b64_tr_b16 v[164:165], v192 offset:10368
    v_mfma_f32_16x16x32_bf16 v[32:35], v[96:99], v[120:123], v[32:35]
    ds_read_b64_tr_b16 v[166:167], v192 offset:15488
    v_mfma_f32_16x16x32_bf16 v[52:55], v[96:99], v[124:127], v[52:55]
    v_mfma_f32_16x16x32_bf16 v[16:19], v[100:103], v[116:119], v[16:19]
    v_mfma_f32_16x16x32_bf16 v[36:39], v[100:103], v[120:123], v[36:39]
    v_mfma_f32_16x16x32_bf16 v[56:59], v[100:103], v[124:127], v[56:59]
    s_waitcnt vmcnt(0) lgkmcnt(0)
    s_barrier
    v_mfma_f32_16x16x32_bf16 v[0:3], v[128:131], v[168:171], v[0:3]
    ds_read_b128 v[104:107], v199 offset:0
    v_mfma_f32_16x16x32_bf16 v[20:23], v[128:131], v[172:175], v[20:23]
    ds_read_b128 v[108:111], v199 offset:2048
    v_mfma_f32_16x16x32_bf16 v[40:43], v[128:131], v[176:179], v[40:43]
    ds_read_b128 v[112:115], v199 offset:4096
    v_mfma_f32_16x16x32_bf16 v[4:7], v[132:135], v[168:171], v[4:7]
    ds_read_b64_tr_b16 v[64:65], v194 offset:0
    v_mfma_f32_16x16x32_bf16 v[24:27], v[132:135], v[172:175], v[24:27]
    ds_read_b64_tr_b16 v[66:67], v194 offset:5120
    v_mfma_f32_16x16x32_bf16 v[44:47], v[132:135], v[176:179], v[44:47]
    ds_read_b64_tr_b16 v[68:69], v195 offset:32
    v_mfma_f32_16x16x32_bf16 v[8:11], v[136:139], v[168:171], v[8:11]
    ds_read_b64_tr_b16 v[70:71], v195 offset:5152
    v_mfma_f32_16x16x32_bf16 v[28:31], v[136:139], v[172:175], v[28:31]
    ds_read_b64_tr_b16 v[72:73], v194 offset:64
    v_mfma_f32_16x16x32_bf16 v[48:51], v[136:139], v[176:179], v[48:51]
    ds_read_b64_tr_b16 v[74:75], v194 offset:5184
    v_mfma_f32_16x16x32_bf16 v[12:15], v[140:143], v[168:171], v[12:15]
    ds_read_b64_tr_b16 v[76:77], v195 offset:96
    v_mfma_f32_16x16x32_bf16 v[32:35], v[140:143], v[172:175], v[32:35]
    ds_read_b64_tr_b16 v[78:79], v195 offset:5216
    v_mfma_f32_16x16x32_bf16 v[52:55], v[140:143], v[176:179], v[52:55]
    ds_read_b64_tr_b16 v[80:81], v194 offset:128
    v_mfma_f32_16x16x32_bf16 v[16:19], v[144:147], v[168:171], v[16:19]
    ds_read_b64_tr_b16 v[82:83], v194 offset:5248
    v_mfma_f32_16x16x32_bf16 v[36:39], v[144:147], v[172:175], v[36:39]
    ds_read_b128 v[116:119], v199 offset:1024
    v_mfma_f32_16x16x32_bf16 v[56:59], v[144:147], v[176:179], v[56:59]
    ds_read_b128 v[120:123], v199 offset:3072
    v_mfma_f32_16x16x32_bf16 v[0:3], v[148:151], v[180:183], v[0:3]
    ds_read_b128 v[124:127], v199 offset:5120
    v_mfma_f32_16x16x32_bf16 v[20:23], v[148:151], v[184:187], v[20:23]
    ds_read_b64_tr_b16 v[84:85], v194 offset:10240
    v_mfma_f32_16x16x32_bf16 v[40:43], v[148:151], v[188:191], v[40:43]
    ds_read_b64_tr_b16 v[86:87], v194 offset:15360
    v_mfma_f32_16x16x32_bf16 v[4:7], v[152:155], v[180:183], v[4:7]
    ds_read_b64_tr_b16 v[88:89], v195 offset:10272
    v_mfma_f32_16x16x32_bf16 v[24:27], v[152:155], v[184:187], v[24:27]
    ds_read_b64_tr_b16 v[90:91], v195 offset:15392
    v_mfma_f32_16x16x32_bf16 v[44:47], v[152:155], v[188:191], v[44:47]
    ds_read_b64_tr_b16 v[92:93], v194 offset:10304
    v_mfma_f32_16x16x32_bf16 v[8:11], v[156:159], v[180:183], v[8:11]
    ds_read_b64_tr_b16 v[94:95], v194 offset:15424
    v_mfma_f32_16x16x32_bf16 v[28:31], v[156:159], v[184:187], v[28:31]
    ds_read_b64_tr_b16 v[96:97], v195 offset:10336
    v_mfma_f32_16x16x32_bf16 v[48:51], v[156:159], v[188:191], v[48:51]
    ds_read_b64_tr_b16 v[98:99], v195 offset:15456
    v_mfma_f32_16x16x32_bf16 v[12:15], v[160:163], v[180:183], v[12:15]
    ds_read_b64_tr_b16 v[100:101], v194 offset:10368
    v_mfma_f32_16x16x32_bf16 v[32:35], v[160:163], v[184:187], v[32:35]
    ds_read_b64_tr_b16 v[102:103], v194 offset:15488
    v_mfma_f32_16x16x32_bf16 v[52:55], v[160:163], v[188:191], v[52:55]
    v_mfma_f32_16x16x32_bf16 v[16:19], v[164:167], v[180:183], v[16:19]
    v_mfma_f32_16x16x32_bf16 v[36:39], v[164:167], v[184:187], v[36:39]
    v_mfma_f32_16x16x32_bf16 v[56:59], v[164:167], v[188:191], v[56:59]
    s_waitcnt lgkmcnt(0)
    s_barrier
    v_mfma_f32_16x16x32_bf16 v[0:3], v[64:67], v[104:107], v[0:3]
    ds_read_b128 v[168:171], v200 offset:0
    v_mfma_f32_16x16x32_bf16 v[20:23], v[64:67], v[108:111], v[20:23]
    ds_read_b128 v[172:175], v200 offset:2048
    v_mfma_f32_16x16x32_bf16 v[40:43], v[64:67], v[112:115], v[40:43]
    ds_read_b128 v[176:179], v200 offset:4096
    v_mfma_f32_16x16x32_bf16 v[4:7], v[68:71], v[104:107], v[4:7]
    ds_read_b64_tr_b16 v[128:129], v196 offset:0
    v_mfma_f32_16x16x32_bf16 v[24:27], v[68:71], v[108:111], v[24:27]
    ds_read_b64_tr_b16 v[130:131], v196 offset:5120
    v_mfma_f32_16x16x32_bf16 v[44:47], v[68:71], v[112:115], v[44:47]
    ds_read_b64_tr_b16 v[132:133], v197 offset:32
    v_mfma_f32_16x16x32_bf16 v[8:11], v[72:75], v[104:107], v[8:11]
    ds_read_b64_tr_b16 v[134:135], v197 offset:5152
    v_mfma_f32_16x16x32_bf16 v[28:31], v[72:75], v[108:111], v[28:31]
    ds_read_b64_tr_b16 v[136:137], v196 offset:64
    v_mfma_f32_16x16x32_bf16 v[48:51], v[72:75], v[112:115], v[48:51]
    ds_read_b64_tr_b16 v[138:139], v196 offset:5184
    v_mfma_f32_16x16x32_bf16 v[12:15], v[76:79], v[104:107], v[12:15]
    ds_read_b64_tr_b16 v[140:141], v197 offset:96
    v_mfma_f32_16x16x32_bf16 v[32:35], v[76:79], v[108:111], v[32:35]
    ds_read_b64_tr_b16 v[142:143], v197 offset:5216
    v_mfma_f32_16x16x32_bf16 v[52:55], v[76:79], v[112:115], v[52:55]
    ds_read_b64_tr_b16 v[144:145], v196 offset:128
    v_mfma_f32_16x16x32_bf16 v[16:19], v[80:83], v[104:107], v[16:19]
    ds_read_b64_tr_b16 v[146:147], v196 offset:5248
    v_mfma_f32_16x16x32_bf16 v[36:39], v[80:83], v[108:111], v[36:39]
    ds_read_b128 v[180:183], v200 offset:1024
    v_mfma_f32_16x16x32_bf16 v[56:59], v[80:83], v[112:115], v[56:59]
    ds_read_b128 v[184:187], v200 offset:3072
    v_mfma_f32_16x16x32_bf16 v[0:3], v[84:87], v[116:119], v[0:3]
    ds_read_b128 v[188:191], v200 offset:5120
    v_mfma_f32_16x16x32_bf16 v[20:23], v[84:87], v[120:123], v[20:23]
    ds_read_b64_tr_b16 v[148:149], v196 offset:10240
    v_mfma_f32_16x16x32_bf16 v[40:43], v[84:87], v[124:127], v[40:43]
    ds_read_b64_tr_b16 v[150:151], v196 offset:15360
    v_mfma_f32_16x16x32_bf16 v[4:7], v[88:91], v[116:119], v[4:7]
    ds_read_b64_tr_b16 v[152:153], v197 offset:10272
    v_mfma_f32_16x16x32_bf16 v[24:27], v[88:91], v[120:123], v[24:27]
    ds_read_b64_tr_b16 v[154:155], v197 offset:15392
    v_mfma_f32_16x16x32_bf16 v[44:47], v[88:91], v[124:127], v[44:47]
    ds_read_b64_tr_b16 v[156:157], v196 offset:10304
    v_mfma_f32_16x16x32_bf16 v[8:11], v[92:95], v[116:119], v[8:11]
    ds_read_b64_tr_b16 v[158:159], v196 offset:15424
    v_mfma_f32_16x16x32_bf16 v[28:31], v[92:95], v[120:123], v[28:31]
    ds_read_b64_tr_b16 v[160:161], v197 offset:10336
    v_mfma_f32_16x16x32_bf16 v[48:51], v[92:95], v[124:127], v[48:51]
    ds_read_b64_tr_b16 v[162:163], v197 offset:15456
    v_mfma_f32_16x16x32_bf16 v[12:15], v[96:99], v[116:119], v[12:15]
    ds_read_b64_tr_b16 v[164:165], v196 offset:10368
    v_mfma_f32_16x16x32_bf16 v[32:35], v[96:99], v[120:123], v[32:35]
    ds_read_b64_tr_b16 v[166:167], v196 offset:15488
    v_mfma_f32_16x16x32_bf16 v[52:55], v[96:99], v[124:127], v[52:55]
    v_mfma_f32_16x16x32_bf16 v[16:19], v[100:103], v[116:119], v[16:19]
    v_mfma_f32_16x16x32_bf16 v[36:39], v[100:103], v[120:123], v[36:39]
    v_mfma_f32_16x16x32_bf16 v[56:59], v[100:103], v[124:127], v[56:59]
    s_waitcnt lgkmcnt(0)
    s_barrier
    v_mfma_f32_16x16x32_bf16 v[0:3], v[128:131], v[168:171], v[0:3]
    ds_read_b128 v[104:107], v199 offset:32768
    v_mfma_f32_16x16x32_bf16 v[20:23], v[128:131], v[172:175], v[20:23]
    ds_read_b128 v[108:111], v199 offset:34816
    v_mfma_f32_16x16x32_bf16 v[40:43], v[128:131], v[176:179], v[40:43]
    ds_read_b128 v[112:115], v199 offset:36864
    v_mfma_f32_16x16x32_bf16 v[4:7], v[132:135], v[168:171], v[4:7]
    ds_read_b64_tr_b16 v[64:65], v194 offset:32768
    v_mfma_f32_16x16x32_bf16 v[24:27], v[132:135], v[172:175], v[24:27]
    ds_read_b64_tr_b16 v[66:67], v194 offset:37888
    v_mfma_f32_16x16x32_bf16 v[44:47], v[132:135], v[176:179], v[44:47]
    ds_read_b64_tr_b16 v[68:69], v195 offset:32800
    v_mfma_f32_16x16x32_bf16 v[8:11], v[136:139], v[168:171], v[8:11]
    ds_read_b64_tr_b16 v[70:71], v195 offset:37920
    v_mfma_f32_16x16x32_bf16 v[28:31], v[136:139], v[172:175], v[28:31]
    ds_read_b64_tr_b16 v[72:73], v194 offset:32832
    v_mfma_f32_16x16x32_bf16 v[48:51], v[136:139], v[176:179], v[48:51]
    ds_read_b64_tr_b16 v[74:75], v194 offset:37952
    v_mfma_f32_16x16x32_bf16 v[12:15], v[140:143], v[168:171], v[12:15]
    ds_read_b64_tr_b16 v[76:77], v195 offset:32864
    v_mfma_f32_16x16x32_bf16 v[32:35], v[140:143], v[172:175], v[32:35]
    ds_read_b64_tr_b16 v[78:79], v195 offset:37984
    v_mfma_f32_16x16x32_bf16 v[52:55], v[140:143], v[176:179], v[52:55]
    ds_read_b64_tr_b16 v[80:81], v194 offset:32896
    v_mfma_f32_16x16x32_bf16 v[16:19], v[144:147], v[168:171], v[16:19]
    ds_read_b64_tr_b16 v[82:83], v194 offset:38016
    v_mfma_f32_16x16x32_bf16 v[36:39], v[144:147], v[172:175], v[36:39]
    ds_read_b128 v[116:119], v199 offset:33792
    v_mfma_f32_16x16x32_bf16 v[56:59], v[144:147], v[176:179], v[56:59]
    ds_read_b128 v[120:123], v199 offset:35840
    v_mfma_f32_16x16x32_bf16 v[0:3], v[148:151], v[180:183], v[0:3]
    ds_read_b128 v[124:127], v199 offset:37888
    v_mfma_f32_16x16x32_bf16 v[20:23], v[148:151], v[184:187], v[20:23]
    ds_read_b64_tr_b16 v[84:85], v194 offset:43008
    v_mfma_f32_16x16x32_bf16 v[40:43], v[148:151], v[188:191], v[40:43]
    ds_read_b64_tr_b16 v[86:87], v194 offset:48128
    v_mfma_f32_16x16x32_bf16 v[4:7], v[152:155], v[180:183], v[4:7]
    ds_read_b64_tr_b16 v[88:89], v195 offset:43040
    v_mfma_f32_16x16x32_bf16 v[24:27], v[152:155], v[184:187], v[24:27]
    ds_read_b64_tr_b16 v[90:91], v195 offset:48160
    v_mfma_f32_16x16x32_bf16 v[44:47], v[152:155], v[188:191], v[44:47]
    ds_read_b64_tr_b16 v[92:93], v194 offset:43072
    v_mfma_f32_16x16x32_bf16 v[8:11], v[156:159], v[180:183], v[8:11]
    ds_read_b64_tr_b16 v[94:95], v194 offset:48192
    v_mfma_f32_16x16x32_bf16 v[28:31], v[156:159], v[184:187], v[28:31]
    ds_read_b64_tr_b16 v[96:97], v195 offset:43104
    v_mfma_f32_16x16x32_bf16 v[48:51], v[156:159], v[188:191], v[48:51]
    ds_read_b64_tr_b16 v[98:99], v195 offset:48224
    v_mfma_f32_16x16x32_bf16 v[12:15], v[160:163], v[180:183], v[12:15]
    ds_read_b64_tr_b16 v[100:101], v194 offset:43136
    v_mfma_f32_16x16x32_bf16 v[32:35], v[160:163], v[184:187], v[32:35]
    ds_read_b64_tr_b16 v[102:103], v194 offset:48256
    v_mfma_f32_16x16x32_bf16 v[52:55], v[160:163], v[188:191], v[52:55]
    v_mfma_f32_16x16x32_bf16 v[16:19], v[164:167], v[180:183], v[16:19]
    v_mfma_f32_16x16x32_bf16 v[36:39], v[164:167], v[184:187], v[36:39]
    v_mfma_f32_16x16x32_bf16 v[56:59], v[164:167], v[188:191], v[56:59]
    s_waitcnt lgkmcnt(0)
    s_barrier
    v_mfma_f32_16x16x32_bf16 v[0:3], v[64:67], v[104:107], v[0:3]
    ds_read_b128 v[168:171], v198 offset:32768
    v_mfma_f32_16x16x32_bf16 v[20:23], v[64:67], v[108:111], v[20:23]
    ds_read_b128 v[172:175], v198 offset:34816
    v_mfma_f32_16x16x32_bf16 v[40:43], v[64:67], v[112:115], v[40:43]
    ds_read_b128 v[176:179], v198 offset:36864
    v_mfma_f32_16x16x32_bf16 v[4:7], v[68:71], v[104:107], v[4:7]
    ds_read_b64_tr_b16 v[128:129], v192 offset:32768
    v_mfma_f32_16x16x32_bf16 v[24:27], v[68:71], v[108:111], v[24:27]
    ds_read_b64_tr_b16 v[130:131], v192 offset:37888
    v_mfma_f32_16x16x32_bf16 v[44:47], v[68:71], v[112:115], v[44:47]
    ds_read_b64_tr_b16 v[132:133], v193 offset:32800
    v_mfma_f32_16x16x32_bf16 v[8:11], v[72:75], v[104:107], v[8:11]
    ds_read_b64_tr_b16 v[134:135], v193 offset:37920
    v_mfma_f32_16x16x32_bf16 v[28:31], v[72:75], v[108:111], v[28:31]
    ds_read_b64_tr_b16 v[136:137], v192 offset:32832
    v_mfma_f32_16x16x32_bf16 v[48:51], v[72:75], v[112:115], v[48:51]
    ds_read_b64_tr_b16 v[138:139], v192 offset:37952
    v_mfma_f32_16x16x32_bf16 v[12:15], v[76:79], v[104:107], v[12:15]
    ds_read_b64_tr_b16 v[140:141], v193 offset:32864
    v_mfma_f32_16x16x32_bf16 v[32:35], v[76:79], v[108:111], v[32:35]
    ds_read_b64_tr_b16 v[142:143], v193 offset:37984
    v_mfma_f32_16x16x32_bf16 v[52:55], v[76:79], v[112:115], v[52:55]
    ds_read_b64_tr_b16 v[144:145], v192 offset:32896
    v_mfma_f32_16x16x32_bf16 v[16:19], v[80:83], v[104:107], v[16:19]
    ds_read_b64_tr_b16 v[146:147], v192 offset:38016
    v_mfma_f32_16x16x32_bf16 v[36:39], v[80:83], v[108:111], v[36:39]
    ds_read_b128 v[180:183], v198 offset:33792
    v_mfma_f32_16x16x32_bf16 v[56:59], v[80:83], v[112:115], v[56:59]
    ds_read_b128 v[184:187], v198 offset:35840
    v_mfma_f32_16x16x32_bf16 v[0:3], v[84:87], v[116:119], v[0:3]
    ds_read_b128 v[188:191], v198 offset:37888
    v_mfma_f32_16x16x32_bf16 v[20:23], v[84:87], v[120:123], v[20:23]
    ds_read_b64_tr_b16 v[148:149], v192 offset:43008
    v_mfma_f32_16x16x32_bf16 v[40:43], v[84:87], v[124:127], v[40:43]
    ds_read_b64_tr_b16 v[150:151], v192 offset:48128
    v_mfma_f32_16x16x32_bf16 v[4:7], v[88:91], v[116:119], v[4:7]
    ds_read_b64_tr_b16 v[152:153], v193 offset:43040
    v_mfma_f32_16x16x32_bf16 v[24:27], v[88:91], v[120:123], v[24:27]
    ds_read_b64_tr_b16 v[154:155], v193 offset:48160
    v_mfma_f32_16x16x32_bf16 v[44:47], v[88:91], v[124:127], v[44:47]
    ds_read_b64_tr_b16 v[156:157], v192 offset:43072
    v_mfma_f32_16x16x32_bf16 v[8:11], v[92:95], v[116:119], v[8:11]
    ds_read_b64_tr_b16 v[158:159], v192 offset:48192
    v_mfma_f32_16x16x32_bf16 v[28:31], v[92:95], v[120:123], v[28:31]
    ds_read_b64_tr_b16 v[160:161], v193 offset:43104
    v_mfma_f32_16x16x32_bf16 v[48:51], v[92:95], v[124:127], v[48:51]
    ds_read_b64_tr_b16 v[162:163], v193 offset:48224
    v_mfma_f32_16x16x32_bf16 v[12:15], v[96:99], v[116:119], v[12:15]
    ds_read_b64_tr_b16 v[164:165], v192 offset:43136
    v_mfma_f32_16x16x32_bf16 v[32:35], v[96:99], v[120:123], v[32:35]
    ds_read_b64_tr_b16 v[166:167], v192 offset:48256
    v_mfma_f32_16x16x32_bf16 v[52:55], v[96:99], v[124:127], v[52:55]
    v_mfma_f32_16x16x32_bf16 v[16:19], v[100:103], v[116:119], v[16:19]
    v_mfma_f32_16x16x32_bf16 v[36:39], v[100:103], v[120:123], v[36:39]
    v_mfma_f32_16x16x32_bf16 v[56:59], v[100:103], v[124:127], v[56:59]
    s_waitcnt lgkmcnt(0)
    s_barrier
    v_mfma_f32_16x16x32_bf16 v[0:3], v[128:131], v[168:171], v[0:3]
    ds_read_b128 v[104:107], v198 offset:0
    v_mfma_f32_16x16x32_bf16 v[20:23], v[128:131], v[172:175], v[20:23]
    ds_read_b128 v[108:111], v198 offset:2048
    v_mfma_f32_16x16x32_bf16 v[40:43], v[128:131], v[176:179], v[40:43]
    ds_read_b128 v[112:115], v198 offset:4096
    v_mfma_f32_16x16x32_bf16 v[4:7], v[132:135], v[168:171], v[4:7]
    ds_read_b64_tr_b16 v[64:65], v192 offset:0
    v_mfma_f32_16x16x32_bf16 v[24:27], v[132:135], v[172:175], v[24:27]
    ds_read_b64_tr_b16 v[66:67], v192 offset:5120
    v_mfma_f32_16x16x32_bf16 v[44:47], v[132:135], v[176:179], v[44:47]
    ds_read_b64_tr_b16 v[68:69], v193 offset:32
    v_mfma_f32_16x16x32_bf16 v[8:11], v[136:139], v[168:171], v[8:11]
    ds_read_b64_tr_b16 v[70:71], v193 offset:5152
    v_mfma_f32_16x16x32_bf16 v[28:31], v[136:139], v[172:175], v[28:31]
    ds_read_b64_tr_b16 v[72:73], v192 offset:64
    v_mfma_f32_16x16x32_bf16 v[48:51], v[136:139], v[176:179], v[48:51]
    ds_read_b64_tr_b16 v[74:75], v192 offset:5184
    v_mfma_f32_16x16x32_bf16 v[12:15], v[140:143], v[168:171], v[12:15]
    ds_read_b64_tr_b16 v[76:77], v193 offset:96
    v_mfma_f32_16x16x32_bf16 v[32:35], v[140:143], v[172:175], v[32:35]
    ds_read_b64_tr_b16 v[78:79], v193 offset:5216
    v_mfma_f32_16x16x32_bf16 v[52:55], v[140:143], v[176:179], v[52:55]
    ds_read_b64_tr_b16 v[80:81], v192 offset:128
    v_mfma_f32_16x16x32_bf16 v[16:19], v[144:147], v[168:171], v[16:19]
    ds_read_b64_tr_b16 v[82:83], v192 offset:5248
    v_mfma_f32_16x16x32_bf16 v[36:39], v[144:147], v[172:175], v[36:39]
    ds_read_b128 v[116:119], v198 offset:1024
    v_mfma_f32_16x16x32_bf16 v[56:59], v[144:147], v[176:179], v[56:59]
    ds_read_b128 v[120:123], v198 offset:3072
    v_mfma_f32_16x16x32_bf16 v[0:3], v[148:151], v[180:183], v[0:3]
    ds_read_b128 v[124:127], v198 offset:5120
    v_mfma_f32_16x16x32_bf16 v[20:23], v[148:151], v[184:187], v[20:23]
    ds_read_b64_tr_b16 v[84:85], v192 offset:10240
    v_mfma_f32_16x16x32_bf16 v[40:43], v[148:151], v[188:191], v[40:43]
    ds_read_b64_tr_b16 v[86:87], v192 offset:15360
    v_mfma_f32_16x16x32_bf16 v[4:7], v[152:155], v[180:183], v[4:7]
    ds_read_b64_tr_b16 v[88:89], v193 offset:10272
    v_mfma_f32_16x16x32_bf16 v[24:27], v[152:155], v[184:187], v[24:27]
    ds_read_b64_tr_b16 v[90:91], v193 offset:15392
    v_mfma_f32_16x16x32_bf16 v[44:47], v[152:155], v[188:191], v[44:47]
    ds_read_b64_tr_b16 v[92:93], v192 offset:10304
    v_mfma_f32_16x16x32_bf16 v[8:11], v[156:159], v[180:183], v[8:11]
    ds_read_b64_tr_b16 v[94:95], v192 offset:15424
    v_mfma_f32_16x16x32_bf16 v[28:31], v[156:159], v[184:187], v[28:31]
    ds_read_b64_tr_b16 v[96:97], v193 offset:10336
    v_mfma_f32_16x16x32_bf16 v[48:51], v[156:159], v[188:191], v[48:51]
    ds_read_b64_tr_b16 v[98:99], v193 offset:15456
    v_mfma_f32_16x16x32_bf16 v[12:15], v[160:163], v[180:183], v[12:15]
    ds_read_b64_tr_b16 v[100:101], v192 offset:10368
    v_mfma_f32_16x16x32_bf16 v[32:35], v[160:163], v[184:187], v[32:35]
    ds_read_b64_tr_b16 v[102:103], v192 offset:15488
    v_mfma_f32_16x16x32_bf16 v[52:55], v[160:163], v[188:191], v[52:55]
    v_mfma_f32_16x16x32_bf16 v[16:19], v[164:167], v[180:183], v[16:19]
    v_mfma_f32_16x16x32_bf16 v[36:39], v[164:167], v[184:187], v[36:39]
    v_mfma_f32_16x16x32_bf16 v[56:59], v[164:167], v[188:191], v[56:59]
    s_waitcnt lgkmcnt(0)
    s_barrier
    v_mfma_f32_16x16x32_bf16 v[0:3], v[64:67], v[104:107], v[0:3]
    ds_read_b128 v[168:171], v199 offset:0
    v_mfma_f32_16x16x32_bf16 v[20:23], v[64:67], v[108:111], v[20:23]
    ds_read_b128 v[172:175], v199 offset:2048
    v_mfma_f32_16x16x32_bf16 v[40:43], v[64:67], v[112:115], v[40:43]
    ds_read_b128 v[176:179], v199 offset:4096
    v_mfma_f32_16x16x32_bf16 v[4:7], v[68:71], v[104:107], v[4:7]
    ds_read_b64_tr_b16 v[128:129], v194 offset:0
    v_mfma_f32_16x16x32_bf16 v[24:27], v[68:71], v[108:111], v[24:27]
    ds_read_b64_tr_b16 v[130:131], v194 offset:5120
    v_mfma_f32_16x16x32_bf16 v[44:47], v[68:71], v[112:115], v[44:47]
    ds_read_b64_tr_b16 v[132:133], v195 offset:32
    v_mfma_f32_16x16x32_bf16 v[8:11], v[72:75], v[104:107], v[8:11]
    ds_read_b64_tr_b16 v[134:135], v195 offset:5152
    v_mfma_f32_16x16x32_bf16 v[28:31], v[72:75], v[108:111], v[28:31]
    ds_read_b64_tr_b16 v[136:137], v194 offset:64
    v_mfma_f32_16x16x32_bf16 v[48:51], v[72:75], v[112:115], v[48:51]
    ds_read_b64_tr_b16 v[138:139], v194 offset:5184
    v_mfma_f32_16x16x32_bf16 v[12:15], v[76:79], v[104:107], v[12:15]
    ds_read_b64_tr_b16 v[140:141], v195 offset:96
    v_mfma_f32_16x16x32_bf16 v[32:35], v[76:79], v[108:111], v[32:35]
    ds_read_b64_tr_b16 v[142:143], v195 offset:5216
    v_mfma_f32_16x16x32_bf16 v[52:55], v[76:79], v[112:115], v[52:55]
    ds_read_b64_tr_b16 v[144:145], v194 offset:128
    v_mfma_f32_16x16x32_bf16 v[16:19], v[80:83], v[104:107], v[16:19]
    ds_read_b64_tr_b16 v[146:147], v194 offset:5248
    v_mfma_f32_16x16x32_bf16 v[36:39], v[80:83], v[108:111], v[36:39]
    ds_read_b128 v[180:183], v199 offset:1024
    v_mfma_f32_16x16x32_bf16 v[56:59], v[80:83], v[112:115], v[56:59]
    ds_read_b128 v[184:187], v199 offset:3072
    v_mfma_f32_16x16x32_bf16 v[0:3], v[84:87], v[116:119], v[0:3]
    ds_read_b128 v[188:191], v199 offset:5120
    v_mfma_f32_16x16x32_bf16 v[20:23], v[84:87], v[120:123], v[20:23]
    ds_read_b64_tr_b16 v[148:149], v194 offset:10240
    v_mfma_f32_16x16x32_bf16 v[40:43], v[84:87], v[124:127], v[40:43]
    ds_read_b64_tr_b16 v[150:151], v194 offset:15360
    v_mfma_f32_16x16x32_bf16 v[4:7], v[88:91], v[116:119], v[4:7]
    ds_read_b64_tr_b16 v[152:153], v195 offset:10272
    v_mfma_f32_16x16x32_bf16 v[24:27], v[88:91], v[120:123], v[24:27]
    ds_read_b64_tr_b16 v[154:155], v195 offset:15392
    v_mfma_f32_16x16x32_bf16 v[44:47], v[88:91], v[124:127], v[44:47]
    ds_read_b64_tr_b16 v[156:157], v194 offset:10304
    v_mfma_f32_16x16x32_bf16 v[8:11], v[92:95], v[116:119], v[8:11]
    ds_read_b64_tr_b16 v[158:159], v194 offset:15424
    v_mfma_f32_16x16x32_bf16 v[28:31], v[92:95], v[120:123], v[28:31]
    ds_read_b64_tr_b16 v[160:161], v195 offset:10336
    v_mfma_f32_16x16x32_bf16 v[48:51], v[92:95], v[124:127], v[48:51]
    ds_read_b64_tr_b16 v[162:163], v195 offset:15456
    v_mfma_f32_16x16x32_bf16 v[12:15], v[96:99], v[116:119], v[12:15]
    ds_read_b64_tr_b16 v[164:165], v194 offset:10368
    v_mfma_f32_16x16x32_bf16 v[32:35], v[96:99], v[120:123], v[32:35]
    ds_read_b64_tr_b16 v[166:167], v194 offset:15488
    v_mfma_f32_16x16x32_bf16 v[52:55], v[96:99], v[124:127], v[52:55]
    v_mfma_f32_16x16x32_bf16 v[16:19], v[100:103], v[116:119], v[16:19]
    v_mfma_f32_16x16x32_bf16 v[36:39], v[100:103], v[120:123], v[36:39]
    v_mfma_f32_16x16x32_bf16 v[56:59], v[100:103], v[124:127], v[56:59]
    s_waitcnt lgkmcnt(0)
    s_barrier
    v_mfma_f32_16x16x32_bf16 v[0:3], v[128:131], v[168:171], v[0:3]
    ds_read_b128 v[104:107], v200 offset:0
    v_mfma_f32_16x16x32_bf16 v[20:23], v[128:131], v[172:175], v[20:23]
    ds_read_b128 v[108:111], v200 offset:2048
    v_mfma_f32_16x16x32_bf16 v[40:43], v[128:131], v[176:179], v[40:43]
    ds_read_b128 v[112:115], v200 offset:4096
    v_mfma_f32_16x16x32_bf16 v[4:7], v[132:135], v[168:171], v[4:7]
    ds_read_b64_tr_b16 v[64:65], v196 offset:0
    v_mfma_f32_16x16x32_bf16 v[24:27], v[132:135], v[172:175], v[24:27]
    ds_read_b64_tr_b16 v[66:67], v196 offset:5120
    v_mfma_f32_16x16x32_bf16 v[44:47], v[132:135], v[176:179], v[44:47]
    ds_read_b64_tr_b16 v[68:69], v197 offset:32
    v_mfma_f32_16x16x32_bf16 v[8:11], v[136:139], v[168:171], v[8:11]
    ds_read_b64_tr_b16 v[70:71], v197 offset:5152
    v_mfma_f32_16x16x32_bf16 v[28:31], v[136:139], v[172:175], v[28:31]
    ds_read_b64_tr_b16 v[72:73], v196 offset:64
    v_mfma_f32_16x16x32_bf16 v[48:51], v[136:139], v[176:179], v[48:51]
    ds_read_b64_tr_b16 v[74:75], v196 offset:5184
    v_mfma_f32_16x16x32_bf16 v[12:15], v[140:143], v[168:171], v[12:15]
    ds_read_b64_tr_b16 v[76:77], v197 offset:96
    v_mfma_f32_16x16x32_bf16 v[32:35], v[140:143], v[172:175], v[32:35]
    ds_read_b64_tr_b16 v[78:79], v197 offset:5216
    v_mfma_f32_16x16x32_bf16 v[52:55], v[140:143], v[176:179], v[52:55]
    ds_read_b64_tr_b16 v[80:81], v196 offset:128
    v_mfma_f32_16x16x32_bf16 v[16:19], v[144:147], v[168:171], v[16:19]
    ds_read_b64_tr_b16 v[82:83], v196 offset:5248
    v_mfma_f32_16x16x32_bf16 v[36:39], v[144:147], v[172:175], v[36:39]
    ds_read_b128 v[116:119], v200 offset:1024
    v_mfma_f32_16x16x32_bf16 v[56:59], v[144:147], v[176:179], v[56:59]
    ds_read_b128 v[120:123], v200 offset:3072
    v_mfma_f32_16x16x32_bf16 v[0:3], v[148:151], v[180:183], v[0:3]
    ds_read_b128 v[124:127], v200 offset:5120
    v_mfma_f32_16x16x32_bf16 v[20:23], v[148:151], v[184:187], v[20:23]
    ds_read_b64_tr_b16 v[84:85], v196 offset:10240
    v_mfma_f32_16x16x32_bf16 v[40:43], v[148:151], v[188:191], v[40:43]
    ds_read_b64_tr_b16 v[86:87], v196 offset:15360
    v_mfma_f32_16x16x32_bf16 v[4:7], v[152:155], v[180:183], v[4:7]
    ds_read_b64_tr_b16 v[88:89], v197 offset:10272
    v_mfma_f32_16x16x32_bf16 v[24:27], v[152:155], v[184:187], v[24:27]
    ds_read_b64_tr_b16 v[90:91], v197 offset:15392
    v_mfma_f32_16x16x32_bf16 v[44:47], v[152:155], v[188:191], v[44:47]
    ds_read_b64_tr_b16 v[92:93], v196 offset:10304
    v_mfma_f32_16x16x32_bf16 v[8:11], v[156:159], v[180:183], v[8:11]
    ds_read_b64_tr_b16 v[94:95], v196 offset:15424
    v_mfma_f32_16x16x32_bf16 v[28:31], v[156:159], v[184:187], v[28:31]
    ds_read_b64_tr_b16 v[96:97], v197 offset:10336
    v_mfma_f32_16x16x32_bf16 v[48:51], v[156:159], v[188:191], v[48:51]
    ds_read_b64_tr_b16 v[98:99], v197 offset:15456
    v_mfma_f32_16x16x32_bf16 v[12:15], v[160:163], v[180:183], v[12:15]
    ds_read_b64_tr_b16 v[100:101], v196 offset:10368
    v_mfma_f32_16x16x32_bf16 v[32:35], v[160:163], v[184:187], v[32:35]
    ds_read_b64_tr_b16 v[102:103], v196 offset:15488
    v_mfma_f32_16x16x32_bf16 v[52:55], v[160:163], v[188:191], v[52:55]
    v_mfma_f32_16x16x32_bf16 v[16:19], v[164:167], v[180:183], v[16:19]
    v_mfma_f32_16x16x32_bf16 v[36:39], v[164:167], v[184:187], v[36:39]
    v_mfma_f32_16x16x32_bf16 v[56:59], v[164:167], v[188:191], v[56:59]
    s_waitcnt lgkmcnt(0)
    s_barrier
    v_mfma_f32_16x16x32_bf16 v[0:3], v[64:67], v[104:107], v[0:3]
    ds_read_b128 v[168:171], v199 offset:32768
    v_mfma_f32_16x16x32_bf16 v[20:23], v[64:67], v[108:111], v[20:23]
    ds_read_b128 v[172:175], v199 offset:34816
    v_mfma_f32_16x16x32_bf16 v[40:43], v[64:67], v[112:115], v[40:43]
    ds_read_b128 v[176:179], v199 offset:36864
    v_mfma_f32_16x16x32_bf16 v[4:7], v[68:71], v[104:107], v[4:7]
    ds_read_b64_tr_b16 v[128:129], v194 offset:32768
    v_mfma_f32_16x16x32_bf16 v[24:27], v[68:71], v[108:111], v[24:27]
    ds_read_b64_tr_b16 v[130:131], v194 offset:37888
    v_mfma_f32_16x16x32_bf16 v[44:47], v[68:71], v[112:115], v[44:47]
    ds_read_b64_tr_b16 v[132:133], v195 offset:32800
    v_mfma_f32_16x16x32_bf16 v[8:11], v[72:75], v[104:107], v[8:11]
    ds_read_b64_tr_b16 v[134:135], v195 offset:37920
    v_mfma_f32_16x16x32_bf16 v[28:31], v[72:75], v[108:111], v[28:31]
    ds_read_b64_tr_b16 v[136:137], v194 offset:32832
    v_mfma_f32_16x16x32_bf16 v[48:51], v[72:75], v[112:115], v[48:51]
    ds_read_b64_tr_b16 v[138:139], v194 offset:37952
    v_mfma_f32_16x16x32_bf16 v[12:15], v[76:79], v[104:107], v[12:15]
    ds_read_b64_tr_b16 v[140:141], v195 offset:32864
    v_mfma_f32_16x16x32_bf16 v[32:35], v[76:79], v[108:111], v[32:35]
    ds_read_b64_tr_b16 v[142:143], v195 offset:37984
    v_mfma_f32_16x16x32_bf16 v[52:55], v[76:79], v[112:115], v[52:55]
    ds_read_b64_tr_b16 v[144:145], v194 offset:32896
    v_mfma_f32_16x16x32_bf16 v[16:19], v[80:83], v[104:107], v[16:19]
    ds_read_b64_tr_b16 v[146:147], v194 offset:38016
    v_mfma_f32_16x16x32_bf16 v[36:39], v[80:83], v[108:111], v[36:39]
    ds_read_b128 v[180:183], v199 offset:33792
    v_mfma_f32_16x16x32_bf16 v[56:59], v[80:83], v[112:115], v[56:59]
    ds_read_b128 v[184:187], v199 offset:35840
    v_mfma_f32_16x16x32_bf16 v[0:3], v[84:87], v[116:119], v[0:3]
    ds_read_b128 v[188:191], v199 offset:37888
    v_mfma_f32_16x16x32_bf16 v[20:23], v[84:87], v[120:123], v[20:23]
    ds_read_b64_tr_b16 v[148:149], v194 offset:43008
    v_mfma_f32_16x16x32_bf16 v[40:43], v[84:87], v[124:127], v[40:43]
    ds_read_b64_tr_b16 v[150:151], v194 offset:48128
    v_mfma_f32_16x16x32_bf16 v[4:7], v[88:91], v[116:119], v[4:7]
    ds_read_b64_tr_b16 v[152:153], v195 offset:43040
    v_mfma_f32_16x16x32_bf16 v[24:27], v[88:91], v[120:123], v[24:27]
    ds_read_b64_tr_b16 v[154:155], v195 offset:48160
    v_mfma_f32_16x16x32_bf16 v[44:47], v[88:91], v[124:127], v[44:47]
    ds_read_b64_tr_b16 v[156:157], v194 offset:43072
    v_mfma_f32_16x16x32_bf16 v[8:11], v[92:95], v[116:119], v[8:11]
    ds_read_b64_tr_b16 v[158:159], v194 offset:48192
    v_mfma_f32_16x16x32_bf16 v[28:31], v[92:95], v[120:123], v[28:31]
    ds_read_b64_tr_b16 v[160:161], v195 offset:43104
    v_mfma_f32_16x16x32_bf16 v[48:51], v[92:95], v[124:127], v[48:51]
    ds_read_b64_tr_b16 v[162:163], v195 offset:48224
    v_mfma_f32_16x16x32_bf16 v[12:15], v[96:99], v[116:119], v[12:15]
    ds_read_b64_tr_b16 v[164:165], v194 offset:43136
    v_mfma_f32_16x16x32_bf16 v[32:35], v[96:99], v[120:123], v[32:35]
    ds_read_b64_tr_b16 v[166:167], v194 offset:48256
    v_mfma_f32_16x16x32_bf16 v[52:55], v[96:99], v[124:127], v[52:55]
    v_mfma_f32_16x16x32_bf16 v[16:19], v[100:103], v[116:119], v[16:19]
    v_mfma_f32_16x16x32_bf16 v[36:39], v[100:103], v[120:123], v[36:39]
    v_mfma_f32_16x16x32_bf16 v[56:59], v[100:103], v[124:127], v[56:59]
    s_waitcnt lgkmcnt(0)
    s_barrier
    v_mfma_f32_16x16x32_bf16 v[0:3], v[128:131], v[168:171], v[0:3]
    ds_read_b128 v[104:107], v198 offset:32768
    v_mfma_f32_16x16x32_bf16 v[20:23], v[128:131], v[172:175], v[20:23]
    ds_read_b128 v[108:111], v198 offset:34816
    v_mfma_f32_16x16x32_bf16 v[40:43], v[128:131], v[176:179], v[40:43]
    ds_read_b128 v[112:115], v198 offset:36864
    v_mfma_f32_16x16x32_bf16 v[4:7], v[132:135], v[168:171], v[4:7]
    ds_read_b64_tr_b16 v[64:65], v192 offset:32768
    v_mfma_f32_16x16x32_bf16 v[24:27], v[132:135], v[172:175], v[24:27]
    ds_read_b64_tr_b16 v[66:67], v192 offset:37888
    v_mfma_f32_16x16x32_bf16 v[44:47], v[132:135], v[176:179], v[44:47]
    ds_read_b64_tr_b16 v[68:69], v193 offset:32800
    v_mfma_f32_16x16x32_bf16 v[8:11], v[136:139], v[168:171], v[8:11]
    ds_read_b64_tr_b16 v[70:71], v193 offset:37920
    v_mfma_f32_16x16x32_bf16 v[28:31], v[136:139], v[172:175], v[28:31]
    ds_read_b64_tr_b16 v[72:73], v192 offset:32832
    v_mfma_f32_16x16x32_bf16 v[48:51], v[136:139], v[176:179], v[48:51]
    ds_read_b64_tr_b16 v[74:75], v192 offset:37952
    v_mfma_f32_16x16x32_bf16 v[12:15], v[140:143], v[168:171], v[12:15]
    ds_read_b64_tr_b16 v[76:77], v193 offset:32864
    v_mfma_f32_16x16x32_bf16 v[32:35], v[140:143], v[172:175], v[32:35]
    ds_read_b64_tr_b16 v[78:79], v193 offset:37984
    v_mfma_f32_16x16x32_bf16 v[52:55], v[140:143], v[176:179], v[52:55]
    ds_read_b64_tr_b16 v[80:81], v192 offset:32896
    v_mfma_f32_16x16x32_bf16 v[16:19], v[144:147], v[168:171], v[16:19]
    ds_read_b64_tr_b16 v[82:83], v192 offset:38016
    v_mfma_f32_16x16x32_bf16 v[36:39], v[144:147], v[172:175], v[36:39]
    ds_read_b128 v[116:119], v198 offset:33792
    v_mfma_f32_16x16x32_bf16 v[56:59], v[144:147], v[176:179], v[56:59]
    ds_read_b128 v[120:123], v198 offset:35840
    v_mfma_f32_16x16x32_bf16 v[0:3], v[148:151], v[180:183], v[0:3]
    ds_read_b128 v[124:127], v198 offset:37888
    v_mfma_f32_16x16x32_bf16 v[20:23], v[148:151], v[184:187], v[20:23]
    ds_read_b64_tr_b16 v[84:85], v192 offset:43008
    v_mfma_f32_16x16x32_bf16 v[40:43], v[148:151], v[188:191], v[40:43]
    ds_read_b64_tr_b16 v[86:87], v192 offset:48128
    v_mfma_f32_16x16x32_bf16 v[4:7], v[152:155], v[180:183], v[4:7]
    ds_read_b64_tr_b16 v[88:89], v193 offset:43040
    v_mfma_f32_16x16x32_bf16 v[24:27], v[152:155], v[184:187], v[24:27]
    ds_read_b64_tr_b16 v[90:91], v193 offset:48160
    v_mfma_f32_16x16x32_bf16 v[44:47], v[152:155], v[188:191], v[44:47]
    ds_read_b64_tr_b16 v[92:93], v192 offset:43072
    v_mfma_f32_16x16x32_bf16 v[8:11], v[156:159], v[180:183], v[8:11]
    ds_read_b64_tr_b16 v[94:95], v192 offset:48192
    v_mfma_f32_16x16x32_bf16 v[28:31], v[156:159], v[184:187], v[28:31]
    ds_read_b64_tr_b16 v[96:97], v193 offset:43104
    v_mfma_f32_16x16x32_bf16 v[48:51], v[156:159], v[188:191], v[48:51]
    ds_read_b64_tr_b16 v[98:99], v193 offset:48224
    v_mfma_f32_16x16x32_bf16 v[12:15], v[160:163], v[180:183], v[12:15]
    ds_read_b64_tr_b16 v[100:101], v192 offset:43136
    v_mfma_f32_16x16x32_bf16 v[32:35], v[160:163], v[184:187], v[32:35]
    ds_read_b64_tr_b16 v[102:103], v192 offset:48256
    v_mfma_f32_16x16x32_bf16 v[52:55], v[160:163], v[188:191], v[52:55]
    v_mfma_f32_16x16x32_bf16 v[16:19], v[164:167], v[180:183], v[16:19]
    v_mfma_f32_16x16x32_bf16 v[36:39], v[164:167], v[184:187], v[36:39]
    v_mfma_f32_16x16x32_bf16 v[56:59], v[164:167], v[188:191], v[56:59]
    s_waitcnt lgkmcnt(0)
    s_barrier
    v_mfma_f32_16x16x32_bf16 v[0:3], v[64:67], v[104:107], v[0:3]
    ds_read_b128 v[168:171], v198 offset:0
    v_mfma_f32_16x16x32_bf16 v[20:23], v[64:67], v[108:111], v[20:23]
    ds_read_b128 v[172:175], v198 offset:2048
    v_mfma_f32_16x16x32_bf16 v[40:43], v[64:67], v[112:115], v[40:43]
    ds_read_b128 v[176:179], v198 offset:4096
    v_mfma_f32_16x16x32_bf16 v[4:7], v[68:71], v[104:107], v[4:7]
    ds_read_b64_tr_b16 v[128:129], v192 offset:0
    v_mfma_f32_16x16x32_bf16 v[24:27], v[68:71], v[108:111], v[24:27]
    ds_read_b64_tr_b16 v[130:131], v192 offset:5120
    v_mfma_f32_16x16x32_bf16 v[44:47], v[68:71], v[112:115], v[44:47]
    ds_read_b64_tr_b16 v[132:133], v193 offset:32
    v_mfma_f32_16x16x32_bf16 v[8:11], v[72:75], v[104:107], v[8:11]
    ds_read_b64_tr_b16 v[134:135], v193 offset:5152
    v_mfma_f32_16x16x32_bf16 v[28:31], v[72:75], v[108:111], v[28:31]
    ds_read_b64_tr_b16 v[136:137], v192 offset:64
    v_mfma_f32_16x16x32_bf16 v[48:51], v[72:75], v[112:115], v[48:51]
    ds_read_b64_tr_b16 v[138:139], v192 offset:5184
    v_mfma_f32_16x16x32_bf16 v[12:15], v[76:79], v[104:107], v[12:15]
    ds_read_b64_tr_b16 v[140:141], v193 offset:96
    v_mfma_f32_16x16x32_bf16 v[32:35], v[76:79], v[108:111], v[32:35]
    ds_read_b64_tr_b16 v[142:143], v193 offset:5216
    v_mfma_f32_16x16x32_bf16 v[52:55], v[76:79], v[112:115], v[52:55]
    ds_read_b64_tr_b16 v[144:145], v192 offset:128
    v_mfma_f32_16x16x32_bf16 v[16:19], v[80:83], v[104:107], v[16:19]
    ds_read_b64_tr_b16 v[146:147], v192 offset:5248
    v_mfma_f32_16x16x32_bf16 v[36:39], v[80:83], v[108:111], v[36:39]
    ds_read_b128 v[180:183], v198 offset:1024
    v_mfma_f32_16x16x32_bf16 v[56:59], v[80:83], v[112:115], v[56:59]
    ds_read_b128 v[184:187], v198 offset:3072
    v_mfma_f32_16x16x32_bf16 v[0:3], v[84:87], v[116:119], v[0:3]
    ds_read_b128 v[188:191], v198 offset:5120
    v_mfma_f32_16x16x32_bf16 v[20:23], v[84:87], v[120:123], v[20:23]
    ds_read_b64_tr_b16 v[148:149], v192 offset:10240
    v_mfma_f32_16x16x32_bf16 v[40:43], v[84:87], v[124:127], v[40:43]
    ds_read_b64_tr_b16 v[150:151], v192 offset:15360
    v_mfma_f32_16x16x32_bf16 v[4:7], v[88:91], v[116:119], v[4:7]
    ds_read_b64_tr_b16 v[152:153], v193 offset:10272
    v_mfma_f32_16x16x32_bf16 v[24:27], v[88:91], v[120:123], v[24:27]
    ds_read_b64_tr_b16 v[154:155], v193 offset:15392
    v_mfma_f32_16x16x32_bf16 v[44:47], v[88:91], v[124:127], v[44:47]
    ds_read_b64_tr_b16 v[156:157], v192 offset:10304
    v_mfma_f32_16x16x32_bf16 v[8:11], v[92:95], v[116:119], v[8:11]
    ds_read_b64_tr_b16 v[158:159], v192 offset:15424
    v_mfma_f32_16x16x32_bf16 v[28:31], v[92:95], v[120:123], v[28:31]
    ds_read_b64_tr_b16 v[160:161], v193 offset:10336
    v_mfma_f32_16x16x32_bf16 v[48:51], v[92:95], v[124:127], v[48:51]
    ds_read_b64_tr_b16 v[162:163], v193 offset:15456
    v_mfma_f32_16x16x32_bf16 v[12:15], v[96:99], v[116:119], v[12:15]
    ds_read_b64_tr_b16 v[164:165], v192 offset:10368
    v_mfma_f32_16x16x32_bf16 v[32:35], v[96:99], v[120:123], v[32:35]
    ds_read_b64_tr_b16 v[166:167], v192 offset:15488
    v_mfma_f32_16x16x32_bf16 v[52:55], v[96:99], v[124:127], v[52:55]
    v_mfma_f32_16x16x32_bf16 v[16:19], v[100:103], v[116:119], v[16:19]
    v_mfma_f32_16x16x32_bf16 v[36:39], v[100:103], v[120:123], v[36:39]
    v_mfma_f32_16x16x32_bf16 v[56:59], v[100:103], v[124:127], v[56:59]
    s_waitcnt lgkmcnt(0)
    s_barrier
    v_mfma_f32_16x16x32_bf16 v[0:3], v[128:131], v[168:171], v[0:3]
    ds_read_b128 v[104:107], v199 offset:0
    v_mfma_f32_16x16x32_bf16 v[20:23], v[128:131], v[172:175], v[20:23]
    ds_read_b128 v[108:111], v199 offset:2048
    v_mfma_f32_16x16x32_bf16 v[40:43], v[128:131], v[176:179], v[40:43]
    ds_read_b128 v[112:115], v199 offset:4096
    v_mfma_f32_16x16x32_bf16 v[4:7], v[132:135], v[168:171], v[4:7]
    ds_read_b64_tr_b16 v[64:65], v194 offset:0
    v_mfma_f32_16x16x32_bf16 v[24:27], v[132:135], v[172:175], v[24:27]
    ds_read_b64_tr_b16 v[66:67], v194 offset:5120
    v_mfma_f32_16x16x32_bf16 v[44:47], v[132:135], v[176:179], v[44:47]
    ds_read_b64_tr_b16 v[68:69], v195 offset:32
    v_mfma_f32_16x16x32_bf16 v[8:11], v[136:139], v[168:171], v[8:11]
    ds_read_b64_tr_b16 v[70:71], v195 offset:5152
    v_mfma_f32_16x16x32_bf16 v[28:31], v[136:139], v[172:175], v[28:31]
    ds_read_b64_tr_b16 v[72:73], v194 offset:64
    v_mfma_f32_16x16x32_bf16 v[48:51], v[136:139], v[176:179], v[48:51]
    ds_read_b64_tr_b16 v[74:75], v194 offset:5184
    v_mfma_f32_16x16x32_bf16 v[12:15], v[140:143], v[168:171], v[12:15]
    ds_read_b64_tr_b16 v[76:77], v195 offset:96
    v_mfma_f32_16x16x32_bf16 v[32:35], v[140:143], v[172:175], v[32:35]
    ds_read_b64_tr_b16 v[78:79], v195 offset:5216
    v_mfma_f32_16x16x32_bf16 v[52:55], v[140:143], v[176:179], v[52:55]
    ds_read_b64_tr_b16 v[80:81], v194 offset:128
    v_mfma_f32_16x16x32_bf16 v[16:19], v[144:147], v[168:171], v[16:19]
    ds_read_b64_tr_b16 v[82:83], v194 offset:5248
    v_mfma_f32_16x16x32_bf16 v[36:39], v[144:147], v[172:175], v[36:39]
    ds_read_b128 v[116:119], v199 offset:1024
    v_mfma_f32_16x16x32_bf16 v[56:59], v[144:147], v[176:179], v[56:59]
    ds_read_b128 v[120:123], v199 offset:3072
    v_mfma_f32_16x16x32_bf16 v[0:3], v[148:151], v[180:183], v[0:3]
    ds_read_b128 v[124:127], v199 offset:5120
    v_mfma_f32_16x16x32_bf16 v[20:23], v[148:151], v[184:187], v[20:23]
    ds_read_b64_tr_b16 v[84:85], v194 offset:10240
    v_mfma_f32_16x16x32_bf16 v[40:43], v[148:151], v[188:191], v[40:43]
    ds_read_b64_tr_b16 v[86:87], v194 offset:15360
    v_mfma_f32_16x16x32_bf16 v[4:7], v[152:155], v[180:183], v[4:7]
    ds_read_b64_tr_b16 v[88:89], v195 offset:10272
    v_mfma_f32_16x16x32_bf16 v[24:27], v[152:155], v[184:187], v[24:27]
    ds_read_b64_tr_b16 v[90:91], v195 offset:15392
    v_mfma_f32_16x16x32_bf16 v[44:47], v[152:155], v[188:191], v[44:47]
    ds_read_b64_tr_b16 v[92:93], v194 offset:10304
    v_mfma_f32_16x16x32_bf16 v[8:11], v[156:159], v[180:183], v[8:11]
    ds_read_b64_tr_b16 v[94:95], v194 offset:15424
    v_mfma_f32_16x16x32_bf16 v[28:31], v[156:159], v[184:187], v[28:31]
    ds_read_b64_tr_b16 v[96:97], v195 offset:10336
    v_mfma_f32_16x16x32_bf16 v[48:51], v[156:159], v[188:191], v[48:51]
    ds_read_b64_tr_b16 v[98:99], v195 offset:15456
    v_mfma_f32_16x16x32_bf16 v[12:15], v[160:163], v[180:183], v[12:15]
    ds_read_b64_tr_b16 v[100:101], v194 offset:10368
    v_mfma_f32_16x16x32_bf16 v[32:35], v[160:163], v[184:187], v[32:35]
    ds_read_b64_tr_b16 v[102:103], v194 offset:15488
    v_mfma_f32_16x16x32_bf16 v[52:55], v[160:163], v[188:191], v[52:55]
    v_mfma_f32_16x16x32_bf16 v[16:19], v[164:167], v[180:183], v[16:19]
    v_mfma_f32_16x16x32_bf16 v[36:39], v[164:167], v[184:187], v[36:39]
    v_mfma_f32_16x16x32_bf16 v[56:59], v[164:167], v[188:191], v[56:59]
    s_waitcnt lgkmcnt(0)
    s_barrier
    v_mfma_f32_16x16x32_bf16 v[0:3], v[64:67], v[104:107], v[0:3]
    ds_read_b128 v[168:171], v200 offset:0
    v_mfma_f32_16x16x32_bf16 v[20:23], v[64:67], v[108:111], v[20:23]
    ds_read_b128 v[172:175], v200 offset:2048
    v_mfma_f32_16x16x32_bf16 v[40:43], v[64:67], v[112:115], v[40:43]
    ds_read_b128 v[176:179], v200 offset:4096
    v_mfma_f32_16x16x32_bf16 v[4:7], v[68:71], v[104:107], v[4:7]
    ds_read_b64_tr_b16 v[128:129], v196 offset:0
    v_mfma_f32_16x16x32_bf16 v[24:27], v[68:71], v[108:111], v[24:27]
    ds_read_b64_tr_b16 v[130:131], v196 offset:5120
    v_mfma_f32_16x16x32_bf16 v[44:47], v[68:71], v[112:115], v[44:47]
    ds_read_b64_tr_b16 v[132:133], v197 offset:32
    v_mfma_f32_16x16x32_bf16 v[8:11], v[72:75], v[104:107], v[8:11]
    ds_read_b64_tr_b16 v[134:135], v197 offset:5152
    v_mfma_f32_16x16x32_bf16 v[28:31], v[72:75], v[108:111], v[28:31]
    ds_read_b64_tr_b16 v[136:137], v196 offset:64
    v_mfma_f32_16x16x32_bf16 v[48:51], v[72:75], v[112:115], v[48:51]
    ds_read_b64_tr_b16 v[138:139], v196 offset:5184
    v_mfma_f32_16x16x32_bf16 v[12:15], v[76:79], v[104:107], v[12:15]
    ds_read_b64_tr_b16 v[140:141], v197 offset:96
    v_mfma_f32_16x16x32_bf16 v[32:35], v[76:79], v[108:111], v[32:35]
    ds_read_b64_tr_b16 v[142:143], v197 offset:5216
    v_mfma_f32_16x16x32_bf16 v[52:55], v[76:79], v[112:115], v[52:55]
    ds_read_b64_tr_b16 v[144:145], v196 offset:128
    v_mfma_f32_16x16x32_bf16 v[16:19], v[80:83], v[104:107], v[16:19]
    ds_read_b64_tr_b16 v[146:147], v196 offset:5248
    v_mfma_f32_16x16x32_bf16 v[36:39], v[80:83], v[108:111], v[36:39]
    ds_read_b128 v[180:183], v200 offset:1024
    v_mfma_f32_16x16x32_bf16 v[56:59], v[80:83], v[112:115], v[56:59]
    ds_read_b128 v[184:187], v200 offset:3072
    v_mfma_f32_16x16x32_bf16 v[0:3], v[84:87], v[116:119], v[0:3]
    ds_read_b128 v[188:191], v200 offset:5120
    v_mfma_f32_16x16x32_bf16 v[20:23], v[84:87], v[120:123], v[20:23]
    ds_read_b64_tr_b16 v[148:149], v196 offset:10240
    v_mfma_f32_16x16x32_bf16 v[40:43], v[84:87], v[124:127], v[40:43]
    ds_read_b64_tr_b16 v[150:151], v196 offset:15360
    v_mfma_f32_16x16x32_bf16 v[4:7], v[88:91], v[116:119], v[4:7]
    ds_read_b64_tr_b16 v[152:153], v197 offset:10272
    v_mfma_f32_16x16x32_bf16 v[24:27], v[88:91], v[120:123], v[24:27]
    ds_read_b64_tr_b16 v[154:155], v197 offset:15392
    v_mfma_f32_16x16x32_bf16 v[44:47], v[88:91], v[124:127], v[44:47]
    ds_read_b64_tr_b16 v[156:157], v196 offset:10304
    v_mfma_f32_16x16x32_bf16 v[8:11], v[92:95], v[116:119], v[8:11]
    ds_read_b64_tr_b16 v[158:159], v196 offset:15424
    v_mfma_f32_16x16x32_bf16 v[28:31], v[92:95], v[120:123], v[28:31]
    ds_read_b64_tr_b16 v[160:161], v197 offset:10336
    v_mfma_f32_16x16x32_bf16 v[48:51], v[92:95], v[124:127], v[48:51]
    ds_read_b64_tr_b16 v[162:163], v197 offset:15456
    v_mfma_f32_16x16x32_bf16 v[12:15], v[96:99], v[116:119], v[12:15]
    ds_read_b64_tr_b16 v[164:165], v196 offset:10368
    v_mfma_f32_16x16x32_bf16 v[32:35], v[96:99], v[120:123], v[32:35]
    ds_read_b64_tr_b16 v[166:167], v196 offset:15488
    v_mfma_f32_16x16x32_bf16 v[52:55], v[96:99], v[124:127], v[52:55]
    v_mfma_f32_16x16x32_bf16 v[16:19], v[100:103], v[116:119], v[16:19]
    v_mfma_f32_16x16x32_bf16 v[36:39], v[100:103], v[120:123], v[36:39]
    v_mfma_f32_16x16x32_bf16 v[56:59], v[100:103], v[124:127], v[56:59]
    s_waitcnt lgkmcnt(0)
    s_barrier
    v_mfma_f32_16x16x32_bf16 v[0:3], v[128:131], v[168:171], v[0:3]
    ds_read_b128 v[104:107], v199 offset:32768
    v_mfma_f32_16x16x32_bf16 v[20:23], v[128:131], v[172:175], v[20:23]
    ds_read_b128 v[108:111], v199 offset:34816
    v_mfma_f32_16x16x32_bf16 v[40:43], v[128:131], v[176:179], v[40:43]
    ds_read_b128 v[112:115], v199 offset:36864
    v_mfma_f32_16x16x32_bf16 v[4:7], v[132:135], v[168:171], v[4:7]
    ds_read_b64_tr_b16 v[64:65], v194 offset:32768
    v_mfma_f32_16x16x32_bf16 v[24:27], v[132:135], v[172:175], v[24:27]
    ds_read_b64_tr_b16 v[66:67], v194 offset:37888
    v_mfma_f32_16x16x32_bf16 v[44:47], v[132:135], v[176:179], v[44:47]
    ds_read_b64_tr_b16 v[68:69], v195 offset:32800
    v_mfma_f32_16x16x32_bf16 v[8:11], v[136:139], v[168:171], v[8:11]
    ds_read_b64_tr_b16 v[70:71], v195 offset:37920
    v_mfma_f32_16x16x32_bf16 v[28:31], v[136:139], v[172:175], v[28:31]
    ds_read_b64_tr_b16 v[72:73], v194 offset:32832
    v_mfma_f32_16x16x32_bf16 v[48:51], v[136:139], v[176:179], v[48:51]
    ds_read_b64_tr_b16 v[74:75], v194 offset:37952
    v_mfma_f32_16x16x32_bf16 v[12:15], v[140:143], v[168:171], v[12:15]
    ds_read_b64_tr_b16 v[76:77], v195 offset:32864
    v_mfma_f32_16x16x32_bf16 v[32:35], v[140:143], v[172:175], v[32:35]
    ds_read_b64_tr_b16 v[78:79], v195 offset:37984
    v_mfma_f32_16x16x32_bf16 v[52:55], v[140:143], v[176:179], v[52:55]
    ds_read_b64_tr_b16 v[80:81], v194 offset:32896
    v_mfma_f32_16x16x32_bf16 v[16:19], v[144:147], v[168:171], v[16:19]
    ds_read_b64_tr_b16 v[82:83], v194 offset:38016
    v_mfma_f32_16x16x32_bf16 v[36:39], v[144:147], v[172:175], v[36:39]
    ds_read_b128 v[116:119], v199 offset:33792
    v_mfma_f32_16x16x32_bf16 v[56:59], v[144:147], v[176:179], v[56:59]
    ds_read_b128 v[120:123], v199 offset:35840
    v_mfma_f32_16x16x32_bf16 v[0:3], v[148:151], v[180:183], v[0:3]
    ds_read_b128 v[124:127], v199 offset:37888
    v_mfma_f32_16x16x32_bf16 v[20:23], v[148:151], v[184:187], v[20:23]
    ds_read_b64_tr_b16 v[84:85], v194 offset:43008
    v_mfma_f32_16x16x32_bf16 v[40:43], v[148:151], v[188:191], v[40:43]
    ds_read_b64_tr_b16 v[86:87], v194 offset:48128
    v_mfma_f32_16x16x32_bf16 v[4:7], v[152:155], v[180:183], v[4:7]
    ds_read_b64_tr_b16 v[88:89], v195 offset:43040
    v_mfma_f32_16x16x32_bf16 v[24:27], v[152:155], v[184:187], v[24:27]
    ds_read_b64_tr_b16 v[90:91], v195 offset:48160
    v_mfma_f32_16x16x32_bf16 v[44:47], v[152:155], v[188:191], v[44:47]
    ds_read_b64_tr_b16 v[92:93], v194 offset:43072
    v_mfma_f32_16x16x32_bf16 v[8:11], v[156:159], v[180:183], v[8:11]
    ds_read_b64_tr_b16 v[94:95], v194 offset:48192
    v_mfma_f32_16x16x32_bf16 v[28:31], v[156:159], v[184:187], v[28:31]
    ds_read_b64_tr_b16 v[96:97], v195 offset:43104
    v_mfma_f32_16x16x32_bf16 v[48:51], v[156:159], v[188:191], v[48:51]
    ds_read_b64_tr_b16 v[98:99], v195 offset:48224
    v_mfma_f32_16x16x32_bf16 v[12:15], v[160:163], v[180:183], v[12:15]
    ds_read_b64_tr_b16 v[100:101], v194 offset:43136
    v_mfma_f32_16x16x32_bf16 v[32:35], v[160:163], v[184:187], v[32:35]
    ds_read_b64_tr_b16 v[102:103], v194 offset:48256
    v_mfma_f32_16x16x32_bf16 v[52:55], v[160:163], v[188:191], v[52:55]
    v_mfma_f32_16x16x32_bf16 v[16:19], v[164:167], v[180:183], v[16:19]
    v_mfma_f32_16x16x32_bf16 v[36:39], v[164:167], v[184:187], v[36:39]
    v_mfma_f32_16x16x32_bf16 v[56:59], v[164:167], v[188:191], v[56:59]
    s_waitcnt lgkmcnt(0)
    s_barrier
    v_mfma_f32_16x16x32_bf16 v[0:3], v[64:67], v[104:107], v[0:3]
    ds_read_b128 v[168:171], v198 offset:32768
    v_mfma_f32_16x16x32_bf16 v[20:23], v[64:67], v[108:111], v[20:23]
    ds_read_b128 v[172:175], v198 offset:34816
    v_mfma_f32_16x16x32_bf16 v[40:43], v[64:67], v[112:115], v[40:43]
    ds_read_b128 v[176:179], v198 offset:36864
    v_mfma_f32_16x16x32_bf16 v[4:7], v[68:71], v[104:107], v[4:7]
    ds_read_b64_tr_b16 v[128:129], v192 offset:32768
    v_mfma_f32_16x16x32_bf16 v[24:27], v[68:71], v[108:111], v[24:27]
    ds_read_b64_tr_b16 v[130:131], v192 offset:37888
    v_mfma_f32_16x16x32_bf16 v[44:47], v[68:71], v[112:115], v[44:47]
    ds_read_b64_tr_b16 v[132:133], v193 offset:32800
    v_mfma_f32_16x16x32_bf16 v[8:11], v[72:75], v[104:107], v[8:11]
    ds_read_b64_tr_b16 v[134:135], v193 offset:37920
    v_mfma_f32_16x16x32_bf16 v[28:31], v[72:75], v[108:111], v[28:31]
    ds_read_b64_tr_b16 v[136:137], v192 offset:32832
    v_mfma_f32_16x16x32_bf16 v[48:51], v[72:75], v[112:115], v[48:51]
    ds_read_b64_tr_b16 v[138:139], v192 offset:37952
    v_mfma_f32_16x16x32_bf16 v[12:15], v[76:79], v[104:107], v[12:15]
    ds_read_b64_tr_b16 v[140:141], v193 offset:32864
    v_mfma_f32_16x16x32_bf16 v[32:35], v[76:79], v[108:111], v[32:35]
    ds_read_b64_tr_b16 v[142:143], v193 offset:37984
    v_mfma_f32_16x16x32_bf16 v[52:55], v[76:79], v[112:115], v[52:55]
    ds_read_b64_tr_b16 v[144:145], v192 offset:32896
    v_mfma_f32_16x16x32_bf16 v[16:19], v[80:83], v[104:107], v[16:19]
    ds_read_b64_tr_b16 v[146:147], v192 offset:38016
    v_mfma_f32_16x16x32_bf16 v[36:39], v[80:83], v[108:111], v[36:39]
    ds_read_b128 v[180:183], v198 offset:33792
    v_mfma_f32_16x16x32_bf16 v[56:59], v[80:83], v[112:115], v[56:59]
    ds_read_b128 v[184:187], v198 offset:35840
    v_mfma_f32_16x16x32_bf16 v[0:3], v[84:87], v[116:119], v[0:3]
    ds_read_b128 v[188:191], v198 offset:37888
    v_mfma_f32_16x16x32_bf16 v[20:23], v[84:87], v[120:123], v[20:23]
    ds_read_b64_tr_b16 v[148:149], v192 offset:43008
    v_mfma_f32_16x16x32_bf16 v[40:43], v[84:87], v[124:127], v[40:43]
    ds_read_b64_tr_b16 v[150:151], v192 offset:48128
    v_mfma_f32_16x16x32_bf16 v[4:7], v[88:91], v[116:119], v[4:7]
    ds_read_b64_tr_b16 v[152:153], v193 offset:43040
    v_mfma_f32_16x16x32_bf16 v[24:27], v[88:91], v[120:123], v[24:27]
    ds_read_b64_tr_b16 v[154:155], v193 offset:48160
    v_mfma_f32_16x16x32_bf16 v[44:47], v[88:91], v[124:127], v[44:47]
    ds_read_b64_tr_b16 v[156:157], v192 offset:43072
    v_mfma_f32_16x16x32_bf16 v[8:11], v[92:95], v[116:119], v[8:11]
    ds_read_b64_tr_b16 v[158:159], v192 offset:48192
    v_mfma_f32_16x16x32_bf16 v[28:31], v[92:95], v[120:123], v[28:31]
    ds_read_b64_tr_b16 v[160:161], v193 offset:43104
    v_mfma_f32_16x16x32_bf16 v[48:51], v[92:95], v[124:127], v[48:51]
    ds_read_b64_tr_b16 v[162:163], v193 offset:48224
    v_mfma_f32_16x16x32_bf16 v[12:15], v[96:99], v[116:119], v[12:15]
    ds_read_b64_tr_b16 v[164:165], v192 offset:43136
    v_mfma_f32_16x16x32_bf16 v[32:35], v[96:99], v[120:123], v[32:35]
    ds_read_b64_tr_b16 v[166:167], v192 offset:48256
    v_mfma_f32_16x16x32_bf16 v[52:55], v[96:99], v[124:127], v[52:55]
    v_mfma_f32_16x16x32_bf16 v[16:19], v[100:103], v[116:119], v[16:19]
    v_mfma_f32_16x16x32_bf16 v[36:39], v[100:103], v[120:123], v[36:39]
    v_mfma_f32_16x16x32_bf16 v[56:59], v[100:103], v[124:127], v[56:59]
    s_waitcnt lgkmcnt(0)
    v_mfma_f32_16x16x32_bf16 v[0:3], v[128:131], v[168:171], v[0:3]
    v_mfma_f32_16x16x32_bf16 v[20:23], v[128:131], v[172:175], v[20:23]
    v_mfma_f32_16x16x32_bf16 v[40:43], v[128:131], v[176:179], v[40:43]
    v_mfma_f32_16x16x32_bf16 v[4:7], v[132:135], v[168:171], v[4:7]
    v_mfma_f32_16x16x32_bf16 v[24:27], v[132:135], v[172:175], v[24:27]
    v_mfma_f32_16x16x32_bf16 v[44:47], v[132:135], v[176:179], v[44:47]
    v_mfma_f32_16x16x32_bf16 v[8:11], v[136:139], v[168:171], v[8:11]
    v_mfma_f32_16x16x32_bf16 v[28:31], v[136:139], v[172:175], v[28:31]
    v_mfma_f32_16x16x32_bf16 v[48:51], v[136:139], v[176:179], v[48:51]
    v_mfma_f32_16x16x32_bf16 v[12:15], v[140:143], v[168:171], v[12:15]
    v_mfma_f32_16x16x32_bf16 v[32:35], v[140:143], v[172:175], v[32:35]
    v_mfma_f32_16x16x32_bf16 v[52:55], v[140:143], v[176:179], v[52:55]
    v_mfma_f32_16x16x32_bf16 v[16:19], v[144:147], v[168:171], v[16:19]
    v_mfma_f32_16x16x32_bf16 v[36:39], v[144:147], v[172:175], v[36:39]
    v_mfma_f32_16x16x32_bf16 v[56:59], v[144:147], v[176:179], v[56:59]
    v_mfma_f32_16x16x32_bf16 v[0:3], v[148:151], v[180:183], v[0:3]
    v_mfma_f32_16x16x32_bf16 v[20:23], v[148:151], v[184:187], v[20:23]
    v_mfma_f32_16x16x32_bf16 v[40:43], v[148:151], v[188:191], v[40:43]
    v_mfma_f32_16x16x32_bf16 v[4:7], v[152:155], v[180:183], v[4:7]
    v_mfma_f32_16x16x32_bf16 v[24:27], v[152:155], v[184:187], v[24:27]
    v_mfma_f32_16x16x32_bf16 v[44:47], v[152:155], v[188:191], v[44:47]
    v_mfma_f32_16x16x32_bf16 v[8:11], v[156:159], v[180:183], v[8:11]
    v_mfma_f32_16x16x32_bf16 v[28:31], v[156:159], v[184:187], v[28:31]
    v_mfma_f32_16x16x32_bf16 v[48:51], v[156:159], v[188:191], v[48:51]
    v_mfma_f32_16x16x32_bf16 v[12:15], v[160:163], v[180:183], v[12:15]
    v_mfma_f32_16x16x32_bf16 v[32:35], v[160:163], v[184:187], v[32:35]
    v_mfma_f32_16x16x32_bf16 v[52:55], v[160:163], v[188:191], v[52:55]
    v_mfma_f32_16x16x32_bf16 v[16:19], v[164:167], v[180:183], v[16:19]
    v_mfma_f32_16x16x32_bf16 v[36:39], v[164:167], v[184:187], v[36:39]
    v_mfma_f32_16x16x32_bf16 v[56:59], v[164:167], v[188:191], v[56:59]
    v_lshlrev_b32 v252, 4, v249
    s_lshl_b32 s53, s96, 2
    s_add_u32 s53, s53, s3
    s_lshl_b32 s53, s53, 2
    s_add_u32 s53, s53, s94
    s_mul_i32 s53, s53, 15360
    s_add_u32 s53, s53, 16777216
    s_nop 2
    s_cmp_eq_u32 s3, s94
    s_cbranch_scc1 L_gown
    buffer_store_dwordx4 v[0:3], v252, s[24:27], s53 offen offset:0 sc1
    buffer_store_dwordx4 v[4:7], v252, s[24:27], s53 offen offset:1024 sc1
    buffer_store_dwordx4 v[8:11], v252, s[24:27], s53 offen offset:2048 sc1
    buffer_store_dwordx4 v[12:15], v252, s[24:27], s53 offen offset:3072 sc1
    s_add_u32 s53, s53, 4096
    buffer_store_dwordx4 v[16:19], v252, s[24:27], s53 offen offset:0 sc1
    buffer_store_dwordx4 v[20:23], v252, s[24:27], s53 offen offset:1024 sc1
    buffer_store_dwordx4 v[24:27], v252, s[24:27], s53 offen offset:2048 sc1
    buffer_store_dwordx4 v[28:31], v252, s[24:27], s53 offen offset:3072 sc1
    s_add_u32 s53, s53, 4096
    buffer_store_dwordx4 v[32:35], v252, s[24:27], s53 offen offset:0 sc1
    buffer_store_dwordx4 v[36:39], v252, s[24:27], s53 offen offset:1024 sc1
    buffer_store_dwordx4 v[40:43], v252, s[24:27], s53 offen offset:2048 sc1
    buffer_store_dwordx4 v[44:47], v252, s[24:27], s53 offen offset:3072 sc1
    s_add_u32 s53, s53, 4096
    buffer_store_dwordx4 v[48:51], v252, s[24:27], s53 offen offset:0 sc1
    buffer_store_dwordx4 v[52:55], v252, s[24:27], s53 offen offset:1024 sc1
    buffer_store_dwordx4 v[56:59], v252, s[24:27], s53 offen offset:2048 sc1
    s_waitcnt vmcnt(0)
    s_branch L_gpub
L_gown:
    ds_write_b128 v252, v[0:3] offset:0
    ds_write_b128 v252, v[4:7] offset:1024
    ds_write_b128 v252, v[8:11] offset:2048
    ds_write_b128 v252, v[12:15] offset:3072
    ds_write_b128 v252, v[16:19] offset:4096
    ds_write_b128 v252, v[20:23] offset:5120
    ds_write_b128 v252, v[24:27] offset:6144
    ds_write_b128 v252, v[28:31] offset:7168
    ds_write_b128 v252, v[32:35] offset:8192
    ds_write_b128 v252, v[36:39] offset:9216
    ds_write_b128 v252, v[40:43] offset:10240
    ds_write_b128 v252, v[44:47] offset:11264
    ds_write_b128 v252, v[48:51] offset:12288
    ds_write_b128 v252, v[52:55] offset:13312
    ds_write_b128 v252, v[56:59] offset:14336
    s_waitcnt lgkmcnt(0)
L_gpub:
    s_barrier
    s_cmp_lg_u32 s3, 5
    s_cbranch_scc1 L_gwait
    s_lshl_b32 s46, s2, 7
    s_add_u32 s46, s46, 33619968
    s_mov_b64 exec, 1
    v_mov_b32 v5, 0
    v_mov_b32 v6, s92
    v_mov_b32 v7, s93
    buffer_store_dwordx2 v[6:7], v5, s[24:27], s46 offen sc1
    s_mov_b64 exec, -1
    s_mov_b32 s48, 1
    s_lshl_b32 s48, s48, s94
    s_xor_b32 s48, s48, 15
    s_mov_b64 exec, 15
    buffer_load_dwordx2 v[8:9], v4, s[24:27], s100 offen sc1
    s_mov_b64 exec, -1
    s_waitcnt vmcnt(0)
    s_mov_b32 s47, 0x8000
L_sp_21:
    v_cmp_eq_u64 vcc, s[92:93], v[8:9]
    s_and_b32 s46, vcc_lo, s48
    s_cmp_eq_u32 s46, s48
    s_cbranch_scc1 L_ok_22
    s_sub_u32 s47, s47, 1
    s_cbranch_scc1 L_ok_22
    s_mov_b64 exec, 15
    buffer_load_dwordx2 v[8:9], v4, s[24:27], s100 offen sc1
    s_mov_b64 exec, -1
    s_waitcnt vmcnt(0)
    s_branch L_sp_21
L_ok_22:
L_gwait:
    s_lshl_b32 s53, s3, 6
    v_add_u32 v0, s53, v249
    v_lshrrev_b32 v253, 4, v0
    v_lshlrev_b32 v252, 9, v253
    v_lshl_add_u32 v252, v251, 4, v252
    v_mul_u32_u24 v254, 26, v253
    v_lshrrev_b32 v254, 8, v254
    v_mul_u32_u24 v255, 10, v254
    v_sub_u32 v253, v253, v255
    v_lshl_add_u32 v254, v254, 4, v251
    v_mul_u32_u24 v255, 2560, v254
    v_lshl_add_u32 v255, v253, 4, v255
    s_mul_i32 s56, s6, 96
    s_lshr_b32 s54, s94, 1
    s_mul_i32 s54, s54, 48
    s_add_u32 s56, s56, s54
    s_mul_i32 s56, s56, 2560
    s_mul_i32 s54, s4, 1280
    s_add_u32 s56, s56, s54
    s_mul_i32 s54, s95, 320
    s_add_u32 s56, s56, s54
    s_and_b32 s54, s94, 1
    s_mul_i32 s54, s54, 160
    s_add_u32 s56, s56, s54
    s_lshl_b32 s57, s96, 2
    s_add_u32 s57, s57, s94
    s_mul_i32 s57, s57, 61440
    s_add_u32 s57, s57, 16777216
    s_barrier
    v_cmp_gt_u32 vcc, 480, v0
    s_and_saveexec_b64 s[58:59], vcc
    s_add_u32 s53, s94, 1
    s_and_b32 s53, s53, 3
    s_mul_i32 s53, s53, 15360
    s_add_u32 s53, s53, s57
    buffer_load_dwordx4 v[72:75], v252, s[24:27], s53 offen offset:0 sc1
    buffer_load_dwordx4 v[76:79], v252, s[24:27], s53 offen offset:256 sc1
    s_add_u32 s53, s94, 2
    s_and_b32 s53, s53, 3
    s_mul_i32 s53, s53, 15360
    s_add_u32 s53, s53, s57
    buffer_load_dwordx4 v[80:83], v252, s[24:27], s53 offen offset:0 sc1
    buffer_load_dwordx4 v[84:87], v252, s[24:27], s53 offen offset:256 sc1
    s_add_u32 s53, s94, 3
    s_and_b32 s53, s53, 3
    s_mul_i32 s53, s53, 15360
    s_add_u32 s53, s53, s57
    buffer_load_dwordx4 v[88:91], v252, s[24:27], s53 offen offset:0 sc1
    buffer_load_dwordx4 v[92:95], v252, s[24:27], s53 offen offset:256 sc1
    ds_read_b128 v[64:67], v252 offset:0
    ds_read_b128 v[68:71], v252 offset:256
    s_waitcnt lgkmcnt(0)
    s_waitcnt vmcnt(4)
    v_add_f32 v64, v64, v72
    v_add_f32 v65, v65, v73
    v_add_f32 v66, v66, v74
    v_add_f32 v67, v67, v75
    v_add_f32 v68, v68, v76
    v_add_f32 v69, v69, v77
    v_add_f32 v70, v70, v78
    v_add_f32 v71, v71, v79
    s_waitcnt vmcnt(2)
    v_add_f32 v64, v64, v80
    v_add_f32 v65, v65, v81
    v_add_f32 v66, v66, v82
    v_add_f32 v67, v67, v83
    v_add_f32 v68, v68, v84
    v_add_f32 v69, v69, v85
    v_add_f32 v70, v70, v86
    v_add_f32 v71, v71, v87
    s_waitcnt vmcnt(0)
    v_add_f32 v64, v64, v88
    v_add_f32 v65, v65, v89
    v_add_f32 v66, v66, v90
    v_add_f32 v67, v67, v91
    v_add_f32 v68, v68, v92
    v_add_f32 v69, v69, v93
    v_add_f32 v70, v70, v94
    v_add_f32 v71, v71, v95
    v_cvt_pk_bf16_f32 v64, v64, v65
    v_cvt_pk_bf16_f32 v65, v66, v67
    v_cvt_pk_bf16_f32 v66, v68, v69
    v_cvt_pk_bf16_f32 v67, v70, v71
    buffer_store_dwordx4 v[64:67], v255, s[32:35], s56 offen
    s_mov_b64 exec, s[58:59]
L_end:
    s_endpgm
.section .rodata,"a"
.p2align 6
.amdhsa_kernel concat_heads__gqa_block_cached__gqa_block_cached__near_ridge_kernel
  .amdhsa_next_free_vgpr 256
  .amdhsa_next_free_sgpr 102
  .amdhsa_accum_offset 256
  .amdhsa_group_segment_fixed_size 0
  .amdhsa_kernarg_size 104
  .amdhsa_user_sgpr_count 2
  .amdhsa_user_sgpr_kernarg_segment_ptr 1
  .amdhsa_system_sgpr_workgroup_id_x 1
.end_amdhsa_kernel
```
